```python
import torch

def _softmax(x, axis=-1):
    return torch.softmax(x, dim=axis)
def _gelu(x):
    return torch.nn.functional.gelu(x, approximate="tanh")
def _silu(x):
    return torch.nn.functional.silu(x)
def _sigmoid(x):
    return torch.sigmoid(x)
def _layernorm(x, axis=-1, eps=1e-5):
    m = x.mean(dim=axis, keepdim=True)
    v = x.var(dim=axis, keepdim=True, unbiased=False)
    return (x - m) / torch.sqrt(v + eps)
def _scatter_add(tgt, idx, src, axis=0):
    return tgt.clone().index_add_(axis, idx, src)
def _segment_sum(src, seg, n):
    out = torch.zeros((n,) + src.shape[1:], dtype=src.dtype)
    return out.index_add_(0, seg, src)
def _pad(x, pw):
    flat = tuple(v for pair in reversed(pw) for v in pair)
    return torch.nn.functional.pad(x, flat)

kernel_name = 'gated_mix__linear_attn_block__mixer_channel_mlp__prompt'

def setup_inputs():

    _w = (lambda a: (lambda t: t.to(torch.bfloat16) if t.is_floating_point() else t)(torch.as_tensor(a)))
    def _A_setup():
        B, S, D = 1, 2048, 576
        return {
            "x": _w((lambda *s: torch.randn(*s, dtype=torch.bfloat16) * 0.05)(B, S, D)),
            "wqkv": _w((lambda *s: torch.randn(*s, dtype=torch.bfloat16) * 0.8)(D, 3 * D)),
            "wo": _w((lambda *s: torch.randn(*s, dtype=torch.bfloat16) * 0.2)(D, D)),
        }
    _A_in = _A_setup()

    def _B_setup():
        B, S, D, F = 1, 2048, 576, 4608
        return {
            "x": _w((lambda *s: torch.randn(*s, dtype=torch.bfloat16) * 0.05)(B, S, D)),
            "w1": _w((lambda *s: torch.randn(*s, dtype=torch.bfloat16) * 1.6)(D, F) * (D ** -0.5)),
            "b1": _w((lambda *s: torch.randn(*s, dtype=torch.bfloat16) * 0.4)(F)),
            "w2": _w((lambda *s: torch.randn(*s, dtype=torch.bfloat16) * 0.05)(F, D) * (F ** -0.5)),
            "b2": _w((lambda *s: torch.randn(*s, dtype=torch.bfloat16) * 0.05)(D)),
        }
    _B_in = _B_setup()

    return {
        "A_x": _A_in["x"],
        "A_wqkv": _A_in["wqkv"],
        "A_wo": _A_in["wo"],
        "B_x": _B_in["x"],
        "B_w1": _B_in["w1"],
        "B_b1": _B_in["b1"],
        "B_w2": _B_in["w2"],
        "B_b2": _B_in["b2"],
        "gate_w": _w((lambda *s: torch.randn(*s, dtype=torch.bfloat16) * 0.05)(576) * 16.0),
    }

def reference(A_x, A_wqkv, A_wo, B_x, B_w1, B_b1, B_w2, B_b2, gate_w):
    def _A_ref(x, wqkv, wo):
        B, S, D = x.shape
        H = 32; Dh = D // H
        qkv = (lambda x, *d: x.permute(*d))((x @ wqkv).reshape(B, S, 3, H, Dh), 2, 0, 3, 1, 4)
        q, k, v = qkv[0], qkv[1], qkv[2]
        phi = lambda t: torch.where(t > 0, t + 1, torch.exp(t)) + 1e-6
        pq, pk = phi(q), phi(k)
        kv = torch.einsum("bhsd,bhse->bhde", pk, v)
        z = torch.einsum("bhsd->bhd", pk)
        num = torch.einsum("bhqd,bhde->bhqe", pq, kv)
        den = torch.einsum("bhqd,bhd->bhq", pq, z)[..., None] + 1e-6
        o = num / den
        return (lambda x, *d: x.permute(*d))(o, 0, 2, 1, 3).reshape(B, S, D) @ wo

    def _B_ref(x, w1, b1, w2, b2):
        y = _layernorm(x, axis=-1)
        h = _gelu(torch.einsum("bsd,df->bsf", y, w1) + b1)
        return torch.einsum("bsf,fd->bsd", h, w2) + b2

    x = A_x
    g = _sigmoid((x * gate_w).sum(-1, keepdims=True))
    a = _A_ref(x, A_wqkv, A_wo)
    b = _B_ref(x, B_w1, B_b1, B_w2, B_b2)
    return g * a + (1 - g) * b
```

```asm
; @launch grid=(256,1,1) block=(512,1,1) lds=163840
.amdgcn_target "amdgcn-amd-amdhsa--gfx950"

.text
.globl gated_mix__linear_attn_block__mixer_channel_mlp__prompt_kernel
.p2align 8
.type gated_mix__linear_attn_block__mixer_channel_mlp__prompt_kernel,@function
gated_mix__linear_attn_block__mixer_channel_mlp__prompt_kernel:
  s_cmp_ge_u32 s2, 256
  s_cbranch_scc1 L_k1_end
  s_load_dwordx16 s[64:79], s[0:1], 0
  s_load_dwordx8 s[80:87], s[0:1], 64
  s_getpc_b64 s[58:59]
  s_lshr_b32 s3, s2, 3
  s_lshl_b32 s3, s3, 11
  v_lshrrev_b32 v1, 5, v0
  v_lshlrev_b32 v1, 7, v1
  v_add_u32 v1, s3, v1
  global_load_dword v247, v1, s[58:59]
  v_and_b32 v255, 63, v0
  v_lshrrev_b32 v1, 6, v0
  v_lshrrev_b32 v3, 2, v255
  v_readfirstlane_b32 s28, v1
  v_mul_u32_u24 v3, 1152, v3
  v_and_b32 v2, 3, v255
  v_lshl_add_u32 v3, v2, 4, v3
  s_and_b32 s3, s2, 7
  s_lshr_b32 s4, s2, 3
  s_and_b32 s47, s4, 7
  s_lshr_b32 s5, s3, 2
  s_lshl_b32 s5, s5, 3
  s_add_u32 s29, s47, s5
  s_lshr_b32 s4, s4, 3
  s_and_b32 s97, s4, 1
  s_lshl_b32 s97, s97, 2
  s_xor_b32 s97, s97, s28
  s_lshl_b32 s34, s29, 3
  s_add_u32 s34, s34, s97
  s_mul_i32 s34, s34, 18432
  s_mov_b32 s10, 2359296
  s_mov_b32 s11, 0x20000
  s_waitcnt lgkmcnt(0)
  s_mov_b32 s8, s64
  s_and_b32 s9, s65, 0xffff
  s_cmp_lt_u32 s4, 1
  s_cbranch_scc1 L_atthead
  buffer_load_dwordx4 v[172:175], v3, s[8:11], s34 offen offset:0
  buffer_load_dwordx4 v[176:179], v3, s[8:11], s34 offen offset:64
  buffer_load_dwordx4 v[180:183], v3, s[8:11], s34 offen offset:128
  buffer_load_dwordx4 v[184:187], v3, s[8:11], s34 offen offset:192
  buffer_load_dwordx4 v[188:191], v3, s[8:11], s34 offen offset:256
  buffer_load_dwordx4 v[192:195], v3, s[8:11], s34 offen offset:320
  buffer_load_dwordx4 v[196:199], v3, s[8:11], s34 offen offset:384
  buffer_load_dwordx4 v[200:203], v3, s[8:11], s34 offen offset:448
  buffer_load_dwordx4 v[204:207], v3, s[8:11], s34 offen offset:512
  buffer_load_dwordx4 v[208:211], v3, s[8:11], s34 offen offset:576
  buffer_load_dwordx4 v[212:215], v3, s[8:11], s34 offen offset:640
  buffer_load_dwordx4 v[216:219], v3, s[8:11], s34 offen offset:704
  buffer_load_dwordx4 v[220:223], v3, s[8:11], s34 offen offset:768
  buffer_load_dwordx4 v[224:227], v3, s[8:11], s34 offen offset:832
  buffer_load_dwordx4 v[228:231], v3, s[8:11], s34 offen offset:896
  buffer_load_dwordx4 v[232:235], v3, s[8:11], s34 offen offset:960
  buffer_load_dwordx4 v[236:239], v3, s[8:11], s34 offen offset:1024
  buffer_load_dwordx4 v[240:243], v3, s[8:11], s34 offen offset:1088
  s_and_b32 s3, s3, 3
  s_mul_i32 s30, s3, 3
  s_add_u32 s30, s30, s4
  s_sub_u32 s30, s30, 1
  s_branch L_common
L_atthead:
  v_lshrrev_b32 v249, 3, v255
  v_lshrrev_b32 v250, 1, v249
  v_and_b32 v244, 7, v255
  v_xor_b32 v250, v244, v250
  v_mul_u32_u24 v244, 1152, v249
  v_lshl_add_u32 v244, v250, 4, v244
  v_xor_b32 v250, 4, v250
  v_add_u32 v249, 8, v249
  v_mul_u32_u24 v245, 1152, v249
  v_lshl_add_u32 v245, v250, 4, v245
  s_mul_i32 s35, s97, 18432
  s_add_u32 m0, s35, 0
  s_add_u32 s37, s34, 0
  buffer_load_dwordx4 v244, s[8:11], s37 offen lds
  s_add_u32 m0, s35, 1024
  s_add_u32 s37, s34, 0
  buffer_load_dwordx4 v245, s[8:11], s37 offen lds
  s_add_u32 m0, s35, 2048
  s_add_u32 s37, s34, 128
  buffer_load_dwordx4 v244, s[8:11], s37 offen lds
  s_add_u32 m0, s35, 3072
  s_add_u32 s37, s34, 128
  buffer_load_dwordx4 v245, s[8:11], s37 offen lds
  s_add_u32 m0, s35, 4096
  s_add_u32 s37, s34, 256
  buffer_load_dwordx4 v244, s[8:11], s37 offen lds
  s_add_u32 m0, s35, 5120
  s_add_u32 s37, s34, 256
  buffer_load_dwordx4 v245, s[8:11], s37 offen lds
  s_add_u32 m0, s35, 6144
  s_add_u32 s37, s34, 384
  buffer_load_dwordx4 v244, s[8:11], s37 offen lds
  s_add_u32 m0, s35, 7168
  s_add_u32 s37, s34, 384
  buffer_load_dwordx4 v245, s[8:11], s37 offen lds
  s_add_u32 m0, s35, 8192
  s_add_u32 s37, s34, 512
  buffer_load_dwordx4 v244, s[8:11], s37 offen lds
  s_add_u32 m0, s35, 9216
  s_add_u32 s37, s34, 512
  buffer_load_dwordx4 v245, s[8:11], s37 offen lds
  s_add_u32 m0, s35, 10240
  s_add_u32 s37, s34, 640
  buffer_load_dwordx4 v244, s[8:11], s37 offen lds
  s_add_u32 m0, s35, 11264
  s_add_u32 s37, s34, 640
  buffer_load_dwordx4 v245, s[8:11], s37 offen lds
  s_add_u32 m0, s35, 12288
  s_add_u32 s37, s34, 768
  buffer_load_dwordx4 v244, s[8:11], s37 offen lds
  s_add_u32 m0, s35, 13312
  s_add_u32 s37, s34, 768
  buffer_load_dwordx4 v245, s[8:11], s37 offen lds
  s_add_u32 m0, s35, 14336
  s_add_u32 s37, s34, 896
  buffer_load_dwordx4 v244, s[8:11], s37 offen lds
  s_add_u32 m0, s35, 15360
  s_add_u32 s37, s34, 896
  buffer_load_dwordx4 v245, s[8:11], s37 offen lds
  s_add_u32 m0, s35, 16384
  s_add_u32 s37, s34, 1024
  buffer_load_dwordx4 v244, s[8:11], s37 offen lds
  s_add_u32 m0, s35, 17408
  s_add_u32 s37, s34, 1024
  buffer_load_dwordx4 v245, s[8:11], s37 offen lds
  s_and_b32 s3, s3, 3
  s_mul_i32 s30, s3, 1
  s_add_u32 s30, s30, s4
L_common:
  s_mov_b32 s96, s4
  s_and_b32 s31, s28, 3
  s_lshr_b32 s32, s28, 2
  s_cmp_eq_u32 s32, 1
  s_cbranch_scc0 L_noprio
  s_setprio 1
L_noprio:
  s_cmp_lt_u32 s4, 1
  s_cbranch_scc1 L_att
  s_mov_b32 s20, s86
  s_and_b32 s21, s87, 0xffff
  s_mov_b32 s22, 268435456
  s_mov_b32 s23, 0x20000
  s_mov_b32 s48, s84
  s_and_b32 s49, s85, 0xffff
  s_mov_b32 s50, 256
  s_mov_b32 s51, 0x20000
  s_mov_b32 s88, s78
  s_mov_b32 s89, s79
  s_mov_b32 s90, s82
  s_mov_b32 s91, s83
  s_mov_b32 s12, s72
  s_and_b32 s13, s73, 0xffff
  s_mov_b32 s14, 5308416
  s_mov_b32 s15, 0x20000
  s_mov_b32 s16, s76
  s_and_b32 s17, s77, 0xffff
  s_mov_b32 s18, 5308416
  s_mov_b32 s19, 0x20000
  s_mov_b32 s24, s74
  s_and_b32 s25, s75, 0xffff
  s_mov_b32 s26, 9216
  s_mov_b32 s27, 0x20000
  s_mov_b32 s44, 0xbdd2d3e8
  v_mov_b32 v253, 0xc0135761
  s_mul_i32 s39, s30, 768
  v_lshlrev_b32 v254, 2, v0
  buffer_load_dword v144, v254, s[24:27], s39 offen
  v_lshrrev_b32 v249, 3, v255
  v_lshrrev_b32 v250, 2, v249
  v_lshlrev_b32 v250, 3, v250
  v_and_b32 v248, 3, v249
  v_add_u32 v248, v248, v250
  s_mov_b32 s33, 9216
  v_mul_lo_u32 v248, v248, s33
  v_lshrrev_b32 v249, 1, v249
  v_lshlrev_b32 v249, 1, v249
  v_and_b32 v250, 7, v255
  v_xor_b32 v250, v250, v249
  v_lshlrev_b32 v250, 4, v250
  v_add_u32 v248, v248, v250
  s_lshr_b32 s33, s28, 2
  s_lshl_b32 s33, s33, 5
  s_and_b32 s34, s28, 1
  s_lshl_b32 s34, s34, 4
  s_add_u32 s33, s33, s34
  s_and_b32 s34, s28, 2
  s_lshl_b32 s34, s34, 1
  s_add_u32 s33, s33, s34
  s_mul_i32 s33, s33, 9216
  v_add_u32 v248, s33, v248
  s_lshl_b32 s38, s28, 10
  s_add_u32 m0, s38, 73728
  s_add_u32 s37, s39, 0
  buffer_load_dwordx4 v248, s[12:15], s37 offen lds
  s_add_u32 m0, s38, 81920
  s_add_u32 s37, s39, 589824
  buffer_load_dwordx4 v248, s[12:15], s37 offen lds
  s_add_u32 m0, s38, 90112
  s_add_u32 s37, s39, 1179648
  buffer_load_dwordx4 v248, s[12:15], s37 offen lds
  s_add_u32 m0, s38, 98304
  s_add_u32 s37, s39, 1769472
  buffer_load_dwordx4 v248, s[12:15], s37 offen lds
  s_add_u32 m0, s38, 106496
  s_add_u32 s37, s39, 2359296
  buffer_load_dwordx4 v248, s[12:15], s37 offen lds
  s_add_u32 m0, s38, 114688
  s_add_u32 s37, s39, 2949120
  buffer_load_dwordx4 v248, s[12:15], s37 offen lds
  s_add_u32 m0, s38, 122880
  s_add_u32 s37, s39, 3538944
  buffer_load_dwordx4 v248, s[12:15], s37 offen lds
  s_add_u32 m0, s38, 131072
  s_add_u32 s37, s39, 4128768
  buffer_load_dwordx4 v248, s[12:15], s37 offen lds
  s_add_u32 m0, s38, 139264
  s_add_u32 s37, s39, 4718592
  buffer_load_dwordx4 v248, s[12:15], s37 offen lds
  s_mul_i32 s33, s28, 9
  s_add_u32 s33, s33, 0
  v_add_u32 v145, s33, v255
  v_min_u32 v145, 71, v145
  s_mul_i32 s34, s47, 72
  v_add_u32 v145, s34, v145
  s_mov_b32 s34, 9216
  v_mul_lo_u32 v145, v145, s34
  v_add_u32 v145, 128, v145
  s_mov_b32 m0, 155648
  s_mov_b32 s37, s39
  buffer_load_dword v145, s[12:15], s37 offen lds
  v_lshrrev_b32 v2, 2, v255
  v_and_b32 v3, 3, v255
  v_lshlrev_b32 v4, 1, v3
  v_xor_b32 v2, v2, v4
  v_lshlrev_b32 v3, 4, v3
  v_add_u32 v2, v2, v3
  v_lshlrev_b32 v2, 4, v2
  s_mul_i32 s33, s97, 9216
  v_add_u32 v244, s33, v2
  v_and_b32 v2, 15, v255
  v_lshrrev_b32 v3, 4, v255
  v_lshlrev_b32 v4, 1, v3
  v_xor_b32 v2, v2, v4
  v_lshlrev_b32 v3, 4, v3
  v_add_u32 v2, v2, v3
  v_lshlrev_b32 v2, 4, v2
  s_mul_i32 s33, s31, 18432
  v_add_u32 v245, s33, v2
  v_mov_b32 v148, 0
  v_mov_b32 v149, 0
  v_mov_b32 v150, 0
  v_mov_b32 v151, 0
  v_mov_b32 v152, 0
  v_mov_b32 v153, 0
  v_mov_b32 v154, 0
  v_mov_b32 v155, 0
  v_mov_b32 v156, 0
  v_mov_b32 v157, 0
  v_mov_b32 v158, 0
  v_mov_b32 v159, 0
  v_mov_b32 v160, 0
  v_mov_b32 v161, 0
  v_mov_b32 v162, 0
  v_mov_b32 v163, 0
  s_waitcnt vmcnt(28)
  v_lshlrev_b32 v0, 16, v172
  v_and_b32 v1, 0xffff0000, v172
  v_lshlrev_b32 v2, 16, v173
  v_and_b32 v3, 0xffff0000, v173
  v_lshlrev_b32 v4, 16, v174
  v_and_b32 v5, 0xffff0000, v174
  v_lshlrev_b32 v6, 16, v175
  v_and_b32 v7, 0xffff0000, v175
  v_pk_add_f32 v[148:149], v[148:149], v[0:1]
  v_pk_fma_f32 v[156:157], v[0:1], v[0:1], v[156:157]
  v_pk_add_f32 v[150:151], v[150:151], v[2:3]
  v_pk_fma_f32 v[158:159], v[2:3], v[2:3], v[158:159]
  v_pk_add_f32 v[152:153], v[152:153], v[4:5]
  v_pk_fma_f32 v[160:161], v[4:5], v[4:5], v[160:161]
  v_pk_add_f32 v[154:155], v[154:155], v[6:7]
  v_pk_fma_f32 v[162:163], v[6:7], v[6:7], v[162:163]
  s_waitcnt vmcnt(27)
  v_lshlrev_b32 v8, 16, v176
  v_and_b32 v9, 0xffff0000, v176
  v_lshlrev_b32 v10, 16, v177
  v_and_b32 v11, 0xffff0000, v177
  v_lshlrev_b32 v12, 16, v178
  v_and_b32 v13, 0xffff0000, v178
  v_lshlrev_b32 v14, 16, v179
  v_and_b32 v15, 0xffff0000, v179
  v_pk_add_f32 v[148:149], v[148:149], v[8:9]
  v_pk_fma_f32 v[156:157], v[8:9], v[8:9], v[156:157]
  v_pk_add_f32 v[150:151], v[150:151], v[10:11]
  v_pk_fma_f32 v[158:159], v[10:11], v[10:11], v[158:159]
  v_pk_add_f32 v[152:153], v[152:153], v[12:13]
  v_pk_fma_f32 v[160:161], v[12:13], v[12:13], v[160:161]
  v_pk_add_f32 v[154:155], v[154:155], v[14:15]
  v_pk_fma_f32 v[162:163], v[14:15], v[14:15], v[162:163]
  s_waitcnt vmcnt(26)
  v_lshlrev_b32 v16, 16, v180
  v_and_b32 v17, 0xffff0000, v180
  v_lshlrev_b32 v18, 16, v181
  v_and_b32 v19, 0xffff0000, v181
  v_lshlrev_b32 v20, 16, v182
  v_and_b32 v21, 0xffff0000, v182
  v_lshlrev_b32 v22, 16, v183
  v_and_b32 v23, 0xffff0000, v183
  v_pk_add_f32 v[148:149], v[148:149], v[16:17]
  v_pk_fma_f32 v[156:157], v[16:17], v[16:17], v[156:157]
  v_pk_add_f32 v[150:151], v[150:151], v[18:19]
  v_pk_fma_f32 v[158:159], v[18:19], v[18:19], v[158:159]
  v_pk_add_f32 v[152:153], v[152:153], v[20:21]
  v_pk_fma_f32 v[160:161], v[20:21], v[20:21], v[160:161]
  v_pk_add_f32 v[154:155], v[154:155], v[22:23]
  v_pk_fma_f32 v[162:163], v[22:23], v[22:23], v[162:163]
  s_waitcnt vmcnt(25)
  v_lshlrev_b32 v24, 16, v184
  v_and_b32 v25, 0xffff0000, v184
  v_lshlrev_b32 v26, 16, v185
  v_and_b32 v27, 0xffff0000, v185
  v_lshlrev_b32 v28, 16, v186
  v_and_b32 v29, 0xffff0000, v186
  v_lshlrev_b32 v30, 16, v187
  v_and_b32 v31, 0xffff0000, v187
  v_pk_add_f32 v[148:149], v[148:149], v[24:25]
  v_pk_fma_f32 v[156:157], v[24:25], v[24:25], v[156:157]
  v_pk_add_f32 v[150:151], v[150:151], v[26:27]
  v_pk_fma_f32 v[158:159], v[26:27], v[26:27], v[158:159]
  v_pk_add_f32 v[152:153], v[152:153], v[28:29]
  v_pk_fma_f32 v[160:161], v[28:29], v[28:29], v[160:161]
  v_pk_add_f32 v[154:155], v[154:155], v[30:31]
  v_pk_fma_f32 v[162:163], v[30:31], v[30:31], v[162:163]
  s_waitcnt vmcnt(24)
  v_lshlrev_b32 v32, 16, v188
  v_and_b32 v33, 0xffff0000, v188
  v_lshlrev_b32 v34, 16, v189
  v_and_b32 v35, 0xffff0000, v189
  v_lshlrev_b32 v36, 16, v190
  v_and_b32 v37, 0xffff0000, v190
  v_lshlrev_b32 v38, 16, v191
  v_and_b32 v39, 0xffff0000, v191
  v_pk_add_f32 v[148:149], v[148:149], v[32:33]
  v_pk_fma_f32 v[156:157], v[32:33], v[32:33], v[156:157]
  v_pk_add_f32 v[150:151], v[150:151], v[34:35]
  v_pk_fma_f32 v[158:159], v[34:35], v[34:35], v[158:159]
  v_pk_add_f32 v[152:153], v[152:153], v[36:37]
  v_pk_fma_f32 v[160:161], v[36:37], v[36:37], v[160:161]
  v_pk_add_f32 v[154:155], v[154:155], v[38:39]
  v_pk_fma_f32 v[162:163], v[38:39], v[38:39], v[162:163]
  s_waitcnt vmcnt(23)
  v_lshlrev_b32 v40, 16, v192
  v_and_b32 v41, 0xffff0000, v192
  v_lshlrev_b32 v42, 16, v193
  v_and_b32 v43, 0xffff0000, v193
  v_lshlrev_b32 v44, 16, v194
  v_and_b32 v45, 0xffff0000, v194
  v_lshlrev_b32 v46, 16, v195
  v_and_b32 v47, 0xffff0000, v195
  v_pk_add_f32 v[148:149], v[148:149], v[40:41]
  v_pk_fma_f32 v[156:157], v[40:41], v[40:41], v[156:157]
  v_pk_add_f32 v[150:151], v[150:151], v[42:43]
  v_pk_fma_f32 v[158:159], v[42:43], v[42:43], v[158:159]
  v_pk_add_f32 v[152:153], v[152:153], v[44:45]
  v_pk_fma_f32 v[160:161], v[44:45], v[44:45], v[160:161]
  v_pk_add_f32 v[154:155], v[154:155], v[46:47]
  v_pk_fma_f32 v[162:163], v[46:47], v[46:47], v[162:163]
  s_waitcnt vmcnt(22)
  v_lshlrev_b32 v48, 16, v196
  v_and_b32 v49, 0xffff0000, v196
  v_lshlrev_b32 v50, 16, v197
  v_and_b32 v51, 0xffff0000, v197
  v_lshlrev_b32 v52, 16, v198
  v_and_b32 v53, 0xffff0000, v198
  v_lshlrev_b32 v54, 16, v199
  v_and_b32 v55, 0xffff0000, v199
  v_pk_add_f32 v[148:149], v[148:149], v[48:49]
  v_pk_fma_f32 v[156:157], v[48:49], v[48:49], v[156:157]
  v_pk_add_f32 v[150:151], v[150:151], v[50:51]
  v_pk_fma_f32 v[158:159], v[50:51], v[50:51], v[158:159]
  v_pk_add_f32 v[152:153], v[152:153], v[52:53]
  v_pk_fma_f32 v[160:161], v[52:53], v[52:53], v[160:161]
  v_pk_add_f32 v[154:155], v[154:155], v[54:55]
  v_pk_fma_f32 v[162:163], v[54:55], v[54:55], v[162:163]
  s_waitcnt vmcnt(21)
  v_lshlrev_b32 v56, 16, v200
  v_and_b32 v57, 0xffff0000, v200
  v_lshlrev_b32 v58, 16, v201
  v_and_b32 v59, 0xffff0000, v201
  v_lshlrev_b32 v60, 16, v202
  v_and_b32 v61, 0xffff0000, v202
  v_lshlrev_b32 v62, 16, v203
  v_and_b32 v63, 0xffff0000, v203
  v_pk_add_f32 v[148:149], v[148:149], v[56:57]
  v_pk_fma_f32 v[156:157], v[56:57], v[56:57], v[156:157]
  v_pk_add_f32 v[150:151], v[150:151], v[58:59]
  v_pk_fma_f32 v[158:159], v[58:59], v[58:59], v[158:159]
  v_pk_add_f32 v[152:153], v[152:153], v[60:61]
  v_pk_fma_f32 v[160:161], v[60:61], v[60:61], v[160:161]
  v_pk_add_f32 v[154:155], v[154:155], v[62:63]
  v_pk_fma_f32 v[162:163], v[62:63], v[62:63], v[162:163]
  s_waitcnt vmcnt(20)
  v_lshlrev_b32 v64, 16, v204
  v_and_b32 v65, 0xffff0000, v204
  v_lshlrev_b32 v66, 16, v205
  v_and_b32 v67, 0xffff0000, v205
  v_lshlrev_b32 v68, 16, v206
  v_and_b32 v69, 0xffff0000, v206
  v_lshlrev_b32 v70, 16, v207
  v_and_b32 v71, 0xffff0000, v207
  v_pk_add_f32 v[148:149], v[148:149], v[64:65]
  v_pk_fma_f32 v[156:157], v[64:65], v[64:65], v[156:157]
  v_pk_add_f32 v[150:151], v[150:151], v[66:67]
  v_pk_fma_f32 v[158:159], v[66:67], v[66:67], v[158:159]
  v_pk_add_f32 v[152:153], v[152:153], v[68:69]
  v_pk_fma_f32 v[160:161], v[68:69], v[68:69], v[160:161]
  v_pk_add_f32 v[154:155], v[154:155], v[70:71]
  v_pk_fma_f32 v[162:163], v[70:71], v[70:71], v[162:163]
  s_waitcnt vmcnt(19)
  v_lshlrev_b32 v72, 16, v208
  v_and_b32 v73, 0xffff0000, v208
  v_lshlrev_b32 v74, 16, v209
  v_and_b32 v75, 0xffff0000, v209
  v_lshlrev_b32 v76, 16, v210
  v_and_b32 v77, 0xffff0000, v210
  v_lshlrev_b32 v78, 16, v211
  v_and_b32 v79, 0xffff0000, v211
  v_pk_add_f32 v[148:149], v[148:149], v[72:73]
  v_pk_fma_f32 v[156:157], v[72:73], v[72:73], v[156:157]
  v_pk_add_f32 v[150:151], v[150:151], v[74:75]
  v_pk_fma_f32 v[158:159], v[74:75], v[74:75], v[158:159]
  v_pk_add_f32 v[152:153], v[152:153], v[76:77]
  v_pk_fma_f32 v[160:161], v[76:77], v[76:77], v[160:161]
  v_pk_add_f32 v[154:155], v[154:155], v[78:79]
  v_pk_fma_f32 v[162:163], v[78:79], v[78:79], v[162:163]
  s_waitcnt vmcnt(18)
  v_lshlrev_b32 v80, 16, v212
  v_and_b32 v81, 0xffff0000, v212
  v_lshlrev_b32 v82, 16, v213
  v_and_b32 v83, 0xffff0000, v213
  v_lshlrev_b32 v84, 16, v214
  v_and_b32 v85, 0xffff0000, v214
  v_lshlrev_b32 v86, 16, v215
  v_and_b32 v87, 0xffff0000, v215
  v_pk_add_f32 v[148:149], v[148:149], v[80:81]
  v_pk_fma_f32 v[156:157], v[80:81], v[80:81], v[156:157]
  v_pk_add_f32 v[150:151], v[150:151], v[82:83]
  v_pk_fma_f32 v[158:159], v[82:83], v[82:83], v[158:159]
  v_pk_add_f32 v[152:153], v[152:153], v[84:85]
  v_pk_fma_f32 v[160:161], v[84:85], v[84:85], v[160:161]
  v_pk_add_f32 v[154:155], v[154:155], v[86:87]
  v_pk_fma_f32 v[162:163], v[86:87], v[86:87], v[162:163]
  s_waitcnt vmcnt(17)
  v_lshlrev_b32 v88, 16, v216
  v_and_b32 v89, 0xffff0000, v216
  v_lshlrev_b32 v90, 16, v217
  v_and_b32 v91, 0xffff0000, v217
  v_lshlrev_b32 v92, 16, v218
  v_and_b32 v93, 0xffff0000, v218
  v_lshlrev_b32 v94, 16, v219
  v_and_b32 v95, 0xffff0000, v219
  v_pk_add_f32 v[148:149], v[148:149], v[88:89]
  v_pk_fma_f32 v[156:157], v[88:89], v[88:89], v[156:157]
  v_pk_add_f32 v[150:151], v[150:151], v[90:91]
  v_pk_fma_f32 v[158:159], v[90:91], v[90:91], v[158:159]
  v_pk_add_f32 v[152:153], v[152:153], v[92:93]
  v_pk_fma_f32 v[160:161], v[92:93], v[92:93], v[160:161]
  v_pk_add_f32 v[154:155], v[154:155], v[94:95]
  v_pk_fma_f32 v[162:163], v[94:95], v[94:95], v[162:163]
  s_waitcnt vmcnt(16)
  v_lshlrev_b32 v96, 16, v220
  v_and_b32 v97, 0xffff0000, v220
  v_lshlrev_b32 v98, 16, v221
  v_and_b32 v99, 0xffff0000, v221
  v_lshlrev_b32 v100, 16, v222
  v_and_b32 v101, 0xffff0000, v222
  v_lshlrev_b32 v102, 16, v223
  v_and_b32 v103, 0xffff0000, v223
  v_pk_add_f32 v[148:149], v[148:149], v[96:97]
  v_pk_fma_f32 v[156:157], v[96:97], v[96:97], v[156:157]
  v_pk_add_f32 v[150:151], v[150:151], v[98:99]
  v_pk_fma_f32 v[158:159], v[98:99], v[98:99], v[158:159]
  v_pk_add_f32 v[152:153], v[152:153], v[100:101]
  v_pk_fma_f32 v[160:161], v[100:101], v[100:101], v[160:161]
  v_pk_add_f32 v[154:155], v[154:155], v[102:103]
  v_pk_fma_f32 v[162:163], v[102:103], v[102:103], v[162:163]
  s_waitcnt vmcnt(15)
  v_lshlrev_b32 v104, 16, v224
  v_and_b32 v105, 0xffff0000, v224
  v_lshlrev_b32 v106, 16, v225
  v_and_b32 v107, 0xffff0000, v225
  v_lshlrev_b32 v108, 16, v226
  v_and_b32 v109, 0xffff0000, v226
  v_lshlrev_b32 v110, 16, v227
  v_and_b32 v111, 0xffff0000, v227
  v_pk_add_f32 v[148:149], v[148:149], v[104:105]
  v_pk_fma_f32 v[156:157], v[104:105], v[104:105], v[156:157]
  v_pk_add_f32 v[150:151], v[150:151], v[106:107]
  v_pk_fma_f32 v[158:159], v[106:107], v[106:107], v[158:159]
  v_pk_add_f32 v[152:153], v[152:153], v[108:109]
  v_pk_fma_f32 v[160:161], v[108:109], v[108:109], v[160:161]
  v_pk_add_f32 v[154:155], v[154:155], v[110:111]
  v_pk_fma_f32 v[162:163], v[110:111], v[110:111], v[162:163]
  s_waitcnt vmcnt(14)
  v_lshlrev_b32 v112, 16, v228
  v_and_b32 v113, 0xffff0000, v228
  v_lshlrev_b32 v114, 16, v229
  v_and_b32 v115, 0xffff0000, v229
  v_lshlrev_b32 v116, 16, v230
  v_and_b32 v117, 0xffff0000, v230
  v_lshlrev_b32 v118, 16, v231
  v_and_b32 v119, 0xffff0000, v231
  v_pk_add_f32 v[148:149], v[148:149], v[112:113]
  v_pk_fma_f32 v[156:157], v[112:113], v[112:113], v[156:157]
  v_pk_add_f32 v[150:151], v[150:151], v[114:115]
  v_pk_fma_f32 v[158:159], v[114:115], v[114:115], v[158:159]
  v_pk_add_f32 v[152:153], v[152:153], v[116:117]
  v_pk_fma_f32 v[160:161], v[116:117], v[116:117], v[160:161]
  v_pk_add_f32 v[154:155], v[154:155], v[118:119]
  v_pk_fma_f32 v[162:163], v[118:119], v[118:119], v[162:163]
  s_waitcnt vmcnt(13)
  v_lshlrev_b32 v120, 16, v232
  v_and_b32 v121, 0xffff0000, v232
  v_lshlrev_b32 v122, 16, v233
  v_and_b32 v123, 0xffff0000, v233
  v_lshlrev_b32 v124, 16, v234
  v_and_b32 v125, 0xffff0000, v234
  v_lshlrev_b32 v126, 16, v235
  v_and_b32 v127, 0xffff0000, v235
  v_pk_add_f32 v[148:149], v[148:149], v[120:121]
  v_pk_fma_f32 v[156:157], v[120:121], v[120:121], v[156:157]
  v_pk_add_f32 v[150:151], v[150:151], v[122:123]
  v_pk_fma_f32 v[158:159], v[122:123], v[122:123], v[158:159]
  v_pk_add_f32 v[152:153], v[152:153], v[124:125]
  v_pk_fma_f32 v[160:161], v[124:125], v[124:125], v[160:161]
  v_pk_add_f32 v[154:155], v[154:155], v[126:127]
  v_pk_fma_f32 v[162:163], v[126:127], v[126:127], v[162:163]
  s_waitcnt vmcnt(12)
  v_lshlrev_b32 v128, 16, v236
  v_and_b32 v129, 0xffff0000, v236
  v_lshlrev_b32 v130, 16, v237
  v_and_b32 v131, 0xffff0000, v237
  v_lshlrev_b32 v132, 16, v238
  v_and_b32 v133, 0xffff0000, v238
  v_lshlrev_b32 v134, 16, v239
  v_and_b32 v135, 0xffff0000, v239
  v_pk_add_f32 v[148:149], v[148:149], v[128:129]
  v_pk_fma_f32 v[156:157], v[128:129], v[128:129], v[156:157]
  v_pk_add_f32 v[150:151], v[150:151], v[130:131]
  v_pk_fma_f32 v[158:159], v[130:131], v[130:131], v[158:159]
  v_pk_add_f32 v[152:153], v[152:153], v[132:133]
  v_pk_fma_f32 v[160:161], v[132:133], v[132:133], v[160:161]
  v_pk_add_f32 v[154:155], v[154:155], v[134:135]
  v_pk_fma_f32 v[162:163], v[134:135], v[134:135], v[162:163]
  s_waitcnt vmcnt(11)
  v_lshlrev_b32 v136, 16, v240
  v_and_b32 v137, 0xffff0000, v240
  v_lshlrev_b32 v138, 16, v241
  v_and_b32 v139, 0xffff0000, v241
  v_lshlrev_b32 v140, 16, v242
  v_and_b32 v141, 0xffff0000, v242
  v_lshlrev_b32 v142, 16, v243
  v_and_b32 v143, 0xffff0000, v243
  v_pk_add_f32 v[148:149], v[148:149], v[136:137]
  v_pk_fma_f32 v[156:157], v[136:137], v[136:137], v[156:157]
  v_pk_add_f32 v[150:151], v[150:151], v[138:139]
  v_pk_fma_f32 v[158:159], v[138:139], v[138:139], v[158:159]
  v_pk_add_f32 v[152:153], v[152:153], v[140:141]
  v_pk_fma_f32 v[160:161], v[140:141], v[140:141], v[160:161]
  v_pk_add_f32 v[154:155], v[154:155], v[142:143]
  v_pk_fma_f32 v[162:163], v[142:143], v[142:143], v[162:163]
  v_pk_add_f32 v[148:149], v[148:149], v[150:151]
  v_pk_add_f32 v[152:153], v[152:153], v[154:155]
  v_pk_add_f32 v[156:157], v[156:157], v[158:159]
  v_pk_add_f32 v[160:161], v[160:161], v[162:163]
  v_pk_add_f32 v[148:149], v[148:149], v[152:153]
  v_pk_add_f32 v[156:157], v[156:157], v[160:161]
  v_add_f32 v249, v148, v149
  v_add_f32 v250, v156, v157
  s_nop 1
  v_add_f32_dpp v249, v249, v249 quad_perm:[1,0,3,2] row_mask:0xf bank_mask:0xf
  v_add_f32_dpp v250, v250, v250 quad_perm:[1,0,3,2] row_mask:0xf bank_mask:0xf
  s_nop 1
  v_add_f32_dpp v249, v249, v249 quad_perm:[2,3,0,1] row_mask:0xf bank_mask:0xf
  v_add_f32_dpp v250, v250, v250 quad_perm:[2,3,0,1] row_mask:0xf bank_mask:0xf
  v_mul_f32 v249, 0x3ae38e39, v249
  v_mul_f32 v250, 0x3ae38e39, v250
  v_fma_f32 v250, -v249, v249, v250
  v_max_f32 v250, 0, v250
  v_add_f32 v250, 0x3727c5ac, v250
  v_rsq_f32 v250, v250
  s_nop 0
  v_mov_b32 v148, v250
  v_mov_b32 v149, v250
  v_mul_f32 v150, v249, v250
  v_sub_f32 v150, 0, v150
  v_mov_b32 v151, v150
  v_pk_fma_f32 v[0:1], v[0:1], v[148:149], v[150:151]
  v_pk_fma_f32 v[2:3], v[2:3], v[148:149], v[150:151]
  v_pk_fma_f32 v[4:5], v[4:5], v[148:149], v[150:151]
  v_pk_fma_f32 v[6:7], v[6:7], v[148:149], v[150:151]
  v_pk_fma_f32 v[8:9], v[8:9], v[148:149], v[150:151]
  v_pk_fma_f32 v[10:11], v[10:11], v[148:149], v[150:151]
  v_pk_fma_f32 v[12:13], v[12:13], v[148:149], v[150:151]
  v_pk_fma_f32 v[14:15], v[14:15], v[148:149], v[150:151]
  v_pk_fma_f32 v[16:17], v[16:17], v[148:149], v[150:151]
  v_pk_fma_f32 v[18:19], v[18:19], v[148:149], v[150:151]
  v_pk_fma_f32 v[20:21], v[20:21], v[148:149], v[150:151]
  v_pk_fma_f32 v[22:23], v[22:23], v[148:149], v[150:151]
  v_pk_fma_f32 v[24:25], v[24:25], v[148:149], v[150:151]
  v_pk_fma_f32 v[26:27], v[26:27], v[148:149], v[150:151]
  v_pk_fma_f32 v[28:29], v[28:29], v[148:149], v[150:151]
  v_pk_fma_f32 v[30:31], v[30:31], v[148:149], v[150:151]
  v_pk_fma_f32 v[32:33], v[32:33], v[148:149], v[150:151]
  v_pk_fma_f32 v[34:35], v[34:35], v[148:149], v[150:151]
  v_pk_fma_f32 v[36:37], v[36:37], v[148:149], v[150:151]
  v_pk_fma_f32 v[38:39], v[38:39], v[148:149], v[150:151]
  v_pk_fma_f32 v[40:41], v[40:41], v[148:149], v[150:151]
  v_pk_fma_f32 v[42:43], v[42:43], v[148:149], v[150:151]
  v_pk_fma_f32 v[44:45], v[44:45], v[148:149], v[150:151]
  v_pk_fma_f32 v[46:47], v[46:47], v[148:149], v[150:151]
  v_pk_fma_f32 v[48:49], v[48:49], v[148:149], v[150:151]
  v_pk_fma_f32 v[50:51], v[50:51], v[148:149], v[150:151]
  v_pk_fma_f32 v[52:53], v[52:53], v[148:149], v[150:151]
  v_pk_fma_f32 v[54:55], v[54:55], v[148:149], v[150:151]
  v_pk_fma_f32 v[56:57], v[56:57], v[148:149], v[150:151]
  v_pk_fma_f32 v[58:59], v[58:59], v[148:149], v[150:151]
  v_pk_fma_f32 v[60:61], v[60:61], v[148:149], v[150:151]
  v_pk_fma_f32 v[62:63], v[62:63], v[148:149], v[150:151]
  v_pk_fma_f32 v[64:65], v[64:65], v[148:149], v[150:151]
  v_pk_fma_f32 v[66:67], v[66:67], v[148:149], v[150:151]
  v_pk_fma_f32 v[68:69], v[68:69], v[148:149], v[150:151]
  v_pk_fma_f32 v[70:71], v[70:71], v[148:149], v[150:151]
  v_pk_fma_f32 v[72:73], v[72:73], v[148:149], v[150:151]
  v_pk_fma_f32 v[74:75], v[74:75], v[148:149], v[150:151]
  v_pk_fma_f32 v[76:77], v[76:77], v[148:149], v[150:151]
  v_pk_fma_f32 v[78:79], v[78:79], v[148:149], v[150:151]
  v_pk_fma_f32 v[80:81], v[80:81], v[148:149], v[150:151]
  v_pk_fma_f32 v[82:83], v[82:83], v[148:149], v[150:151]
  v_pk_fma_f32 v[84:85], v[84:85], v[148:149], v[150:151]
  v_pk_fma_f32 v[86:87], v[86:87], v[148:149], v[150:151]
  v_pk_fma_f32 v[88:89], v[88:89], v[148:149], v[150:151]
  v_pk_fma_f32 v[90:91], v[90:91], v[148:149], v[150:151]
  v_pk_fma_f32 v[92:93], v[92:93], v[148:149], v[150:151]
  v_pk_fma_f32 v[94:95], v[94:95], v[148:149], v[150:151]
  v_pk_fma_f32 v[96:97], v[96:97], v[148:149], v[150:151]
  v_pk_fma_f32 v[98:99], v[98:99], v[148:149], v[150:151]
  v_pk_fma_f32 v[100:101], v[100:101], v[148:149], v[150:151]
  v_pk_fma_f32 v[102:103], v[102:103], v[148:149], v[150:151]
  v_pk_fma_f32 v[104:105], v[104:105], v[148:149], v[150:151]
  v_pk_fma_f32 v[106:107], v[106:107], v[148:149], v[150:151]
  v_pk_fma_f32 v[108:109], v[108:109], v[148:149], v[150:151]
  v_pk_fma_f32 v[110:111], v[110:111], v[148:149], v[150:151]
  v_pk_fma_f32 v[112:113], v[112:113], v[148:149], v[150:151]
  v_pk_fma_f32 v[114:115], v[114:115], v[148:149], v[150:151]
  v_pk_fma_f32 v[116:117], v[116:117], v[148:149], v[150:151]
  v_pk_fma_f32 v[118:119], v[118:119], v[148:149], v[150:151]
  v_pk_fma_f32 v[120:121], v[120:121], v[148:149], v[150:151]
  v_pk_fma_f32 v[122:123], v[122:123], v[148:149], v[150:151]
  v_pk_fma_f32 v[124:125], v[124:125], v[148:149], v[150:151]
  v_pk_fma_f32 v[126:127], v[126:127], v[148:149], v[150:151]
  v_pk_fma_f32 v[128:129], v[128:129], v[148:149], v[150:151]
  v_pk_fma_f32 v[130:131], v[130:131], v[148:149], v[150:151]
  v_pk_fma_f32 v[132:133], v[132:133], v[148:149], v[150:151]
  v_pk_fma_f32 v[134:135], v[134:135], v[148:149], v[150:151]
  v_pk_fma_f32 v[136:137], v[136:137], v[148:149], v[150:151]
  v_pk_fma_f32 v[138:139], v[138:139], v[148:149], v[150:151]
  v_pk_fma_f32 v[140:141], v[140:141], v[148:149], v[150:151]
  v_pk_fma_f32 v[142:143], v[142:143], v[148:149], v[150:151]
  v_cvt_pk_bf16_f32 v172, v0, v1
  v_cvt_pk_bf16_f32 v173, v2, v3
  v_cvt_pk_bf16_f32 v174, v4, v5
  v_cvt_pk_bf16_f32 v175, v6, v7
  v_cvt_pk_bf16_f32 v176, v8, v9
  v_cvt_pk_bf16_f32 v177, v10, v11
  v_cvt_pk_bf16_f32 v178, v12, v13
  v_cvt_pk_bf16_f32 v179, v14, v15
  v_cvt_pk_bf16_f32 v180, v16, v17
  v_cvt_pk_bf16_f32 v181, v18, v19
  v_cvt_pk_bf16_f32 v182, v20, v21
  v_cvt_pk_bf16_f32 v183, v22, v23
  v_cvt_pk_bf16_f32 v184, v24, v25
  v_cvt_pk_bf16_f32 v185, v26, v27
  v_cvt_pk_bf16_f32 v186, v28, v29
  v_cvt_pk_bf16_f32 v187, v30, v31
  v_cvt_pk_bf16_f32 v188, v32, v33
  v_cvt_pk_bf16_f32 v189, v34, v35
  v_cvt_pk_bf16_f32 v190, v36, v37
  v_cvt_pk_bf16_f32 v191, v38, v39
  v_cvt_pk_bf16_f32 v192, v40, v41
  v_cvt_pk_bf16_f32 v193, v42, v43
  v_cvt_pk_bf16_f32 v194, v44, v45
  v_cvt_pk_bf16_f32 v195, v46, v47
  v_cvt_pk_bf16_f32 v196, v48, v49
  v_cvt_pk_bf16_f32 v197, v50, v51
  v_cvt_pk_bf16_f32 v198, v52, v53
  v_cvt_pk_bf16_f32 v199, v54, v55
  v_cvt_pk_bf16_f32 v200, v56, v57
  v_cvt_pk_bf16_f32 v201, v58, v59
  v_cvt_pk_bf16_f32 v202, v60, v61
  v_cvt_pk_bf16_f32 v203, v62, v63
  v_cvt_pk_bf16_f32 v204, v64, v65
  v_cvt_pk_bf16_f32 v205, v66, v67
  v_cvt_pk_bf16_f32 v206, v68, v69
  v_cvt_pk_bf16_f32 v207, v70, v71
  v_cvt_pk_bf16_f32 v208, v72, v73
  v_cvt_pk_bf16_f32 v209, v74, v75
  v_cvt_pk_bf16_f32 v210, v76, v77
  v_cvt_pk_bf16_f32 v211, v78, v79
  v_cvt_pk_bf16_f32 v212, v80, v81
  v_cvt_pk_bf16_f32 v213, v82, v83
  v_cvt_pk_bf16_f32 v214, v84, v85
  v_cvt_pk_bf16_f32 v215, v86, v87
  v_cvt_pk_bf16_f32 v216, v88, v89
  v_cvt_pk_bf16_f32 v217, v90, v91
  v_cvt_pk_bf16_f32 v218, v92, v93
  v_cvt_pk_bf16_f32 v219, v94, v95
  v_cvt_pk_bf16_f32 v220, v96, v97
  v_cvt_pk_bf16_f32 v221, v98, v99
  v_cvt_pk_bf16_f32 v222, v100, v101
  v_cvt_pk_bf16_f32 v223, v102, v103
  v_cvt_pk_bf16_f32 v224, v104, v105
  v_cvt_pk_bf16_f32 v225, v106, v107
  v_cvt_pk_bf16_f32 v226, v108, v109
  v_cvt_pk_bf16_f32 v227, v110, v111
  v_cvt_pk_bf16_f32 v228, v112, v113
  v_cvt_pk_bf16_f32 v229, v114, v115
  v_cvt_pk_bf16_f32 v230, v116, v117
  v_cvt_pk_bf16_f32 v231, v118, v119
  v_cvt_pk_bf16_f32 v232, v120, v121
  v_cvt_pk_bf16_f32 v233, v122, v123
  v_cvt_pk_bf16_f32 v234, v124, v125
  v_cvt_pk_bf16_f32 v235, v126, v127
  v_cvt_pk_bf16_f32 v236, v128, v129
  v_cvt_pk_bf16_f32 v237, v130, v131
  v_cvt_pk_bf16_f32 v238, v132, v133
  v_cvt_pk_bf16_f32 v239, v134, v135
  v_cvt_pk_bf16_f32 v240, v136, v137
  v_cvt_pk_bf16_f32 v241, v138, v139
  v_cvt_pk_bf16_f32 v242, v140, v141
  v_cvt_pk_bf16_f32 v243, v142, v143
  s_waitcnt vmcnt(10)
  v_lshlrev_b32 v146, 16, v144
  v_and_b32 v147, 0xffff0000, v144
  v_lshlrev_b32 v148, 1, v254
  v_add_u32 v148, 147456, v148
  ds_write_b64 v148, v[146:147]
  ds_write_b128 v244, v[172:175] offset:0
  ds_write_b128 v244, v[176:179] offset:1024
  ds_write_b128 v244, v[180:183] offset:2048
  ds_write_b128 v244, v[184:187] offset:3072
  ds_write_b128 v244, v[188:191] offset:4096
  ds_write_b128 v244, v[192:195] offset:5120
  ds_write_b128 v244, v[196:199] offset:6144
  ds_write_b128 v244, v[200:203] offset:7168
  ds_write_b128 v244, v[204:207] offset:8192
  s_waitcnt lgkmcnt(0)
  s_barrier
  ds_read_b128 v[0:3], v245 offset:0
  ds_read_b128 v[4:7], v245 offset:1024
  ds_read_b128 v[8:11], v245 offset:2048
  ds_read_b128 v[12:15], v245 offset:3072
  ds_read_b128 v[16:19], v245 offset:4096
  ds_read_b128 v[20:23], v245 offset:5120
  ds_read_b128 v[24:27], v245 offset:6144
  ds_read_b128 v[28:31], v245 offset:7168
  ds_read_b128 v[32:35], v245 offset:8192
  ds_read_b128 v[72:75], v245 offset:9216
  ds_read_b128 v[76:79], v245 offset:10240
  ds_read_b128 v[80:83], v245 offset:11264
  ds_read_b128 v[84:87], v245 offset:12288
  ds_read_b128 v[88:91], v245 offset:13312
  ds_read_b128 v[92:95], v245 offset:14336
  ds_read_b128 v[96:99], v245 offset:15360
  ds_read_b128 v[100:103], v245 offset:16384
  ds_read_b128 v[104:107], v245 offset:17408
  s_mul_i32 s33, s28, 18
  s_add_u32 s33, s33, 0
  v_add_u32 v40, s33, v255
  v_min_u32 v40, 143, v40
  s_mul_i32 s34, s47, 72
  v_and_b32 v249, 1, v40
  v_lshrrev_b32 v40, 1, v40
  v_add_u32 v40, s34, v40
  s_mov_b32 s34, 9216
  v_mul_lo_u32 v40, v40, s34
  v_lshl_add_u32 v40, v249, 7, v40
  v_add_u32 v40, 256, v40
  s_mov_b32 m0, 155648
  s_mov_b32 s37, s39
  buffer_load_dword v40, s[12:15], s37 offen lds
  s_waitcnt lgkmcnt(0)
  s_barrier
  ds_write_b128 v244, v[208:211] offset:0
  ds_write_b128 v244, v[212:215] offset:1024
  ds_write_b128 v244, v[216:219] offset:2048
  ds_write_b128 v244, v[220:223] offset:3072
  ds_write_b128 v244, v[224:227] offset:4096
  ds_write_b128 v244, v[228:231] offset:5120
  ds_write_b128 v244, v[232:235] offset:6144
  ds_write_b128 v244, v[236:239] offset:7168
  ds_write_b128 v244, v[240:243] offset:8192
  s_waitcnt lgkmcnt(0)
  s_barrier
  ds_read_b128 v[36:39], v245 offset:0
  ds_read_b128 v[40:43], v245 offset:1024
  ds_read_b128 v[44:47], v245 offset:2048
  ds_read_b128 v[48:51], v245 offset:3072
  ds_read_b128 v[52:55], v245 offset:4096
  ds_read_b128 v[56:59], v245 offset:5120
  ds_read_b128 v[60:63], v245 offset:6144
  ds_read_b128 v[64:67], v245 offset:7168
  ds_read_b128 v[68:71], v245 offset:8192
  ds_read_b128 v[108:111], v245 offset:9216
  ds_read_b128 v[112:115], v245 offset:10240
  ds_read_b128 v[116:119], v245 offset:11264
  ds_read_b128 v[120:123], v245 offset:12288
  ds_read_b128 v[124:127], v245 offset:13312
  ds_read_b128 v[128:131], v245 offset:14336
  ds_read_b128 v[132:135], v245 offset:15360
  ds_read_b128 v[136:139], v245 offset:16384
  ds_read_b128 v[140:143], v245 offset:17408
  s_waitcnt lgkmcnt(0)
  s_waitcnt vmcnt(1)
  s_barrier
  v_lshrrev_b32 v249, 4, v255
  v_and_b32 v250, 15, v255
  v_lshlrev_b32 v244, 2, v249
  v_lshrrev_b32 v245, 2, v250
  v_add_u32 v244, v244, v245
  v_lshlrev_b32 v244, 7, v244
  v_and_b32 v245, 3, v250
  v_lshlrev_b32 v245, 3, v245
  v_add_u32 v244, v244, v245
  v_and_b32 v249, 1, v249
  v_lshlrev_b32 v249, 1, v249
  v_lshrrev_b32 v250, 3, v250
  v_add_u32 v249, v249, v250
  s_lshl_b32 s33, s32, 1
  v_xor_b32 v249, s33, v249
  v_lshlrev_b32 v249, 5, v249
  v_add_u32 v244, v244, v249
  v_xor_b32 v245, 32, v244
  v_add_u32 v244, 73728, v244
  v_add_u32 v245, 73728, v245
  v_add_u32 v246, 65536, v244
  v_add_u32 v247, 65536, v245
  v_lshrrev_b32 v254, 4, v255
  v_lshlrev_b32 v254, 4, v254
  s_lshl_b32 s33, s32, 7
  s_add_u32 s33, s33, 147456
  v_add_u32 v254, s33, v254
  s_mul_i32 s40, s30, 442368
  v_lshrrev_b32 v249, 3, v255
  v_mov_b32 v243, v249
  s_mov_b32 s33, 1152
  v_mul_lo_u32 v243, v243, s33
  v_lshrrev_b32 v249, 1, v249
  v_lshlrev_b32 v249, 1, v249
  v_and_b32 v250, 7, v255
  v_xor_b32 v250, v250, v249
  v_lshlrev_b32 v250, 4, v250
  v_add_u32 v243, v243, v250
  s_mul_i32 s33, s28, 9216
  v_add_u32 v243, s33, v243
  ds_read_b128 v[144:147], v254 offset:0
  ds_read_b128 v[148:151], v254 offset:0
  ds_read_b128 v[152:155], v254 offset:64
  ds_read_b128 v[156:159], v254 offset:64
  s_mul_i32 s33, s28, 18
  s_add_u32 s33, s33, 0
  v_add_u32 v236, s33, v255
  v_min_u32 v236, 143, v236
  s_mul_i32 s34, s47, 72
  v_and_b32 v249, 1, v236
  v_lshrrev_b32 v236, 1, v236
  v_add_u32 v236, s34, v236
  s_mov_b32 s34, 9216
  v_mul_lo_u32 v236, v236, s34
  v_lshl_add_u32 v236, v249, 7, v236
  v_add_u32 v236, 512, v236
  s_mul_i32 s33, s28, 24
  s_add_u32 s33, s33, 0
  v_add_u32 v237, s33, v255
  v_min_u32 v237, 191, v237
  s_mul_i32 s34, s47, 48
  v_and_b32 v249, 3, v237
  v_lshrrev_b32 v237, 2, v237
  v_add_u32 v237, s34, v237
  s_mov_b32 s34, 1152
  v_mul_lo_u32 v237, v237, s34
  v_lshl_add_u32 v237, v249, 7, v237
  s_mul_i32 s33, s28, 24
  s_add_u32 s33, s33, 0
  v_add_u32 v238, s33, v255
  v_min_u32 v238, 191, v238
  s_mul_i32 s34, s47, 48
  v_and_b32 v249, 3, v238
  v_lshrrev_b32 v238, 2, v238
  v_add_u32 v238, s34, v238
  s_mov_b32 s34, 1152
  v_mul_lo_u32 v238, v238, s34
  v_lshl_add_u32 v238, v249, 7, v238
  v_add_u32 v238, 512, v238
  s_mul_i32 s33, s28, 6
  s_add_u32 s33, s33, 0
  v_add_u32 v239, s33, v255
  v_min_u32 v239, 47, v239
  s_mul_i32 s34, s47, 48
  v_add_u32 v239, s34, v239
  s_mov_b32 s34, 1152
  v_mul_lo_u32 v239, v239, s34
  v_add_u32 v239, 1024, v239
  ds_read_b64_tr_b16 v[176:177], v244 offset:0
  ds_read_b64_tr_b16 v[178:179], v244 offset:2048
  ds_read_b64_tr_b16 v[180:181], v245 offset:0
  ds_read_b64_tr_b16 v[182:183], v245 offset:2048
  ds_read_b64_tr_b16 v[184:185], v244 offset:4096
  ds_read_b64_tr_b16 v[186:187], v244 offset:6144
  ds_read_b64_tr_b16 v[188:189], v245 offset:4096
  ds_read_b64_tr_b16 v[190:191], v245 offset:6144
  s_waitcnt lgkmcnt(6)
  v_mfma_f32_16x16x32_bf16 v[144:147], v[176:179], v[0:3], v[144:147]
  ds_read_b64_tr_b16 v[192:193], v244 offset:8192
  v_mfma_f32_16x16x32_bf16 v[148:151], v[176:179], v[72:75], v[148:151]
  ds_read_b64_tr_b16 v[194:195], v244 offset:10240
  s_waitcnt lgkmcnt(6)
  v_mfma_f32_16x16x32_bf16 v[152:155], v[180:183], v[0:3], v[152:155]
  ds_read_b64_tr_b16 v[176:177], v245 offset:8192
  s_add_u32 m0, s38, 0
  s_add_u32 s37, s39, 128
  buffer_load_dwordx4 v248, s[12:15], s37 offen lds
  v_mfma_f32_16x16x32_bf16 v[156:159], v[180:183], v[72:75], v[156:159]
  ds_read_b64_tr_b16 v[178:179], v245 offset:10240
  s_waitcnt lgkmcnt(6)
  v_mfma_f32_16x16x32_bf16 v[144:147], v[184:187], v[4:7], v[144:147]
  ds_read_b64_tr_b16 v[180:181], v244 offset:12288
  v_mfma_f32_16x16x32_bf16 v[148:151], v[184:187], v[76:79], v[148:151]
  ds_read_b64_tr_b16 v[182:183], v244 offset:14336
  s_add_u32 m0, s38, 8192
  s_add_u32 s37, s39, 589952
  buffer_load_dwordx4 v248, s[12:15], s37 offen lds
  s_waitcnt lgkmcnt(6)
  v_mfma_f32_16x16x32_bf16 v[152:155], v[188:191], v[4:7], v[152:155]
  ds_read_b64_tr_b16 v[184:185], v245 offset:12288
  v_mfma_f32_16x16x32_bf16 v[156:159], v[188:191], v[76:79], v[156:159]
  ds_read_b64_tr_b16 v[186:187], v245 offset:14336
  s_waitcnt lgkmcnt(6)
  v_mfma_f32_16x16x32_bf16 v[144:147], v[192:195], v[8:11], v[144:147]
  ds_read_b64_tr_b16 v[188:189], v244 offset:16384
  s_add_u32 m0, s38, 16384
  s_add_u32 s37, s39, 1179776
  buffer_load_dwordx4 v248, s[12:15], s37 offen lds
  v_mfma_f32_16x16x32_bf16 v[148:151], v[192:195], v[80:83], v[148:151]
  ds_read_b64_tr_b16 v[190:191], v244 offset:18432
  s_waitcnt lgkmcnt(6)
  v_mfma_f32_16x16x32_bf16 v[152:155], v[176:179], v[8:11], v[152:155]
  ds_read_b64_tr_b16 v[192:193], v245 offset:16384
  v_mfma_f32_16x16x32_bf16 v[156:159], v[176:179], v[80:83], v[156:159]
  ds_read_b64_tr_b16 v[194:195], v245 offset:18432
  s_add_u32 m0, s38, 24576
  s_add_u32 s37, s39, 1769600
  buffer_load_dwordx4 v248, s[12:15], s37 offen lds
  s_waitcnt lgkmcnt(6)
  v_mfma_f32_16x16x32_bf16 v[144:147], v[180:183], v[12:15], v[144:147]
  ds_read_b64_tr_b16 v[176:177], v244 offset:20480
  v_mfma_f32_16x16x32_bf16 v[148:151], v[180:183], v[84:87], v[148:151]
  ds_read_b64_tr_b16 v[178:179], v244 offset:22528
  s_waitcnt lgkmcnt(6)
  v_mfma_f32_16x16x32_bf16 v[152:155], v[184:187], v[12:15], v[152:155]
  ds_read_b64_tr_b16 v[180:181], v245 offset:20480
  s_add_u32 m0, s38, 32768
  s_add_u32 s37, s39, 2359424
  buffer_load_dwordx4 v248, s[12:15], s37 offen lds
  v_mfma_f32_16x16x32_bf16 v[156:159], v[184:187], v[84:87], v[156:159]
  ds_read_b64_tr_b16 v[182:183], v245 offset:22528
  s_waitcnt lgkmcnt(6)
  v_mfma_f32_16x16x32_bf16 v[144:147], v[188:191], v[16:19], v[144:147]
  ds_read_b64_tr_b16 v[184:185], v244 offset:24576
  v_mfma_f32_16x16x32_bf16 v[148:151], v[188:191], v[88:91], v[148:151]
  ds_read_b64_tr_b16 v[186:187], v244 offset:26624
  s_add_u32 m0, s38, 40960
  s_add_u32 s37, s39, 2949248
  buffer_load_dwordx4 v248, s[12:15], s37 offen lds
  s_waitcnt lgkmcnt(6)
  v_mfma_f32_16x16x32_bf16 v[152:155], v[192:195], v[16:19], v[152:155]
  ds_read_b64_tr_b16 v[188:189], v245 offset:24576
  v_mfma_f32_16x16x32_bf16 v[156:159], v[192:195], v[88:91], v[156:159]
  ds_read_b64_tr_b16 v[190:191], v245 offset:26624
  s_waitcnt lgkmcnt(6)
  v_mfma_f32_16x16x32_bf16 v[144:147], v[176:179], v[20:23], v[144:147]
  ds_read_b64_tr_b16 v[192:193], v244 offset:28672
  s_add_u32 m0, s38, 49152
  s_add_u32 s37, s39, 3539072
  buffer_load_dwordx4 v248, s[12:15], s37 offen lds
  v_mfma_f32_16x16x32_bf16 v[148:151], v[176:179], v[92:95], v[148:151]
  ds_read_b64_tr_b16 v[194:195], v244 offset:30720
  s_waitcnt lgkmcnt(6)
  v_mfma_f32_16x16x32_bf16 v[152:155], v[180:183], v[20:23], v[152:155]
  ds_read_b64_tr_b16 v[176:177], v245 offset:28672
  v_mfma_f32_16x16x32_bf16 v[156:159], v[180:183], v[92:95], v[156:159]
  ds_read_b64_tr_b16 v[178:179], v245 offset:30720
  s_add_u32 m0, s38, 57344
  s_add_u32 s37, s39, 4128896
  buffer_load_dwordx4 v248, s[12:15], s37 offen lds
  s_waitcnt lgkmcnt(6)
  v_mfma_f32_16x16x32_bf16 v[144:147], v[184:187], v[24:27], v[144:147]
  ds_read_b64_tr_b16 v[180:181], v244 offset:32768
  v_mfma_f32_16x16x32_bf16 v[148:151], v[184:187], v[96:99], v[148:151]
  ds_read_b64_tr_b16 v[182:183], v244 offset:34816
  s_waitcnt lgkmcnt(6)
  v_mfma_f32_16x16x32_bf16 v[152:155], v[188:191], v[24:27], v[152:155]
  ds_read_b64_tr_b16 v[184:185], v245 offset:32768
  s_add_u32 m0, s38, 65536
  s_add_u32 s37, s39, 4718720
  buffer_load_dwordx4 v248, s[12:15], s37 offen lds
  v_mfma_f32_16x16x32_bf16 v[156:159], v[188:191], v[96:99], v[156:159]
  ds_read_b64_tr_b16 v[186:187], v245 offset:34816
  s_waitcnt lgkmcnt(6)
  v_mfma_f32_16x16x32_bf16 v[144:147], v[192:195], v[28:31], v[144:147]
  ds_read_b64_tr_b16 v[188:189], v244 offset:36864
  v_mfma_f32_16x16x32_bf16 v[148:151], v[192:195], v[100:103], v[148:151]
  ds_read_b64_tr_b16 v[190:191], v244 offset:38912
  s_waitcnt lgkmcnt(6)
  v_mfma_f32_16x16x32_bf16 v[152:155], v[176:179], v[28:31], v[152:155]
  ds_read_b64_tr_b16 v[192:193], v245 offset:36864
  v_mfma_f32_16x16x32_bf16 v[156:159], v[176:179], v[100:103], v[156:159]
  ds_read_b64_tr_b16 v[194:195], v245 offset:38912
  s_waitcnt lgkmcnt(6)
  v_mfma_f32_16x16x32_bf16 v[144:147], v[180:183], v[32:35], v[144:147]
  ds_read_b64_tr_b16 v[176:177], v244 offset:40960
  s_mov_b32 m0, 155648
  s_mov_b32 s37, s39
  buffer_load_dword v236, s[12:15], s37 offen lds
  v_mfma_f32_16x16x32_bf16 v[148:151], v[180:183], v[104:107], v[148:151]
  ds_read_b64_tr_b16 v[178:179], v244 offset:43008
  s_waitcnt lgkmcnt(6)
  v_mfma_f32_16x16x32_bf16 v[152:155], v[184:187], v[32:35], v[152:155]
  ds_read_b64_tr_b16 v[180:181], v245 offset:40960
  v_mfma_f32_16x16x32_bf16 v[156:159], v[184:187], v[104:107], v[156:159]
  ds_read_b64_tr_b16 v[182:183], v245 offset:43008
  s_waitcnt lgkmcnt(6)
  v_mfma_f32_16x16x32_bf16 v[144:147], v[188:191], v[36:39], v[144:147]
  ds_read_b64_tr_b16 v[184:185], v244 offset:45056
  v_mfma_f32_16x16x32_bf16 v[148:151], v[188:191], v[108:111], v[148:151]
  ds_read_b64_tr_b16 v[186:187], v244 offset:47104
  s_waitcnt lgkmcnt(6)
  v_mfma_f32_16x16x32_bf16 v[152:155], v[192:195], v[36:39], v[152:155]
  ds_read_b64_tr_b16 v[188:189], v245 offset:45056
  v_mfma_f32_16x16x32_bf16 v[156:159], v[192:195], v[108:111], v[156:159]
  ds_read_b64_tr_b16 v[190:191], v245 offset:47104
  s_waitcnt lgkmcnt(6)
  v_mfma_f32_16x16x32_bf16 v[144:147], v[176:179], v[40:43], v[144:147]
  ds_read_b64_tr_b16 v[192:193], v244 offset:49152
  v_mfma_f32_16x16x32_bf16 v[148:151], v[176:179], v[112:115], v[148:151]
  ds_read_b64_tr_b16 v[194:195], v244 offset:51200
  s_waitcnt lgkmcnt(6)
  v_mfma_f32_16x16x32_bf16 v[152:155], v[180:183], v[40:43], v[152:155]
  ds_read_b64_tr_b16 v[176:177], v245 offset:49152
  v_mfma_f32_16x16x32_bf16 v[156:159], v[180:183], v[112:115], v[156:159]
  ds_read_b64_tr_b16 v[178:179], v245 offset:51200
  s_waitcnt lgkmcnt(6)
  v_mfma_f32_16x16x32_bf16 v[144:147], v[184:187], v[44:47], v[144:147]
  ds_read_b64_tr_b16 v[180:181], v244 offset:53248
  v_mfma_f32_16x16x32_bf16 v[148:151], v[184:187], v[116:119], v[148:151]
  ds_read_b64_tr_b16 v[182:183], v244 offset:55296
  s_waitcnt lgkmcnt(6)
  v_mfma_f32_16x16x32_bf16 v[152:155], v[188:191], v[44:47], v[152:155]
  ds_read_b64_tr_b16 v[184:185], v245 offset:53248
  v_mfma_f32_16x16x32_bf16 v[156:159], v[188:191], v[116:119], v[156:159]
  ds_read_b64_tr_b16 v[186:187], v245 offset:55296
  s_waitcnt lgkmcnt(6)
  v_mfma_f32_16x16x32_bf16 v[144:147], v[192:195], v[48:51], v[144:147]
  ds_read_b64_tr_b16 v[188:189], v244 offset:57344
  v_mfma_f32_16x16x32_bf16 v[148:151], v[192:195], v[120:123], v[148:151]
  ds_read_b64_tr_b16 v[190:191], v244 offset:59392
  s_waitcnt lgkmcnt(6)
  v_mfma_f32_16x16x32_bf16 v[152:155], v[176:179], v[48:51], v[152:155]
  ds_read_b64_tr_b16 v[192:193], v245 offset:57344
  v_mfma_f32_16x16x32_bf16 v[156:159], v[176:179], v[120:123], v[156:159]
  ds_read_b64_tr_b16 v[194:195], v245 offset:59392
  s_waitcnt lgkmcnt(6)
  v_mfma_f32_16x16x32_bf16 v[144:147], v[180:183], v[52:55], v[144:147]
  ds_read_b64_tr_b16 v[176:177], v244 offset:61440
  v_mfma_f32_16x16x32_bf16 v[148:151], v[180:183], v[124:127], v[148:151]
  ds_read_b64_tr_b16 v[178:179], v244 offset:63488
  s_waitcnt lgkmcnt(6)
  v_mfma_f32_16x16x32_bf16 v[152:155], v[184:187], v[52:55], v[152:155]
  ds_read_b64_tr_b16 v[180:181], v245 offset:61440
  v_mfma_f32_16x16x32_bf16 v[156:159], v[184:187], v[124:127], v[156:159]
  ds_read_b64_tr_b16 v[182:183], v245 offset:63488
  s_waitcnt lgkmcnt(6)
  v_mfma_f32_16x16x32_bf16 v[144:147], v[188:191], v[56:59], v[144:147]
  ds_read_b64_tr_b16 v[184:185], v246 offset:0
  v_mfma_f32_16x16x32_bf16 v[148:151], v[188:191], v[128:131], v[148:151]
  ds_read_b64_tr_b16 v[186:187], v246 offset:2048
  s_waitcnt lgkmcnt(6)
  v_mfma_f32_16x16x32_bf16 v[152:155], v[192:195], v[56:59], v[152:155]
  ds_read_b64_tr_b16 v[188:189], v247 offset:0
  ds_read_b128 v[160:163], v254 offset:256
  v_mfma_f32_16x16x32_bf16 v[156:159], v[192:195], v[128:131], v[156:159]
  ds_read_b64_tr_b16 v[190:191], v247 offset:2048
  ds_read_b128 v[164:167], v254 offset:256
  s_waitcnt lgkmcnt(8)
  v_mfma_f32_16x16x32_bf16 v[144:147], v[176:179], v[60:63], v[144:147]
  ds_read_b64_tr_b16 v[192:193], v246 offset:4096
  ds_read_b128 v[168:171], v254 offset:320
  v_mfma_f32_16x16x32_bf16 v[148:151], v[176:179], v[132:135], v[148:151]
  ds_read_b64_tr_b16 v[194:195], v246 offset:6144
  ds_read_b128 v[172:175], v254 offset:320
  s_waitcnt lgkmcnt(10)
  v_mfma_f32_16x16x32_bf16 v[152:155], v[180:183], v[60:63], v[152:155]
  ds_read_b64_tr_b16 v[176:177], v247 offset:4096
  v_mfma_f32_16x16x32_bf16 v[156:159], v[180:183], v[132:135], v[156:159]
  ds_read_b64_tr_b16 v[178:179], v247 offset:6144
  s_waitcnt lgkmcnt(0)
  s_waitcnt vmcnt(1)
  s_barrier
  v_add_u32 v244, 4294893568, v244
  v_add_u32 v245, 4294893568, v245
  v_add_u32 v246, 4294893568, v246
  v_add_u32 v247, 4294893568, v247
  v_mfma_f32_16x16x32_bf16 v[144:147], v[184:187], v[64:67], v[144:147]
  ds_read_b64_tr_b16 v[180:181], v244 offset:0
  v_mfma_f32_16x16x32_bf16 v[148:151], v[184:187], v[136:139], v[148:151]
  ds_read_b64_tr_b16 v[182:183], v244 offset:2048
  s_add_u32 m0, s38, 73728
  s_add_u32 s37, s39, 256
  buffer_load_dwordx4 v248, s[12:15], s37 offen lds
  v_mfma_f32_16x16x32_bf16 v[152:155], v[188:191], v[64:67], v[152:155]
  ds_read_b64_tr_b16 v[184:185], v245 offset:0
  v_mfma_f32_16x16x32_bf16 v[156:159], v[188:191], v[136:139], v[156:159]
  ds_read_b64_tr_b16 v[186:187], v245 offset:2048
  v_mfma_f32_16x16x32_bf16 v[144:147], v[192:195], v[68:71], v[144:147]
  ds_read_b64_tr_b16 v[188:189], v244 offset:4096
  s_add_u32 m0, s38, 81920
  s_add_u32 s37, s39, 590080
  buffer_load_dwordx4 v248, s[12:15], s37 offen lds
  v_mfma_f32_16x16x32_bf16 v[148:151], v[192:195], v[140:143], v[148:151]
  ds_read_b64_tr_b16 v[190:191], v244 offset:6144
  v_mfma_f32_16x16x32_bf16 v[152:155], v[176:179], v[68:71], v[152:155]
  ds_read_b64_tr_b16 v[192:193], v245 offset:4096
  v_mfma_f32_16x16x32_bf16 v[156:159], v[176:179], v[140:143], v[156:159]
  ds_read_b64_tr_b16 v[194:195], v245 offset:6144
  s_add_u32 m0, s38, 90112
  s_add_u32 s37, s39, 1179904
  buffer_load_dwordx4 v248, s[12:15], s37 offen lds
  s_waitcnt lgkmcnt(6)
  v_mfma_f32_16x16x32_bf16 v[160:163], v[180:183], v[0:3], v[160:163]
  ds_read_b64_tr_b16 v[176:177], v244 offset:8192
  v_mfma_f32_16x16x32_bf16 v[164:167], v[180:183], v[72:75], v[164:167]
  ds_read_b64_tr_b16 v[178:179], v244 offset:10240
  s_waitcnt lgkmcnt(6)
  v_mfma_f32_16x16x32_bf16 v[168:171], v[184:187], v[0:3], v[168:171]
  ds_read_b64_tr_b16 v[180:181], v245 offset:8192
  s_add_u32 m0, s38, 98304
  s_add_u32 s37, s39, 1769728
  buffer_load_dwordx4 v248, s[12:15], s37 offen lds
  v_mfma_f32_16x16x32_bf16 v[172:175], v[184:187], v[72:75], v[172:175]
  ds_read_b64_tr_b16 v[182:183], v245 offset:10240
  s_waitcnt lgkmcnt(6)
  v_mfma_f32_16x16x32_bf16 v[160:163], v[188:191], v[4:7], v[160:163]
  ds_read_b64_tr_b16 v[184:185], v244 offset:12288
  v_mfma_f32_16x16x32_bf16 v[164:167], v[188:191], v[76:79], v[164:167]
  ds_read_b64_tr_b16 v[186:187], v244 offset:14336
  s_add_u32 m0, s38, 106496
  s_add_u32 s37, s39, 2359552
  buffer_load_dwordx4 v248, s[12:15], s37 offen lds
  s_waitcnt lgkmcnt(6)
  v_mfma_f32_16x16x32_bf16 v[168:171], v[192:195], v[4:7], v[168:171]
  ds_read_b64_tr_b16 v[188:189], v245 offset:12288
  v_mul_f32 v249, v144, v144
  v_mul_f32 v250, v145, v145
  v_mul_f32 v251, v146, v146
  v_mfma_f32_16x16x32_bf16 v[172:175], v[192:195], v[76:79], v[172:175]
  ds_read_b64_tr_b16 v[190:191], v245 offset:14336
  v_mul_f32 v252, v147, v147
  v_fma_f32 v249, v249, s44, v253
  s_waitcnt lgkmcnt(6)
  v_mfma_f32_16x16x32_bf16 v[160:163], v[176:179], v[8:11], v[160:163]
  ds_read_b64_tr_b16 v[192:193], v244 offset:16384
  s_add_u32 m0, s38, 114688
  s_add_u32 s37, s39, 2949376
  buffer_load_dwordx4 v248, s[12:15], s37 offen lds
  v_fma_f32 v250, v250, s44, v253
  v_fma_f32 v251, v251, s44, v253
  v_fma_f32 v252, v252, s44, v253
  v_mfma_f32_16x16x32_bf16 v[164:167], v[176:179], v[80:83], v[164:167]
  ds_read_b64_tr_b16 v[194:195], v244 offset:18432
  v_mul_f32 v249, v144, v249
  v_mul_f32 v250, v145, v250
  s_waitcnt lgkmcnt(6)
  v_mfma_f32_16x16x32_bf16 v[168:171], v[180:183], v[8:11], v[168:171]
  ds_read_b64_tr_b16 v[176:177], v245 offset:16384
  v_mul_f32 v251, v146, v251
  v_mul_f32 v252, v147, v252
  v_mfma_f32_16x16x32_bf16 v[172:175], v[180:183], v[80:83], v[172:175]
  ds_read_b64_tr_b16 v[178:179], v245 offset:18432
  s_add_u32 m0, s38, 122880
  s_add_u32 s37, s39, 3539200
  buffer_load_dwordx4 v248, s[12:15], s37 offen lds
  v_exp_f32 v249, v249
  v_exp_f32 v250, v250
  v_exp_f32 v251, v251
  s_waitcnt lgkmcnt(6)
  v_mfma_f32_16x16x32_bf16 v[160:163], v[184:187], v[12:15], v[160:163]
  ds_read_b64_tr_b16 v[180:181], v244 offset:20480
  v_exp_f32 v252, v252
  v_add_f32 v249, 1.0, v249
  v_mfma_f32_16x16x32_bf16 v[164:167], v[184:187], v[84:87], v[164:167]
  ds_read_b64_tr_b16 v[182:183], v244 offset:22528
  v_add_f32 v250, 1.0, v250
  v_add_f32 v251, 1.0, v251
  s_waitcnt lgkmcnt(6)
  v_mfma_f32_16x16x32_bf16 v[168:171], v[188:191], v[12:15], v[168:171]
  ds_read_b64_tr_b16 v[184:185], v245 offset:20480
  s_add_u32 m0, s38, 131072
  s_add_u32 s37, s39, 4129024
  buffer_load_dwordx4 v248, s[12:15], s37 offen lds
  v_add_f32 v252, 1.0, v252
  v_rcp_f32 v249, v249
  v_rcp_f32 v250, v250
  v_mfma_f32_16x16x32_bf16 v[172:175], v[188:191], v[84:87], v[172:175]
  ds_read_b64_tr_b16 v[186:187], v245 offset:22528
  v_rcp_f32 v251, v251
  v_rcp_f32 v252, v252
  s_waitcnt lgkmcnt(6)
  v_mfma_f32_16x16x32_bf16 v[160:163], v[192:195], v[16:19], v[160:163]
  ds_read_b64_tr_b16 v[188:189], v244 offset:24576
  v_mul_f32 v144, v144, v249
  v_mul_f32 v145, v145, v250
  v_mfma_f32_16x16x32_bf16 v[164:167], v[192:195], v[88:91], v[164:167]
  ds_read_b64_tr_b16 v[190:191], v244 offset:26624
  s_add_u32 m0, s38, 139264
  s_add_u32 s37, s39, 4718848
  buffer_load_dwordx4 v248, s[12:15], s37 offen lds
  v_mul_f32 v146, v146, v251
  v_mul_f32 v147, v147, v252
  v_cvt_pk_bf16_f32 v196, v144, v145
  s_waitcnt lgkmcnt(6)
  v_mfma_f32_16x16x32_bf16 v[168:171], v[176:179], v[16:19], v[168:171]
  ds_read_b64_tr_b16 v[192:193], v245 offset:24576
  v_cvt_pk_bf16_f32 v197, v146, v147
  v_mul_f32 v249, v148, v148
  v_mfma_f32_16x16x32_bf16 v[172:175], v[176:179], v[88:91], v[172:175]
  ds_read_b64_tr_b16 v[194:195], v245 offset:26624
  v_mul_f32 v250, v149, v149
  v_mul_f32 v251, v150, v150
  s_waitcnt lgkmcnt(6)
  v_mfma_f32_16x16x32_bf16 v[160:163], v[180:183], v[20:23], v[160:163]
  ds_read_b64_tr_b16 v[176:177], v244 offset:28672
  v_mul_f32 v252, v151, v151
  v_fma_f32 v249, v249, s44, v253
  v_fma_f32 v250, v250, s44, v253
  v_mfma_f32_16x16x32_bf16 v[164:167], v[180:183], v[92:95], v[164:167]
  ds_read_b64_tr_b16 v[178:179], v244 offset:30720
  v_fma_f32 v251, v251, s44, v253
  v_fma_f32 v252, v252, s44, v253
  s_waitcnt lgkmcnt(6)
  v_mfma_f32_16x16x32_bf16 v[168:171], v[184:187], v[20:23], v[168:171]
  ds_read_b64_tr_b16 v[180:181], v245 offset:28672
  v_mul_f32 v249, v148, v249
  v_mul_f32 v250, v149, v250
  v_mfma_f32_16x16x32_bf16 v[172:175], v[184:187], v[92:95], v[172:175]
  ds_read_b64_tr_b16 v[182:183], v245 offset:30720
  v_mul_f32 v251, v150, v251
  v_mul_f32 v252, v151, v252
  v_exp_f32 v249, v249
  s_waitcnt lgkmcnt(6)
  v_mfma_f32_16x16x32_bf16 v[160:163], v[188:191], v[24:27], v[160:163]
  ds_read_b64_tr_b16 v[184:185], v244 offset:32768
  v_exp_f32 v250, v250
  v_exp_f32 v251, v251
  v_mfma_f32_16x16x32_bf16 v[164:167], v[188:191], v[96:99], v[164:167]
  ds_read_b64_tr_b16 v[186:187], v244 offset:34816
  v_exp_f32 v252, v252
  v_add_f32 v249, 1.0, v249
  v_add_f32 v250, 1.0, v250
  s_waitcnt lgkmcnt(6)
  v_mfma_f32_16x16x32_bf16 v[168:171], v[192:195], v[24:27], v[168:171]
  ds_read_b64_tr_b16 v[188:189], v245 offset:32768
  v_add_f32 v251, 1.0, v251
  v_add_f32 v252, 1.0, v252
  v_mfma_f32_16x16x32_bf16 v[172:175], v[192:195], v[96:99], v[172:175]
  ds_read_b64_tr_b16 v[190:191], v245 offset:34816
  v_rcp_f32 v249, v249
  v_rcp_f32 v250, v250
  s_waitcnt lgkmcnt(6)
  v_mfma_f32_16x16x32_bf16 v[160:163], v[176:179], v[28:31], v[160:163]
  ds_read_b64_tr_b16 v[192:193], v244 offset:36864
  v_rcp_f32 v251, v251
  v_rcp_f32 v252, v252
  v_mul_f32 v148, v148, v249
  v_mfma_f32_16x16x32_bf16 v[164:167], v[176:179], v[100:103], v[164:167]
  ds_read_b64_tr_b16 v[194:195], v244 offset:38912
  v_mul_f32 v149, v149, v250
  v_mul_f32 v150, v150, v251
  s_waitcnt lgkmcnt(6)
  v_mfma_f32_16x16x32_bf16 v[168:171], v[180:183], v[28:31], v[168:171]
  ds_read_b64_tr_b16 v[176:177], v245 offset:36864
  v_mul_f32 v151, v151, v252
  v_cvt_pk_bf16_f32 v200, v148, v149
  v_mfma_f32_16x16x32_bf16 v[172:175], v[180:183], v[100:103], v[172:175]
  ds_read_b64_tr_b16 v[178:179], v245 offset:38912
  v_cvt_pk_bf16_f32 v201, v150, v151
  v_mul_f32 v249, v152, v152
  v_mul_f32 v250, v153, v153
  s_waitcnt lgkmcnt(6)
  v_mfma_f32_16x16x32_bf16 v[160:163], v[184:187], v[32:35], v[160:163]
  ds_read_b64_tr_b16 v[180:181], v244 offset:40960
  v_mul_f32 v251, v154, v154
  v_mul_f32 v252, v155, v155
  s_mov_b32 m0, 155648
  s_mov_b32 s37, s40
  buffer_load_dword v237, s[16:19], s37 offen lds
  v_mfma_f32_16x16x32_bf16 v[164:167], v[184:187], v[104:107], v[164:167]
  ds_read_b64_tr_b16 v[182:183], v244 offset:43008
  v_fma_f32 v249, v249, s44, v253
  v_fma_f32 v250, v250, s44, v253
  s_waitcnt lgkmcnt(6)
  v_mfma_f32_16x16x32_bf16 v[168:171], v[188:191], v[32:35], v[168:171]
  ds_read_b64_tr_b16 v[184:185], v245 offset:40960
  v_fma_f32 v251, v251, s44, v253
  v_fma_f32 v252, v252, s44, v253
  v_mul_f32 v249, v152, v249
  v_mfma_f32_16x16x32_bf16 v[172:175], v[188:191], v[104:107], v[172:175]
  ds_read_b64_tr_b16 v[186:187], v245 offset:43008
  v_mul_f32 v250, v153, v250
  v_mul_f32 v251, v154, v251
  s_waitcnt lgkmcnt(6)
  v_mfma_f32_16x16x32_bf16 v[160:163], v[192:195], v[36:39], v[160:163]
  ds_read_b64_tr_b16 v[188:189], v244 offset:45056
  v_mul_f32 v252, v155, v252
  v_exp_f32 v249, v249
  v_mfma_f32_16x16x32_bf16 v[164:167], v[192:195], v[108:111], v[164:167]
  ds_read_b64_tr_b16 v[190:191], v244 offset:47104
  v_exp_f32 v250, v250
  v_exp_f32 v251, v251
  v_exp_f32 v252, v252
  s_waitcnt lgkmcnt(6)
  v_mfma_f32_16x16x32_bf16 v[168:171], v[176:179], v[36:39], v[168:171]
  ds_read_b64_tr_b16 v[192:193], v245 offset:45056
  v_add_f32 v249, 1.0, v249
  v_add_f32 v250, 1.0, v250
  v_mfma_f32_16x16x32_bf16 v[172:175], v[176:179], v[108:111], v[172:175]
  ds_read_b64_tr_b16 v[194:195], v245 offset:47104
  v_add_f32 v251, 1.0, v251
  v_add_f32 v252, 1.0, v252
  s_waitcnt lgkmcnt(6)
  v_mfma_f32_16x16x32_bf16 v[160:163], v[180:183], v[40:43], v[160:163]
  ds_read_b64_tr_b16 v[176:177], v244 offset:49152
  v_rcp_f32 v249, v249
  v_rcp_f32 v250, v250
  v_rcp_f32 v251, v251
  v_mfma_f32_16x16x32_bf16 v[164:167], v[180:183], v[112:115], v[164:167]
  ds_read_b64_tr_b16 v[178:179], v244 offset:51200
  v_rcp_f32 v252, v252
  v_mul_f32 v152, v152, v249
  s_waitcnt lgkmcnt(6)
  v_mfma_f32_16x16x32_bf16 v[168:171], v[184:187], v[40:43], v[168:171]
  ds_read_b64_tr_b16 v[180:181], v245 offset:49152
  v_mul_f32 v153, v153, v250
  v_mul_f32 v154, v154, v251
  v_mul_f32 v155, v155, v252
  v_mfma_f32_16x16x32_bf16 v[172:175], v[184:187], v[112:115], v[172:175]
  ds_read_b64_tr_b16 v[182:183], v245 offset:51200
  v_cvt_pk_bf16_f32 v198, v152, v153
  v_cvt_pk_bf16_f32 v199, v154, v155
  s_waitcnt lgkmcnt(6)
  v_mfma_f32_16x16x32_bf16 v[160:163], v[188:191], v[44:47], v[160:163]
  ds_read_b64_tr_b16 v[184:185], v244 offset:53248
  v_mul_f32 v249, v156, v156
  v_mul_f32 v250, v157, v157
  v_mfma_f32_16x16x32_bf16 v[164:167], v[188:191], v[116:119], v[164:167]
  ds_read_b64_tr_b16 v[186:187], v244 offset:55296
  v_mul_f32 v251, v158, v158
  v_mul_f32 v252, v159, v159
  v_fma_f32 v249, v249, s44, v253
  s_waitcnt lgkmcnt(6)
  v_mfma_f32_16x16x32_bf16 v[168:171], v[192:195], v[44:47], v[168:171]
  ds_read_b64_tr_b16 v[188:189], v245 offset:53248
  v_fma_f32 v250, v250, s44, v253
  v_fma_f32 v251, v251, s44, v253
  v_mfma_f32_16x16x32_bf16 v[172:175], v[192:195], v[116:119], v[172:175]
  ds_read_b64_tr_b16 v[190:191], v245 offset:55296
  v_fma_f32 v252, v252, s44, v253
  v_mul_f32 v249, v156, v249
  s_waitcnt lgkmcnt(6)
  v_mfma_f32_16x16x32_bf16 v[160:163], v[176:179], v[48:51], v[160:163]
  ds_read_b64_tr_b16 v[192:193], v244 offset:57344
  v_mul_f32 v250, v157, v250
  v_mul_f32 v251, v158, v251
  v_mul_f32 v252, v159, v252
  v_mfma_f32_16x16x32_bf16 v[164:167], v[176:179], v[120:123], v[164:167]
  ds_read_b64_tr_b16 v[194:195], v244 offset:59392
  v_exp_f32 v249, v249
  v_exp_f32 v250, v250
  s_waitcnt lgkmcnt(6)
  v_mfma_f32_16x16x32_bf16 v[168:171], v[180:183], v[48:51], v[168:171]
  ds_read_b64_tr_b16 v[176:177], v245 offset:57344
  v_exp_f32 v251, v251
  v_exp_f32 v252, v252
  v_mfma_f32_16x16x32_bf16 v[172:175], v[180:183], v[120:123], v[172:175]
  ds_read_b64_tr_b16 v[178:179], v245 offset:59392
  v_add_f32 v249, 1.0, v249
  v_add_f32 v250, 1.0, v250
  v_add_f32 v251, 1.0, v251
  s_waitcnt lgkmcnt(6)
  v_mfma_f32_16x16x32_bf16 v[160:163], v[184:187], v[52:55], v[160:163]
  ds_read_b64_tr_b16 v[180:181], v244 offset:61440
  v_add_f32 v252, 1.0, v252
  v_rcp_f32 v249, v249
  v_mfma_f32_16x16x32_bf16 v[164:167], v[184:187], v[124:127], v[164:167]
  ds_read_b64_tr_b16 v[182:183], v244 offset:63488
  v_rcp_f32 v250, v250
  v_rcp_f32 v251, v251
  s_waitcnt lgkmcnt(6)
  v_mfma_f32_16x16x32_bf16 v[168:171], v[188:191], v[52:55], v[168:171]
  ds_read_b64_tr_b16 v[184:185], v245 offset:61440
  v_rcp_f32 v252, v252
  v_mul_f32 v156, v156, v249
  v_mul_f32 v157, v157, v250
  v_mfma_f32_16x16x32_bf16 v[172:175], v[188:191], v[124:127], v[172:175]
  ds_read_b64_tr_b16 v[186:187], v245 offset:63488
  v_mul_f32 v158, v158, v251
  v_mul_f32 v159, v159, v252
  s_waitcnt lgkmcnt(6)
  v_mfma_f32_16x16x32_bf16 v[160:163], v[192:195], v[56:59], v[160:163]
  ds_read_b64_tr_b16 v[188:189], v246 offset:0
  v_cvt_pk_bf16_f32 v202, v156, v157
  v_cvt_pk_bf16_f32 v203, v158, v159
  v_mfma_f32_16x16x32_bf16 v[164:167], v[192:195], v[128:131], v[164:167]
  ds_read_b64_tr_b16 v[190:191], v246 offset:2048
  s_waitcnt lgkmcnt(6)
  v_mfma_f32_16x16x32_bf16 v[168:171], v[176:179], v[56:59], v[168:171]
  ds_read_b64_tr_b16 v[192:193], v247 offset:0
  ds_read_b128 v[144:147], v254 offset:512
  v_mfma_f32_16x16x32_bf16 v[172:175], v[176:179], v[128:131], v[172:175]
  ds_read_b64_tr_b16 v[194:195], v247 offset:2048
  ds_read_b128 v[148:151], v254 offset:512
  s_waitcnt lgkmcnt(8)
  v_mfma_f32_16x16x32_bf16 v[160:163], v[180:183], v[60:63], v[160:163]
  ds_read_b64_tr_b16 v[176:177], v246 offset:4096
  ds_read_b128 v[152:155], v254 offset:576
  v_mfma_f32_16x16x32_bf16 v[164:167], v[180:183], v[132:135], v[164:167]
  ds_read_b64_tr_b16 v[178:179], v246 offset:6144
  ds_read_b128 v[156:159], v254 offset:576
  s_waitcnt lgkmcnt(10)
  v_mfma_f32_16x16x32_bf16 v[168:171], v[184:187], v[60:63], v[168:171]
  ds_read_b64_tr_b16 v[180:181], v247 offset:4096
  v_mfma_f32_16x16x32_bf16 v[172:175], v[184:187], v[132:135], v[172:175]
  ds_read_b64_tr_b16 v[182:183], v247 offset:6144
  s_waitcnt lgkmcnt(0)
  s_waitcnt vmcnt(1)
  s_barrier
  v_add_u32 v244, 73728, v244
  v_add_u32 v245, 73728, v245
  v_add_u32 v246, 73728, v246
  v_add_u32 v247, 73728, v247
  v_mfma_f32_16x16x32_bf16 v[160:163], v[188:191], v[64:67], v[160:163]
  ds_read_b64_tr_b16 v[184:185], v244 offset:0
  v_mfma_f32_16x16x32_bf16 v[164:167], v[188:191], v[136:139], v[164:167]
  ds_read_b64_tr_b16 v[186:187], v244 offset:2048
  s_add_u32 m0, s38, 0
  s_add_u32 s37, s39, 384
  buffer_load_dwordx4 v248, s[12:15], s37 offen lds
  v_mfma_f32_16x16x32_bf16 v[168:171], v[192:195], v[64:67], v[168:171]
  ds_read_b64_tr_b16 v[188:189], v245 offset:0
  v_mfma_f32_16x16x32_bf16 v[172:175], v[192:195], v[136:139], v[172:175]
  ds_read_b64_tr_b16 v[190:191], v245 offset:2048
  v_mfma_f32_16x16x32_bf16 v[160:163], v[176:179], v[68:71], v[160:163]
  ds_read_b64_tr_b16 v[192:193], v244 offset:4096
  s_add_u32 m0, s38, 8192
  s_add_u32 s37, s39, 590208
  buffer_load_dwordx4 v248, s[12:15], s37 offen lds
  v_mfma_f32_16x16x32_bf16 v[164:167], v[176:179], v[140:143], v[164:167]
  ds_read_b64_tr_b16 v[194:195], v244 offset:6144
  v_mfma_f32_16x16x32_bf16 v[168:171], v[180:183], v[68:71], v[168:171]
  ds_read_b64_tr_b16 v[176:177], v245 offset:4096
  v_mfma_f32_16x16x32_bf16 v[172:175], v[180:183], v[140:143], v[172:175]
  ds_read_b64_tr_b16 v[178:179], v245 offset:6144
  s_add_u32 m0, s38, 16384
  s_add_u32 s37, s39, 1180032
  buffer_load_dwordx4 v248, s[12:15], s37 offen lds
  s_waitcnt lgkmcnt(6)
  v_mfma_f32_16x16x32_bf16 v[144:147], v[184:187], v[0:3], v[144:147]
  ds_read_b64_tr_b16 v[180:181], v244 offset:8192
  v_mfma_f32_16x16x32_bf16 v[148:151], v[184:187], v[72:75], v[148:151]
  ds_read_b64_tr_b16 v[182:183], v244 offset:10240
  s_waitcnt lgkmcnt(6)
  v_mfma_f32_16x16x32_bf16 v[152:155], v[188:191], v[0:3], v[152:155]
  ds_read_b64_tr_b16 v[184:185], v245 offset:8192
  s_add_u32 m0, s38, 24576
  s_add_u32 s37, s39, 1769856
  buffer_load_dwordx4 v248, s[12:15], s37 offen lds
  v_mfma_f32_16x16x32_bf16 v[156:159], v[188:191], v[72:75], v[156:159]
  ds_read_b64_tr_b16 v[186:187], v245 offset:10240
  s_waitcnt lgkmcnt(6)
  v_mfma_f32_16x16x32_bf16 v[144:147], v[192:195], v[4:7], v[144:147]
  ds_read_b64_tr_b16 v[188:189], v244 offset:12288
  v_mfma_f32_16x16x32_bf16 v[148:151], v[192:195], v[76:79], v[148:151]
  ds_read_b64_tr_b16 v[190:191], v244 offset:14336
  s_add_u32 m0, s38, 32768
  s_add_u32 s37, s39, 2359680
  buffer_load_dwordx4 v248, s[12:15], s37 offen lds
  s_waitcnt lgkmcnt(6)
  v_mfma_f32_16x16x32_bf16 v[152:155], v[176:179], v[4:7], v[152:155]
  ds_read_b64_tr_b16 v[192:193], v245 offset:12288
  v_mul_f32 v249, v160, v160
  v_mul_f32 v250, v161, v161
  v_mul_f32 v251, v162, v162
  v_mfma_f32_16x16x32_bf16 v[156:159], v[176:179], v[76:79], v[156:159]
  ds_read_b64_tr_b16 v[194:195], v245 offset:14336
  v_mul_f32 v252, v163, v163
  v_fma_f32 v249, v249, s44, v253
  s_waitcnt lgkmcnt(6)
  v_mfma_f32_16x16x32_bf16 v[144:147], v[180:183], v[8:11], v[144:147]
  ds_read_b64_tr_b16 v[176:177], v244 offset:16384
  s_add_u32 m0, s38, 40960
  s_add_u32 s37, s39, 2949504
  buffer_load_dwordx4 v248, s[12:15], s37 offen lds
  v_fma_f32 v250, v250, s44, v253
  v_fma_f32 v251, v251, s44, v253
  v_fma_f32 v252, v252, s44, v253
  v_mfma_f32_16x16x32_bf16 v[148:151], v[180:183], v[80:83], v[148:151]
  ds_read_b64_tr_b16 v[178:179], v244 offset:18432
  v_mul_f32 v249, v160, v249
  v_mul_f32 v250, v161, v250
  s_waitcnt lgkmcnt(6)
  v_mfma_f32_16x16x32_bf16 v[152:155], v[184:187], v[8:11], v[152:155]
  ds_read_b64_tr_b16 v[180:181], v245 offset:16384
  v_mul_f32 v251, v162, v251
  v_mul_f32 v252, v163, v252
  v_mfma_f32_16x16x32_bf16 v[156:159], v[184:187], v[80:83], v[156:159]
  ds_read_b64_tr_b16 v[182:183], v245 offset:18432
  s_add_u32 m0, s38, 49152
  s_add_u32 s37, s39, 3539328
  buffer_load_dwordx4 v248, s[12:15], s37 offen lds
  v_exp_f32 v249, v249
  v_exp_f32 v250, v250
  v_exp_f32 v251, v251
  s_waitcnt lgkmcnt(6)
  v_mfma_f32_16x16x32_bf16 v[144:147], v[188:191], v[12:15], v[144:147]
  ds_read_b64_tr_b16 v[184:185], v244 offset:20480
  v_exp_f32 v252, v252
  v_add_f32 v249, 1.0, v249
  v_mfma_f32_16x16x32_bf16 v[148:151], v[188:191], v[84:87], v[148:151]
  ds_read_b64_tr_b16 v[186:187], v244 offset:22528
  v_add_f32 v250, 1.0, v250
  v_add_f32 v251, 1.0, v251
  s_waitcnt lgkmcnt(6)
  v_mfma_f32_16x16x32_bf16 v[152:155], v[192:195], v[12:15], v[152:155]
  ds_read_b64_tr_b16 v[188:189], v245 offset:20480
  s_add_u32 m0, s38, 57344
  s_add_u32 s37, s39, 4129152
  buffer_load_dwordx4 v248, s[12:15], s37 offen lds
  v_add_f32 v252, 1.0, v252
  v_rcp_f32 v249, v249
  v_rcp_f32 v250, v250
  v_mfma_f32_16x16x32_bf16 v[156:159], v[192:195], v[84:87], v[156:159]
  ds_read_b64_tr_b16 v[190:191], v245 offset:22528
  v_rcp_f32 v251, v251
  v_rcp_f32 v252, v252
  s_waitcnt lgkmcnt(6)
  v_mfma_f32_16x16x32_bf16 v[144:147], v[176:179], v[16:19], v[144:147]
  ds_read_b64_tr_b16 v[192:193], v244 offset:24576
  v_mul_f32 v160, v160, v249
  v_mul_f32 v161, v161, v250
  v_mfma_f32_16x16x32_bf16 v[148:151], v[176:179], v[88:91], v[148:151]
  ds_read_b64_tr_b16 v[194:195], v244 offset:26624
  s_add_u32 m0, s38, 65536
  s_add_u32 s37, s39, 4718976
  buffer_load_dwordx4 v248, s[12:15], s37 offen lds
  v_mul_f32 v162, v162, v251
  v_mul_f32 v163, v163, v252
  v_cvt_pk_bf16_f32 v204, v160, v161
  s_waitcnt lgkmcnt(6)
  v_mfma_f32_16x16x32_bf16 v[152:155], v[180:183], v[16:19], v[152:155]
  ds_read_b64_tr_b16 v[176:177], v245 offset:24576
  v_cvt_pk_bf16_f32 v205, v162, v163
  v_mul_f32 v249, v164, v164
  v_mfma_f32_16x16x32_bf16 v[156:159], v[180:183], v[88:91], v[156:159]
  ds_read_b64_tr_b16 v[178:179], v245 offset:26624
  v_mul_f32 v250, v165, v165
  v_mul_f32 v251, v166, v166
  s_waitcnt lgkmcnt(6)
  v_mfma_f32_16x16x32_bf16 v[144:147], v[184:187], v[20:23], v[144:147]
  ds_read_b64_tr_b16 v[180:181], v244 offset:28672
  v_mul_f32 v252, v167, v167
  v_fma_f32 v249, v249, s44, v253
  v_fma_f32 v250, v250, s44, v253
  v_mfma_f32_16x16x32_bf16 v[148:151], v[184:187], v[92:95], v[148:151]
  ds_read_b64_tr_b16 v[182:183], v244 offset:30720
  v_fma_f32 v251, v251, s44, v253
  v_fma_f32 v252, v252, s44, v253
  s_waitcnt lgkmcnt(6)
  v_mfma_f32_16x16x32_bf16 v[152:155], v[188:191], v[20:23], v[152:155]
  ds_read_b64_tr_b16 v[184:185], v245 offset:28672
  v_mul_f32 v249, v164, v249
  v_mul_f32 v250, v165, v250
  v_mfma_f32_16x16x32_bf16 v[156:159], v[188:191], v[92:95], v[156:159]
  ds_read_b64_tr_b16 v[186:187], v245 offset:30720
  v_mul_f32 v251, v166, v251
  v_mul_f32 v252, v167, v252
  v_exp_f32 v249, v249
  s_waitcnt lgkmcnt(6)
  v_mfma_f32_16x16x32_bf16 v[144:147], v[192:195], v[24:27], v[144:147]
  ds_read_b64_tr_b16 v[188:189], v244 offset:32768
  v_exp_f32 v250, v250
  v_exp_f32 v251, v251
  v_mfma_f32_16x16x32_bf16 v[148:151], v[192:195], v[96:99], v[148:151]
  ds_read_b64_tr_b16 v[190:191], v244 offset:34816
  v_exp_f32 v252, v252
  v_add_f32 v249, 1.0, v249
  v_add_f32 v250, 1.0, v250
  s_waitcnt lgkmcnt(6)
  v_mfma_f32_16x16x32_bf16 v[152:155], v[176:179], v[24:27], v[152:155]
  ds_read_b64_tr_b16 v[192:193], v245 offset:32768
  v_add_f32 v251, 1.0, v251
  v_add_f32 v252, 1.0, v252
  v_mfma_f32_16x16x32_bf16 v[156:159], v[176:179], v[96:99], v[156:159]
  ds_read_b64_tr_b16 v[194:195], v245 offset:34816
  v_rcp_f32 v249, v249
  v_rcp_f32 v250, v250
  s_waitcnt lgkmcnt(6)
  v_mfma_f32_16x16x32_bf16 v[144:147], v[180:183], v[28:31], v[144:147]
  ds_read_b64_tr_b16 v[176:177], v244 offset:36864
  v_rcp_f32 v251, v251
  v_rcp_f32 v252, v252
  v_mul_f32 v164, v164, v249
  v_mfma_f32_16x16x32_bf16 v[148:151], v[180:183], v[100:103], v[148:151]
  ds_read_b64_tr_b16 v[178:179], v244 offset:38912
  v_mul_f32 v165, v165, v250
  v_mul_f32 v166, v166, v251
  s_waitcnt lgkmcnt(6)
  v_mfma_f32_16x16x32_bf16 v[152:155], v[184:187], v[28:31], v[152:155]
  ds_read_b64_tr_b16 v[180:181], v245 offset:36864
  v_mul_f32 v167, v167, v252
  v_cvt_pk_bf16_f32 v208, v164, v165
  v_mfma_f32_16x16x32_bf16 v[156:159], v[184:187], v[100:103], v[156:159]
  ds_read_b64_tr_b16 v[182:183], v245 offset:38912
  v_cvt_pk_bf16_f32 v209, v166, v167
  v_mul_f32 v249, v168, v168
  v_mul_f32 v250, v169, v169
  s_waitcnt lgkmcnt(6)
  v_mfma_f32_16x16x32_bf16 v[144:147], v[188:191], v[32:35], v[144:147]
  ds_read_b64_tr_b16 v[184:185], v244 offset:40960
  v_mul_f32 v251, v170, v170
  v_mul_f32 v252, v171, v171
  s_mov_b32 m0, 155648
  s_mov_b32 s37, s40
  buffer_load_dword v238, s[16:19], s37 offen lds
  v_mfma_f32_16x16x32_bf16 v[148:151], v[188:191], v[104:107], v[148:151]
  ds_read_b64_tr_b16 v[186:187], v244 offset:43008
  v_fma_f32 v249, v249, s44, v253
  v_fma_f32 v250, v250, s44, v253
  s_waitcnt lgkmcnt(6)
  v_mfma_f32_16x16x32_bf16 v[152:155], v[192:195], v[32:35], v[152:155]
  ds_read_b64_tr_b16 v[188:189], v245 offset:40960
  v_fma_f32 v251, v251, s44, v253
  v_fma_f32 v252, v252, s44, v253
  v_mul_f32 v249, v168, v249
  v_mfma_f32_16x16x32_bf16 v[156:159], v[192:195], v[104:107], v[156:159]
  ds_read_b64_tr_b16 v[190:191], v245 offset:43008
  v_mul_f32 v250, v169, v250
  v_mul_f32 v251, v170, v251
  s_waitcnt lgkmcnt(6)
  v_mfma_f32_16x16x32_bf16 v[144:147], v[176:179], v[36:39], v[144:147]
  ds_read_b64_tr_b16 v[192:193], v244 offset:45056
  v_mul_f32 v252, v171, v252
  v_exp_f32 v249, v249
  v_mfma_f32_16x16x32_bf16 v[148:151], v[176:179], v[108:111], v[148:151]
  ds_read_b64_tr_b16 v[194:195], v244 offset:47104
  v_exp_f32 v250, v250
  v_exp_f32 v251, v251
  v_exp_f32 v252, v252
  s_waitcnt lgkmcnt(6)
  v_mfma_f32_16x16x32_bf16 v[152:155], v[180:183], v[36:39], v[152:155]
  ds_read_b64_tr_b16 v[176:177], v245 offset:45056
  v_add_f32 v249, 1.0, v249
  v_add_f32 v250, 1.0, v250
  v_mfma_f32_16x16x32_bf16 v[156:159], v[180:183], v[108:111], v[156:159]
  ds_read_b64_tr_b16 v[178:179], v245 offset:47104
  v_add_f32 v251, 1.0, v251
  v_add_f32 v252, 1.0, v252
  s_waitcnt lgkmcnt(6)
  v_mfma_f32_16x16x32_bf16 v[144:147], v[184:187], v[40:43], v[144:147]
  ds_read_b64_tr_b16 v[180:181], v244 offset:49152
  v_rcp_f32 v249, v249
  v_rcp_f32 v250, v250
  v_rcp_f32 v251, v251
  v_mfma_f32_16x16x32_bf16 v[148:151], v[184:187], v[112:115], v[148:151]
  ds_read_b64_tr_b16 v[182:183], v244 offset:51200
  v_rcp_f32 v252, v252
  v_mul_f32 v168, v168, v249
  s_waitcnt lgkmcnt(6)
  v_mfma_f32_16x16x32_bf16 v[152:155], v[188:191], v[40:43], v[152:155]
  ds_read_b64_tr_b16 v[184:185], v245 offset:49152
  v_mul_f32 v169, v169, v250
  v_mul_f32 v170, v170, v251
  v_mul_f32 v171, v171, v252
  v_mfma_f32_16x16x32_bf16 v[156:159], v[188:191], v[112:115], v[156:159]
  ds_read_b64_tr_b16 v[186:187], v245 offset:51200
  v_cvt_pk_bf16_f32 v206, v168, v169
  v_cvt_pk_bf16_f32 v207, v170, v171
  s_waitcnt lgkmcnt(6)
  v_mfma_f32_16x16x32_bf16 v[144:147], v[192:195], v[44:47], v[144:147]
  ds_read_b64_tr_b16 v[188:189], v244 offset:53248
  v_mul_f32 v249, v172, v172
  v_mul_f32 v250, v173, v173
  v_mfma_f32_16x16x32_bf16 v[148:151], v[192:195], v[116:119], v[148:151]
  ds_read_b64_tr_b16 v[190:191], v244 offset:55296
  v_mul_f32 v251, v174, v174
  v_mul_f32 v252, v175, v175
  v_fma_f32 v249, v249, s44, v253
  s_waitcnt lgkmcnt(6)
  v_mfma_f32_16x16x32_bf16 v[152:155], v[176:179], v[44:47], v[152:155]
  ds_read_b64_tr_b16 v[192:193], v245 offset:53248
  v_fma_f32 v250, v250, s44, v253
  v_fma_f32 v251, v251, s44, v253
  v_mfma_f32_16x16x32_bf16 v[156:159], v[176:179], v[116:119], v[156:159]
  ds_read_b64_tr_b16 v[194:195], v245 offset:55296
  v_fma_f32 v252, v252, s44, v253
  v_mul_f32 v249, v172, v249
  s_waitcnt lgkmcnt(6)
  v_mfma_f32_16x16x32_bf16 v[144:147], v[180:183], v[48:51], v[144:147]
  ds_read_b64_tr_b16 v[176:177], v244 offset:57344
  v_mul_f32 v250, v173, v250
  v_mul_f32 v251, v174, v251
  v_mul_f32 v252, v175, v252
  v_mfma_f32_16x16x32_bf16 v[148:151], v[180:183], v[120:123], v[148:151]
  ds_read_b64_tr_b16 v[178:179], v244 offset:59392
  v_exp_f32 v249, v249
  v_exp_f32 v250, v250
  s_waitcnt lgkmcnt(6)
  v_mfma_f32_16x16x32_bf16 v[152:155], v[184:187], v[48:51], v[152:155]
  ds_read_b64_tr_b16 v[180:181], v245 offset:57344
  v_exp_f32 v251, v251
  v_exp_f32 v252, v252
  v_mfma_f32_16x16x32_bf16 v[156:159], v[184:187], v[120:123], v[156:159]
  ds_read_b64_tr_b16 v[182:183], v245 offset:59392
  v_add_f32 v249, 1.0, v249
  v_add_f32 v250, 1.0, v250
  v_add_f32 v251, 1.0, v251
  s_waitcnt lgkmcnt(6)
  v_mfma_f32_16x16x32_bf16 v[144:147], v[188:191], v[52:55], v[144:147]
  ds_read_b64_tr_b16 v[184:185], v244 offset:61440
  v_add_f32 v252, 1.0, v252
  v_rcp_f32 v249, v249
  v_mfma_f32_16x16x32_bf16 v[148:151], v[188:191], v[124:127], v[148:151]
  ds_read_b64_tr_b16 v[186:187], v244 offset:63488
  v_rcp_f32 v250, v250
  v_rcp_f32 v251, v251
  s_waitcnt lgkmcnt(6)
  v_mfma_f32_16x16x32_bf16 v[152:155], v[192:195], v[52:55], v[152:155]
  ds_read_b64_tr_b16 v[188:189], v245 offset:61440
  v_rcp_f32 v252, v252
  v_mul_f32 v172, v172, v249
  v_mul_f32 v173, v173, v250
  v_mfma_f32_16x16x32_bf16 v[156:159], v[192:195], v[124:127], v[156:159]
  ds_read_b64_tr_b16 v[190:191], v245 offset:63488
  v_mul_f32 v174, v174, v251
  v_mul_f32 v175, v175, v252
  s_waitcnt lgkmcnt(6)
  v_mfma_f32_16x16x32_bf16 v[144:147], v[176:179], v[56:59], v[144:147]
  ds_read_b64_tr_b16 v[192:193], v246 offset:0
  v_cvt_pk_bf16_f32 v210, v172, v173
  v_cvt_pk_bf16_f32 v211, v174, v175
  v_mfma_f32_16x16x32_bf16 v[148:151], v[176:179], v[128:131], v[148:151]
  ds_read_b64_tr_b16 v[194:195], v246 offset:2048
  s_waitcnt lgkmcnt(6)
  v_mfma_f32_16x16x32_bf16 v[152:155], v[180:183], v[56:59], v[152:155]
  ds_read_b64_tr_b16 v[176:177], v247 offset:0
  ds_read_b128 v[160:163], v254 offset:768
  v_mfma_f32_16x16x32_bf16 v[156:159], v[180:183], v[128:131], v[156:159]
  ds_read_b64_tr_b16 v[178:179], v247 offset:2048
  ds_read_b128 v[164:167], v254 offset:768
  s_waitcnt lgkmcnt(8)
  v_mfma_f32_16x16x32_bf16 v[144:147], v[184:187], v[60:63], v[144:147]
  ds_read_b64_tr_b16 v[180:181], v246 offset:4096
  ds_read_b128 v[168:171], v254 offset:832
  v_mfma_f32_16x16x32_bf16 v[148:151], v[184:187], v[132:135], v[148:151]
  ds_read_b64_tr_b16 v[182:183], v246 offset:6144
  ds_read_b128 v[172:175], v254 offset:832
  s_waitcnt lgkmcnt(10)
  v_mfma_f32_16x16x32_bf16 v[152:155], v[188:191], v[60:63], v[152:155]
  ds_read_b64_tr_b16 v[184:185], v247 offset:4096
  v_mfma_f32_16x16x32_bf16 v[156:159], v[188:191], v[132:135], v[156:159]
  ds_read_b64_tr_b16 v[186:187], v247 offset:6144
  s_waitcnt lgkmcnt(0)
  s_waitcnt vmcnt(1)
  s_barrier
  v_add_u32 v244, 4294893568, v244
  v_add_u32 v245, 4294893568, v245
  v_add_u32 v246, 4294893568, v246
  v_add_u32 v247, 4294893568, v247
  v_mfma_f32_16x16x32_bf16 v[144:147], v[192:195], v[64:67], v[144:147]
  ds_read_b64_tr_b16 v[188:189], v244 offset:0
  v_mfma_f32_16x16x32_bf16 v[148:151], v[192:195], v[136:139], v[148:151]
  ds_read_b64_tr_b16 v[190:191], v244 offset:2048
  s_add_u32 m0, s38, 73728
  s_add_u32 s37, s39, 512
  buffer_load_dwordx4 v248, s[12:15], s37 offen lds
  v_mfma_f32_16x16x32_bf16 v[152:155], v[176:179], v[64:67], v[152:155]
  ds_read_b64_tr_b16 v[192:193], v245 offset:0
  v_mfma_f32_16x16x32_bf16 v[156:159], v[176:179], v[136:139], v[156:159]
  ds_read_b64_tr_b16 v[194:195], v245 offset:2048
  v_mfma_f32_16x16x32_bf16 v[144:147], v[180:183], v[68:71], v[144:147]
  ds_read_b64_tr_b16 v[176:177], v244 offset:4096
  s_add_u32 m0, s38, 81920
  s_add_u32 s37, s39, 590336
  buffer_load_dwordx4 v248, s[12:15], s37 offen lds
  v_mfma_f32_16x16x32_bf16 v[148:151], v[180:183], v[140:143], v[148:151]
  ds_read_b64_tr_b16 v[178:179], v244 offset:6144
  v_mfma_f32_16x16x32_bf16 v[152:155], v[184:187], v[68:71], v[152:155]
  ds_read_b64_tr_b16 v[180:181], v245 offset:4096
  v_mfma_f32_16x16x32_bf16 v[156:159], v[184:187], v[140:143], v[156:159]
  ds_read_b64_tr_b16 v[182:183], v245 offset:6144
  s_add_u32 m0, s38, 90112
  s_add_u32 s37, s39, 1180160
  buffer_load_dwordx4 v248, s[12:15], s37 offen lds
  s_waitcnt lgkmcnt(6)
  v_mfma_f32_16x16x32_bf16 v[160:163], v[188:191], v[0:3], v[160:163]
  ds_read_b64_tr_b16 v[184:185], v244 offset:8192
  v_mfma_f32_16x16x32_bf16 v[164:167], v[188:191], v[72:75], v[164:167]
  ds_read_b64_tr_b16 v[186:187], v244 offset:10240
  s_waitcnt lgkmcnt(6)
  v_mfma_f32_16x16x32_bf16 v[168:171], v[192:195], v[0:3], v[168:171]
  ds_read_b64_tr_b16 v[188:189], v245 offset:8192
  s_add_u32 m0, s38, 98304
  s_add_u32 s37, s39, 1769984
  buffer_load_dwordx4 v248, s[12:15], s37 offen lds
  v_mfma_f32_16x16x32_bf16 v[172:175], v[192:195], v[72:75], v[172:175]
  ds_read_b64_tr_b16 v[190:191], v245 offset:10240
  s_waitcnt lgkmcnt(6)
  v_mfma_f32_16x16x32_bf16 v[160:163], v[176:179], v[4:7], v[160:163]
  ds_read_b64_tr_b16 v[192:193], v244 offset:12288
  v_mfma_f32_16x16x32_bf16 v[164:167], v[176:179], v[76:79], v[164:167]
  ds_read_b64_tr_b16 v[194:195], v244 offset:14336
  s_add_u32 m0, s38, 106496
  s_add_u32 s37, s39, 2359808
  buffer_load_dwordx4 v248, s[12:15], s37 offen lds
  s_waitcnt lgkmcnt(6)
  v_mfma_f32_16x16x32_bf16 v[168:171], v[180:183], v[4:7], v[168:171]
  ds_read_b64_tr_b16 v[176:177], v245 offset:12288
  v_mul_f32 v249, v144, v144
  v_mul_f32 v250, v145, v145
  v_mul_f32 v251, v146, v146
  v_mfma_f32_16x16x32_bf16 v[172:175], v[180:183], v[76:79], v[172:175]
  ds_read_b64_tr_b16 v[178:179], v245 offset:14336
  v_mul_f32 v252, v147, v147
  v_fma_f32 v249, v249, s44, v253
  s_waitcnt lgkmcnt(6)
  v_mfma_f32_16x16x32_bf16 v[160:163], v[184:187], v[8:11], v[160:163]
  ds_read_b64_tr_b16 v[180:181], v244 offset:16384
  s_add_u32 m0, s38, 114688
  s_add_u32 s37, s39, 2949632
  buffer_load_dwordx4 v248, s[12:15], s37 offen lds
  v_fma_f32 v250, v250, s44, v253
  v_fma_f32 v251, v251, s44, v253
  v_fma_f32 v252, v252, s44, v253
  v_mfma_f32_16x16x32_bf16 v[164:167], v[184:187], v[80:83], v[164:167]
  ds_read_b64_tr_b16 v[182:183], v244 offset:18432
  v_mul_f32 v249, v144, v249
  v_mul_f32 v250, v145, v250
  s_waitcnt lgkmcnt(6)
  v_mfma_f32_16x16x32_bf16 v[168:171], v[188:191], v[8:11], v[168:171]
  ds_read_b64_tr_b16 v[184:185], v245 offset:16384
  v_mul_f32 v251, v146, v251
  v_mul_f32 v252, v147, v252
  v_mfma_f32_16x16x32_bf16 v[172:175], v[188:191], v[80:83], v[172:175]
  ds_read_b64_tr_b16 v[186:187], v245 offset:18432
  s_add_u32 m0, s38, 122880
  s_add_u32 s37, s39, 3539456
  buffer_load_dwordx4 v248, s[12:15], s37 offen lds
  v_exp_f32 v249, v249
  v_exp_f32 v250, v250
  v_exp_f32 v251, v251
  s_waitcnt lgkmcnt(6)
  v_mfma_f32_16x16x32_bf16 v[160:163], v[192:195], v[12:15], v[160:163]
  ds_read_b64_tr_b16 v[188:189], v244 offset:20480
  v_exp_f32 v252, v252
  v_add_f32 v249, 1.0, v249
  v_mfma_f32_16x16x32_bf16 v[164:167], v[192:195], v[84:87], v[164:167]
  ds_read_b64_tr_b16 v[190:191], v244 offset:22528
  v_add_f32 v250, 1.0, v250
  v_add_f32 v251, 1.0, v251
  s_waitcnt lgkmcnt(6)
  v_mfma_f32_16x16x32_bf16 v[168:171], v[176:179], v[12:15], v[168:171]
  ds_read_b64_tr_b16 v[192:193], v245 offset:20480
  s_add_u32 m0, s38, 131072
  s_add_u32 s37, s39, 4129280
  buffer_load_dwordx4 v248, s[12:15], s37 offen lds
  v_add_f32 v252, 1.0, v252
  v_rcp_f32 v249, v249
  v_rcp_f32 v250, v250
  v_mfma_f32_16x16x32_bf16 v[172:175], v[176:179], v[84:87], v[172:175]
  ds_read_b64_tr_b16 v[194:195], v245 offset:22528
  v_rcp_f32 v251, v251
  v_rcp_f32 v252, v252
  s_waitcnt lgkmcnt(6)
  v_mfma_f32_16x16x32_bf16 v[160:163], v[180:183], v[16:19], v[160:163]
  ds_read_b64_tr_b16 v[176:177], v244 offset:24576
  v_mul_f32 v144, v144, v249
  v_mul_f32 v145, v145, v250
  v_mfma_f32_16x16x32_bf16 v[164:167], v[180:183], v[88:91], v[164:167]
  ds_read_b64_tr_b16 v[178:179], v244 offset:26624
  s_add_u32 m0, s38, 139264
  s_add_u32 s37, s39, 4719104
  buffer_load_dwordx4 v248, s[12:15], s37 offen lds
  v_mul_f32 v146, v146, v251
  v_mul_f32 v147, v147, v252
  v_cvt_pk_bf16_f32 v212, v144, v145
  s_waitcnt lgkmcnt(6)
  v_mfma_f32_16x16x32_bf16 v[168:171], v[184:187], v[16:19], v[168:171]
  ds_read_b64_tr_b16 v[180:181], v245 offset:24576
  v_cvt_pk_bf16_f32 v213, v146, v147
  v_mul_f32 v249, v148, v148
  v_mfma_f32_16x16x32_bf16 v[172:175], v[184:187], v[88:91], v[172:175]
  ds_read_b64_tr_b16 v[182:183], v245 offset:26624
  v_mul_f32 v250, v149, v149
  v_mul_f32 v251, v150, v150
  s_waitcnt lgkmcnt(6)
  v_mfma_f32_16x16x32_bf16 v[160:163], v[188:191], v[20:23], v[160:163]
  ds_read_b64_tr_b16 v[184:185], v244 offset:28672
  v_mul_f32 v252, v151, v151
  v_fma_f32 v249, v249, s44, v253
  v_fma_f32 v250, v250, s44, v253
  v_mfma_f32_16x16x32_bf16 v[164:167], v[188:191], v[92:95], v[164:167]
  ds_read_b64_tr_b16 v[186:187], v244 offset:30720
  v_fma_f32 v251, v251, s44, v253
  v_fma_f32 v252, v252, s44, v253
  s_waitcnt lgkmcnt(6)
  v_mfma_f32_16x16x32_bf16 v[168:171], v[192:195], v[20:23], v[168:171]
  ds_read_b64_tr_b16 v[188:189], v245 offset:28672
  v_mul_f32 v249, v148, v249
  v_mul_f32 v250, v149, v250
  v_mfma_f32_16x16x32_bf16 v[172:175], v[192:195], v[92:95], v[172:175]
  ds_read_b64_tr_b16 v[190:191], v245 offset:30720
  v_mul_f32 v251, v150, v251
  v_mul_f32 v252, v151, v252
  v_exp_f32 v249, v249
  s_waitcnt lgkmcnt(6)
  v_mfma_f32_16x16x32_bf16 v[160:163], v[176:179], v[24:27], v[160:163]
  ds_read_b64_tr_b16 v[192:193], v244 offset:32768
  v_exp_f32 v250, v250
  v_exp_f32 v251, v251
  v_mfma_f32_16x16x32_bf16 v[164:167], v[176:179], v[96:99], v[164:167]
  ds_read_b64_tr_b16 v[194:195], v244 offset:34816
  v_exp_f32 v252, v252
  v_add_f32 v249, 1.0, v249
  v_add_f32 v250, 1.0, v250
  s_waitcnt lgkmcnt(6)
  v_mfma_f32_16x16x32_bf16 v[168:171], v[180:183], v[24:27], v[168:171]
  ds_read_b64_tr_b16 v[176:177], v245 offset:32768
  v_add_f32 v251, 1.0, v251
  v_add_f32 v252, 1.0, v252
  v_mfma_f32_16x16x32_bf16 v[172:175], v[180:183], v[96:99], v[172:175]
  ds_read_b64_tr_b16 v[178:179], v245 offset:34816
  v_rcp_f32 v249, v249
  v_rcp_f32 v250, v250
  s_waitcnt lgkmcnt(6)
  v_mfma_f32_16x16x32_bf16 v[160:163], v[184:187], v[28:31], v[160:163]
  ds_read_b64_tr_b16 v[180:181], v244 offset:36864
  v_rcp_f32 v251, v251
  v_rcp_f32 v252, v252
  v_mul_f32 v148, v148, v249
  v_mfma_f32_16x16x32_bf16 v[164:167], v[184:187], v[100:103], v[164:167]
  ds_read_b64_tr_b16 v[182:183], v244 offset:38912
  v_mul_f32 v149, v149, v250
  v_mul_f32 v150, v150, v251
  s_waitcnt lgkmcnt(6)
  v_mfma_f32_16x16x32_bf16 v[168:171], v[188:191], v[28:31], v[168:171]
  ds_read_b64_tr_b16 v[184:185], v245 offset:36864
  v_mul_f32 v151, v151, v252
  v_cvt_pk_bf16_f32 v216, v148, v149
  v_mfma_f32_16x16x32_bf16 v[172:175], v[188:191], v[100:103], v[172:175]
  ds_read_b64_tr_b16 v[186:187], v245 offset:38912
  v_cvt_pk_bf16_f32 v217, v150, v151
  v_mul_f32 v249, v152, v152
  v_mul_f32 v250, v153, v153
  s_waitcnt lgkmcnt(6)
  v_mfma_f32_16x16x32_bf16 v[160:163], v[192:195], v[32:35], v[160:163]
  ds_read_b64_tr_b16 v[188:189], v244 offset:40960
  v_mul_f32 v251, v154, v154
  v_mul_f32 v252, v155, v155
  s_mov_b32 m0, 155648
  s_mov_b32 s37, s40
  buffer_load_dword v239, s[16:19], s37 offen lds
  v_mfma_f32_16x16x32_bf16 v[164:167], v[192:195], v[104:107], v[164:167]
  ds_read_b64_tr_b16 v[190:191], v244 offset:43008
  v_fma_f32 v249, v249, s44, v253
  v_fma_f32 v250, v250, s44, v253
  s_waitcnt lgkmcnt(6)
  v_mfma_f32_16x16x32_bf16 v[168:171], v[176:179], v[32:35], v[168:171]
  ds_read_b64_tr_b16 v[192:193], v245 offset:40960
  v_fma_f32 v251, v251, s44, v253
  v_fma_f32 v252, v252, s44, v253
  v_mul_f32 v249, v152, v249
  v_mfma_f32_16x16x32_bf16 v[172:175], v[176:179], v[104:107], v[172:175]
  ds_read_b64_tr_b16 v[194:195], v245 offset:43008
  v_mul_f32 v250, v153, v250
  v_mul_f32 v251, v154, v251
  s_waitcnt lgkmcnt(6)
  v_mfma_f32_16x16x32_bf16 v[160:163], v[180:183], v[36:39], v[160:163]
  ds_read_b64_tr_b16 v[176:177], v244 offset:45056
  v_mul_f32 v252, v155, v252
  v_exp_f32 v249, v249
  v_mfma_f32_16x16x32_bf16 v[164:167], v[180:183], v[108:111], v[164:167]
  ds_read_b64_tr_b16 v[178:179], v244 offset:47104
  v_exp_f32 v250, v250
  v_exp_f32 v251, v251
  v_exp_f32 v252, v252
  s_waitcnt lgkmcnt(6)
  v_mfma_f32_16x16x32_bf16 v[168:171], v[184:187], v[36:39], v[168:171]
  ds_read_b64_tr_b16 v[180:181], v245 offset:45056
  v_add_f32 v249, 1.0, v249
  v_add_f32 v250, 1.0, v250
  v_mfma_f32_16x16x32_bf16 v[172:175], v[184:187], v[108:111], v[172:175]
  ds_read_b64_tr_b16 v[182:183], v245 offset:47104
  v_add_f32 v251, 1.0, v251
  v_add_f32 v252, 1.0, v252
  s_waitcnt lgkmcnt(6)
  v_mfma_f32_16x16x32_bf16 v[160:163], v[188:191], v[40:43], v[160:163]
  ds_read_b64_tr_b16 v[184:185], v244 offset:49152
  v_rcp_f32 v249, v249
  v_rcp_f32 v250, v250
  v_rcp_f32 v251, v251
  v_mfma_f32_16x16x32_bf16 v[164:167], v[188:191], v[112:115], v[164:167]
  ds_read_b64_tr_b16 v[186:187], v244 offset:51200
  v_rcp_f32 v252, v252
  v_mul_f32 v152, v152, v249
  s_waitcnt lgkmcnt(6)
  v_mfma_f32_16x16x32_bf16 v[168:171], v[192:195], v[40:43], v[168:171]
  ds_read_b64_tr_b16 v[188:189], v245 offset:49152
  v_mul_f32 v153, v153, v250
  v_mul_f32 v154, v154, v251
  v_mul_f32 v155, v155, v252
  v_mfma_f32_16x16x32_bf16 v[172:175], v[192:195], v[112:115], v[172:175]
  ds_read_b64_tr_b16 v[190:191], v245 offset:51200
  v_cvt_pk_bf16_f32 v214, v152, v153
  v_cvt_pk_bf16_f32 v215, v154, v155
  s_waitcnt lgkmcnt(6)
  v_mfma_f32_16x16x32_bf16 v[160:163], v[176:179], v[44:47], v[160:163]
  ds_read_b64_tr_b16 v[192:193], v244 offset:53248
  v_mul_f32 v249, v156, v156
  v_mul_f32 v250, v157, v157
  v_mfma_f32_16x16x32_bf16 v[164:167], v[176:179], v[116:119], v[164:167]
  ds_read_b64_tr_b16 v[194:195], v244 offset:55296
  v_mul_f32 v251, v158, v158
  v_mul_f32 v252, v159, v159
  v_fma_f32 v249, v249, s44, v253
  s_waitcnt lgkmcnt(6)
  v_mfma_f32_16x16x32_bf16 v[168:171], v[180:183], v[44:47], v[168:171]
  ds_read_b64_tr_b16 v[176:177], v245 offset:53248
  v_fma_f32 v250, v250, s44, v253
  v_fma_f32 v251, v251, s44, v253
  v_mfma_f32_16x16x32_bf16 v[172:175], v[180:183], v[116:119], v[172:175]
  ds_read_b64_tr_b16 v[178:179], v245 offset:55296
  v_fma_f32 v252, v252, s44, v253
  v_mul_f32 v249, v156, v249
  s_waitcnt lgkmcnt(6)
  v_mfma_f32_16x16x32_bf16 v[160:163], v[184:187], v[48:51], v[160:163]
  ds_read_b64_tr_b16 v[180:181], v244 offset:57344
  v_mul_f32 v250, v157, v250
  v_mul_f32 v251, v158, v251
  v_mul_f32 v252, v159, v252
  v_mfma_f32_16x16x32_bf16 v[164:167], v[184:187], v[120:123], v[164:167]
  ds_read_b64_tr_b16 v[182:183], v244 offset:59392
  v_exp_f32 v249, v249
  v_exp_f32 v250, v250
  s_waitcnt lgkmcnt(6)
  v_mfma_f32_16x16x32_bf16 v[168:171], v[188:191], v[48:51], v[168:171]
  ds_read_b64_tr_b16 v[184:185], v245 offset:57344
  v_exp_f32 v251, v251
  v_exp_f32 v252, v252
  v_mfma_f32_16x16x32_bf16 v[172:175], v[188:191], v[120:123], v[172:175]
  ds_read_b64_tr_b16 v[186:187], v245 offset:59392
  v_add_f32 v249, 1.0, v249
  v_add_f32 v250, 1.0, v250
  v_add_f32 v251, 1.0, v251
  s_waitcnt lgkmcnt(6)
  v_mfma_f32_16x16x32_bf16 v[160:163], v[192:195], v[52:55], v[160:163]
  ds_read_b64_tr_b16 v[188:189], v244 offset:61440
  v_add_f32 v252, 1.0, v252
  v_rcp_f32 v249, v249
  v_mfma_f32_16x16x32_bf16 v[164:167], v[192:195], v[124:127], v[164:167]
  ds_read_b64_tr_b16 v[190:191], v244 offset:63488
  v_rcp_f32 v250, v250
  v_rcp_f32 v251, v251
  s_waitcnt lgkmcnt(6)
  v_mfma_f32_16x16x32_bf16 v[168:171], v[176:179], v[52:55], v[168:171]
  ds_read_b64_tr_b16 v[192:193], v245 offset:61440
  v_rcp_f32 v252, v252
  v_mul_f32 v156, v156, v249
  v_mul_f32 v157, v157, v250
  v_mfma_f32_16x16x32_bf16 v[172:175], v[176:179], v[124:127], v[172:175]
  ds_read_b64_tr_b16 v[194:195], v245 offset:63488
  v_mul_f32 v158, v158, v251
  v_mul_f32 v159, v159, v252
  s_waitcnt lgkmcnt(6)
  v_mfma_f32_16x16x32_bf16 v[160:163], v[180:183], v[56:59], v[160:163]
  ds_read_b64_tr_b16 v[176:177], v246 offset:0
  v_cvt_pk_bf16_f32 v218, v156, v157
  v_cvt_pk_bf16_f32 v219, v158, v159
  v_mfma_f32_16x16x32_bf16 v[164:167], v[180:183], v[128:131], v[164:167]
  ds_read_b64_tr_b16 v[178:179], v246 offset:2048
  s_waitcnt lgkmcnt(6)
  v_mfma_f32_16x16x32_bf16 v[168:171], v[184:187], v[56:59], v[168:171]
  ds_read_b64_tr_b16 v[180:181], v247 offset:0
  ds_read_b128 v[144:147], v254 offset:1024
  v_mfma_f32_16x16x32_bf16 v[172:175], v[184:187], v[128:131], v[172:175]
  ds_read_b64_tr_b16 v[182:183], v247 offset:2048
  ds_read_b128 v[148:151], v254 offset:1024
  s_waitcnt lgkmcnt(8)
  v_mfma_f32_16x16x32_bf16 v[160:163], v[188:191], v[60:63], v[160:163]
  ds_read_b64_tr_b16 v[184:185], v246 offset:4096
  ds_read_b128 v[152:155], v254 offset:1088
  v_mfma_f32_16x16x32_bf16 v[164:167], v[188:191], v[132:135], v[164:167]
  ds_read_b64_tr_b16 v[186:187], v246 offset:6144
  ds_read_b128 v[156:159], v254 offset:1088
  s_waitcnt lgkmcnt(10)
  v_mfma_f32_16x16x32_bf16 v[168:171], v[192:195], v[60:63], v[168:171]
  ds_read_b64_tr_b16 v[188:189], v247 offset:4096
  v_mfma_f32_16x16x32_bf16 v[172:175], v[192:195], v[132:135], v[172:175]
  ds_read_b64_tr_b16 v[190:191], v247 offset:6144
  s_waitcnt lgkmcnt(0)
  s_waitcnt vmcnt(1)
  s_barrier
  v_add_u32 v244, 73728, v244
  v_add_u32 v245, 73728, v245
  v_add_u32 v246, 73728, v246
  v_add_u32 v247, 73728, v247
  v_mfma_f32_16x16x32_bf16 v[160:163], v[176:179], v[64:67], v[160:163]
  ds_read_b64_tr_b16 v[192:193], v244 offset:0
  v_mfma_f32_16x16x32_bf16 v[164:167], v[176:179], v[136:139], v[164:167]
  ds_read_b64_tr_b16 v[194:195], v244 offset:2048
  s_add_u32 m0, s38, 0
  s_add_u32 s37, s39, 640
  buffer_load_dwordx4 v248, s[12:15], s37 offen lds
  v_mfma_f32_16x16x32_bf16 v[168:171], v[180:183], v[64:67], v[168:171]
  ds_read_b64_tr_b16 v[176:177], v245 offset:0
  v_mfma_f32_16x16x32_bf16 v[172:175], v[180:183], v[136:139], v[172:175]
  ds_read_b64_tr_b16 v[178:179], v245 offset:2048
  v_mfma_f32_16x16x32_bf16 v[160:163], v[184:187], v[68:71], v[160:163]
  ds_read_b64_tr_b16 v[180:181], v244 offset:4096
  s_add_u32 m0, s38, 8192
  s_add_u32 s37, s39, 590464
  buffer_load_dwordx4 v248, s[12:15], s37 offen lds
  v_mfma_f32_16x16x32_bf16 v[164:167], v[184:187], v[140:143], v[164:167]
  ds_read_b64_tr_b16 v[182:183], v244 offset:6144
  v_mfma_f32_16x16x32_bf16 v[168:171], v[188:191], v[68:71], v[168:171]
  ds_read_b64_tr_b16 v[184:185], v245 offset:4096
  v_mfma_f32_16x16x32_bf16 v[172:175], v[188:191], v[140:143], v[172:175]
  ds_read_b64_tr_b16 v[186:187], v245 offset:6144
  s_add_u32 m0, s38, 16384
  s_add_u32 s37, s39, 1180288
  buffer_load_dwordx4 v248, s[12:15], s37 offen lds
  s_waitcnt lgkmcnt(6)
  v_mfma_f32_16x16x32_bf16 v[144:147], v[192:195], v[0:3], v[144:147]
  ds_read_b64_tr_b16 v[188:189], v244 offset:8192
  v_mfma_f32_16x16x32_bf16 v[148:151], v[192:195], v[72:75], v[148:151]
  ds_read_b64_tr_b16 v[190:191], v244 offset:10240
  s_waitcnt lgkmcnt(6)
  v_mfma_f32_16x16x32_bf16 v[152:155], v[176:179], v[0:3], v[152:155]
  ds_read_b64_tr_b16 v[192:193], v245 offset:8192
  s_add_u32 m0, s38, 24576
  s_add_u32 s37, s39, 1770112
  buffer_load_dwordx4 v248, s[12:15], s37 offen lds
  v_mfma_f32_16x16x32_bf16 v[156:159], v[176:179], v[72:75], v[156:159]
  ds_read_b64_tr_b16 v[194:195], v245 offset:10240
  s_waitcnt lgkmcnt(6)
  v_mfma_f32_16x16x32_bf16 v[144:147], v[180:183], v[4:7], v[144:147]
  ds_read_b64_tr_b16 v[176:177], v244 offset:12288
  v_mfma_f32_16x16x32_bf16 v[148:151], v[180:183], v[76:79], v[148:151]
  ds_read_b64_tr_b16 v[178:179], v244 offset:14336
  s_add_u32 m0, s38, 32768
  s_add_u32 s37, s39, 2359936
  buffer_load_dwordx4 v248, s[12:15], s37 offen lds
  s_waitcnt lgkmcnt(6)
  v_mfma_f32_16x16x32_bf16 v[152:155], v[184:187], v[4:7], v[152:155]
  ds_read_b64_tr_b16 v[180:181], v245 offset:12288
  v_mul_f32 v249, v160, v160
  v_mul_f32 v250, v161, v161
  v_mul_f32 v251, v162, v162
  v_mfma_f32_16x16x32_bf16 v[156:159], v[184:187], v[76:79], v[156:159]
  ds_read_b64_tr_b16 v[182:183], v245 offset:14336
  v_mul_f32 v252, v163, v163
  v_fma_f32 v249, v249, s44, v253
  s_waitcnt lgkmcnt(6)
  v_mfma_f32_16x16x32_bf16 v[144:147], v[188:191], v[8:11], v[144:147]
  ds_read_b64_tr_b16 v[184:185], v244 offset:16384
  s_add_u32 m0, s38, 40960
  s_add_u32 s37, s39, 2949760
  buffer_load_dwordx4 v248, s[12:15], s37 offen lds
  v_fma_f32 v250, v250, s44, v253
  v_fma_f32 v251, v251, s44, v253
  v_fma_f32 v252, v252, s44, v253
  v_mfma_f32_16x16x32_bf16 v[148:151], v[188:191], v[80:83], v[148:151]
  ds_read_b64_tr_b16 v[186:187], v244 offset:18432
  v_mul_f32 v249, v160, v249
  v_mul_f32 v250, v161, v250
  s_waitcnt lgkmcnt(6)
  v_mfma_f32_16x16x32_bf16 v[152:155], v[192:195], v[8:11], v[152:155]
  ds_read_b64_tr_b16 v[188:189], v245 offset:16384
  v_mul_f32 v251, v162, v251
  v_mul_f32 v252, v163, v252
  v_mfma_f32_16x16x32_bf16 v[156:159], v[192:195], v[80:83], v[156:159]
  ds_read_b64_tr_b16 v[190:191], v245 offset:18432
  s_add_u32 m0, s38, 49152
  s_add_u32 s37, s39, 3539584
  buffer_load_dwordx4 v248, s[12:15], s37 offen lds
  v_exp_f32 v249, v249
  v_exp_f32 v250, v250
  v_exp_f32 v251, v251
  s_waitcnt lgkmcnt(6)
  v_mfma_f32_16x16x32_bf16 v[144:147], v[176:179], v[12:15], v[144:147]
  ds_read_b64_tr_b16 v[192:193], v244 offset:20480
  v_exp_f32 v252, v252
  v_add_f32 v249, 1.0, v249
  v_mfma_f32_16x16x32_bf16 v[148:151], v[176:179], v[84:87], v[148:151]
  ds_read_b64_tr_b16 v[194:195], v244 offset:22528
  v_add_f32 v250, 1.0, v250
  v_add_f32 v251, 1.0, v251
  s_waitcnt lgkmcnt(6)
  v_mfma_f32_16x16x32_bf16 v[152:155], v[180:183], v[12:15], v[152:155]
  ds_read_b64_tr_b16 v[176:177], v245 offset:20480
  s_add_u32 m0, s38, 57344
  s_add_u32 s37, s39, 4129408
  buffer_load_dwordx4 v248, s[12:15], s37 offen lds
  v_add_f32 v252, 1.0, v252
  v_rcp_f32 v249, v249
  v_rcp_f32 v250, v250
  v_mfma_f32_16x16x32_bf16 v[156:159], v[180:183], v[84:87], v[156:159]
  ds_read_b64_tr_b16 v[178:179], v245 offset:22528
  v_rcp_f32 v251, v251
  v_rcp_f32 v252, v252
  s_waitcnt lgkmcnt(6)
  v_mfma_f32_16x16x32_bf16 v[144:147], v[184:187], v[16:19], v[144:147]
  ds_read_b64_tr_b16 v[180:181], v244 offset:24576
  v_mul_f32 v160, v160, v249
  v_mul_f32 v161, v161, v250
  v_mfma_f32_16x16x32_bf16 v[148:151], v[184:187], v[88:91], v[148:151]
  ds_read_b64_tr_b16 v[182:183], v244 offset:26624
  s_add_u32 m0, s38, 65536
  s_add_u32 s37, s39, 4719232
  buffer_load_dwordx4 v248, s[12:15], s37 offen lds
  v_mul_f32 v162, v162, v251
  v_mul_f32 v163, v163, v252
  v_cvt_pk_bf16_f32 v220, v160, v161
  s_waitcnt lgkmcnt(6)
  v_mfma_f32_16x16x32_bf16 v[152:155], v[188:191], v[16:19], v[152:155]
  ds_read_b64_tr_b16 v[184:185], v245 offset:24576
  v_cvt_pk_bf16_f32 v221, v162, v163
  v_mul_f32 v249, v164, v164
  v_mfma_f32_16x16x32_bf16 v[156:159], v[188:191], v[88:91], v[156:159]
  ds_read_b64_tr_b16 v[186:187], v245 offset:26624
  v_mul_f32 v250, v165, v165
  v_mul_f32 v251, v166, v166
  s_waitcnt lgkmcnt(6)
  v_mfma_f32_16x16x32_bf16 v[144:147], v[192:195], v[20:23], v[144:147]
  ds_read_b64_tr_b16 v[188:189], v244 offset:28672
  v_mul_f32 v252, v167, v167
  v_fma_f32 v249, v249, s44, v253
  v_fma_f32 v250, v250, s44, v253
  v_mfma_f32_16x16x32_bf16 v[148:151], v[192:195], v[92:95], v[148:151]
  ds_read_b64_tr_b16 v[190:191], v244 offset:30720
  v_fma_f32 v251, v251, s44, v253
  v_fma_f32 v252, v252, s44, v253
  s_waitcnt lgkmcnt(6)
  v_mfma_f32_16x16x32_bf16 v[152:155], v[176:179], v[20:23], v[152:155]
  ds_read_b64_tr_b16 v[192:193], v245 offset:28672
  v_mul_f32 v249, v164, v249
  v_mul_f32 v250, v165, v250
  v_mfma_f32_16x16x32_bf16 v[156:159], v[176:179], v[92:95], v[156:159]
  ds_read_b64_tr_b16 v[194:195], v245 offset:30720
  v_mul_f32 v251, v166, v251
  v_mul_f32 v252, v167, v252
  v_exp_f32 v249, v249
  s_waitcnt lgkmcnt(6)
  v_mfma_f32_16x16x32_bf16 v[144:147], v[180:183], v[24:27], v[144:147]
  ds_read_b64_tr_b16 v[176:177], v244 offset:32768
  v_exp_f32 v250, v250
  v_exp_f32 v251, v251
  v_mfma_f32_16x16x32_bf16 v[148:151], v[180:183], v[96:99], v[148:151]
  ds_read_b64_tr_b16 v[178:179], v244 offset:34816
  v_exp_f32 v252, v252
  v_add_f32 v249, 1.0, v249
  v_add_f32 v250, 1.0, v250
  s_waitcnt lgkmcnt(6)
  v_mfma_f32_16x16x32_bf16 v[152:155], v[184:187], v[24:27], v[152:155]
  ds_read_b64_tr_b16 v[180:181], v245 offset:32768
  v_add_f32 v251, 1.0, v251
  v_add_f32 v252, 1.0, v252
  v_mfma_f32_16x16x32_bf16 v[156:159], v[184:187], v[96:99], v[156:159]
  ds_read_b64_tr_b16 v[182:183], v245 offset:34816
  v_rcp_f32 v249, v249
  v_rcp_f32 v250, v250
  s_waitcnt lgkmcnt(6)
  v_mfma_f32_16x16x32_bf16 v[144:147], v[188:191], v[28:31], v[144:147]
  ds_read_b64_tr_b16 v[184:185], v244 offset:36864
  v_rcp_f32 v251, v251
  v_rcp_f32 v252, v252
  v_mul_f32 v164, v164, v249
  v_mfma_f32_16x16x32_bf16 v[148:151], v[188:191], v[100:103], v[148:151]
  ds_read_b64_tr_b16 v[186:187], v244 offset:38912
  v_mul_f32 v165, v165, v250
  v_mul_f32 v166, v166, v251
  s_waitcnt lgkmcnt(6)
  v_mfma_f32_16x16x32_bf16 v[152:155], v[192:195], v[28:31], v[152:155]
  ds_read_b64_tr_b16 v[188:189], v245 offset:36864
  v_mul_f32 v167, v167, v252
  v_cvt_pk_bf16_f32 v224, v164, v165
  v_mfma_f32_16x16x32_bf16 v[156:159], v[192:195], v[100:103], v[156:159]
  ds_read_b64_tr_b16 v[190:191], v245 offset:38912
  v_cvt_pk_bf16_f32 v225, v166, v167
  v_mul_f32 v249, v168, v168
  v_mul_f32 v250, v169, v169
  s_waitcnt lgkmcnt(6)
  v_mfma_f32_16x16x32_bf16 v[144:147], v[176:179], v[32:35], v[144:147]
  ds_read_b64_tr_b16 v[192:193], v244 offset:40960
  v_mul_f32 v251, v170, v170
  v_mul_f32 v252, v171, v171
  v_mfma_f32_16x16x32_bf16 v[148:151], v[176:179], v[104:107], v[148:151]
  ds_read_b64_tr_b16 v[194:195], v244 offset:43008
  v_fma_f32 v249, v249, s44, v253
  v_fma_f32 v250, v250, s44, v253
  s_waitcnt lgkmcnt(6)
  v_mfma_f32_16x16x32_bf16 v[152:155], v[180:183], v[32:35], v[152:155]
  ds_read_b64_tr_b16 v[176:177], v245 offset:40960
  v_fma_f32 v251, v251, s44, v253
  v_fma_f32 v252, v252, s44, v253
  v_mul_f32 v249, v168, v249
  v_mfma_f32_16x16x32_bf16 v[156:159], v[180:183], v[104:107], v[156:159]
  ds_read_b64_tr_b16 v[178:179], v245 offset:43008
  v_mul_f32 v250, v169, v250
  v_mul_f32 v251, v170, v251
  s_waitcnt lgkmcnt(6)
  v_mfma_f32_16x16x32_bf16 v[144:147], v[184:187], v[36:39], v[144:147]
  ds_read_b64_tr_b16 v[180:181], v244 offset:45056
  v_mul_f32 v252, v171, v252
  v_exp_f32 v249, v249
  v_mfma_f32_16x16x32_bf16 v[148:151], v[184:187], v[108:111], v[148:151]
  ds_read_b64_tr_b16 v[182:183], v244 offset:47104
  v_exp_f32 v250, v250
  v_exp_f32 v251, v251
  v_exp_f32 v252, v252
  s_waitcnt lgkmcnt(6)
  v_mfma_f32_16x16x32_bf16 v[152:155], v[188:191], v[36:39], v[152:155]
  ds_read_b64_tr_b16 v[184:185], v245 offset:45056
  v_add_f32 v249, 1.0, v249
  v_add_f32 v250, 1.0, v250
  v_mfma_f32_16x16x32_bf16 v[156:159], v[188:191], v[108:111], v[156:159]
  ds_read_b64_tr_b16 v[186:187], v245 offset:47104
  v_add_f32 v251, 1.0, v251
  v_add_f32 v252, 1.0, v252
  s_waitcnt lgkmcnt(6)
  v_mfma_f32_16x16x32_bf16 v[144:147], v[192:195], v[40:43], v[144:147]
  ds_read_b64_tr_b16 v[188:189], v244 offset:49152
  v_rcp_f32 v249, v249
  v_rcp_f32 v250, v250
  v_rcp_f32 v251, v251
  v_mfma_f32_16x16x32_bf16 v[148:151], v[192:195], v[112:115], v[148:151]
  ds_read_b64_tr_b16 v[190:191], v244 offset:51200
  v_rcp_f32 v252, v252
  v_mul_f32 v168, v168, v249
  s_waitcnt lgkmcnt(6)
  v_mfma_f32_16x16x32_bf16 v[152:155], v[176:179], v[40:43], v[152:155]
  ds_read_b64_tr_b16 v[192:193], v245 offset:49152
  v_mul_f32 v169, v169, v250
  v_mul_f32 v170, v170, v251
  v_mul_f32 v171, v171, v252
  v_mfma_f32_16x16x32_bf16 v[156:159], v[176:179], v[112:115], v[156:159]
  ds_read_b64_tr_b16 v[194:195], v245 offset:51200
  v_cvt_pk_bf16_f32 v222, v168, v169
  v_cvt_pk_bf16_f32 v223, v170, v171
  s_waitcnt lgkmcnt(6)
  v_mfma_f32_16x16x32_bf16 v[144:147], v[180:183], v[44:47], v[144:147]
  ds_read_b64_tr_b16 v[176:177], v244 offset:53248
  v_mul_f32 v249, v172, v172
  v_mul_f32 v250, v173, v173
  v_mfma_f32_16x16x32_bf16 v[148:151], v[180:183], v[116:119], v[148:151]
  ds_read_b64_tr_b16 v[178:179], v244 offset:55296
  v_mul_f32 v251, v174, v174
  v_mul_f32 v252, v175, v175
  v_fma_f32 v249, v249, s44, v253
  s_waitcnt lgkmcnt(6)
  v_mfma_f32_16x16x32_bf16 v[152:155], v[184:187], v[44:47], v[152:155]
  ds_read_b64_tr_b16 v[180:181], v245 offset:53248
  v_fma_f32 v250, v250, s44, v253
  v_fma_f32 v251, v251, s44, v253
  v_mfma_f32_16x16x32_bf16 v[156:159], v[184:187], v[116:119], v[156:159]
  ds_read_b64_tr_b16 v[182:183], v245 offset:55296
  v_fma_f32 v252, v252, s44, v253
  v_mul_f32 v249, v172, v249
  s_waitcnt lgkmcnt(6)
  v_mfma_f32_16x16x32_bf16 v[144:147], v[188:191], v[48:51], v[144:147]
  ds_read_b64_tr_b16 v[184:185], v244 offset:57344
  v_mul_f32 v250, v173, v250
  v_mul_f32 v251, v174, v251
  v_mul_f32 v252, v175, v252
  v_mfma_f32_16x16x32_bf16 v[148:151], v[188:191], v[120:123], v[148:151]
  ds_read_b64_tr_b16 v[186:187], v244 offset:59392
  v_exp_f32 v249, v249
  v_exp_f32 v250, v250
  s_waitcnt lgkmcnt(6)
  v_mfma_f32_16x16x32_bf16 v[152:155], v[192:195], v[48:51], v[152:155]
  ds_read_b64_tr_b16 v[188:189], v245 offset:57344
  v_exp_f32 v251, v251
  v_exp_f32 v252, v252
  v_mfma_f32_16x16x32_bf16 v[156:159], v[192:195], v[120:123], v[156:159]
  ds_read_b64_tr_b16 v[190:191], v245 offset:59392
  v_add_f32 v249, 1.0, v249
  v_add_f32 v250, 1.0, v250
  v_add_f32 v251, 1.0, v251
  s_waitcnt lgkmcnt(6)
  v_mfma_f32_16x16x32_bf16 v[144:147], v[176:179], v[52:55], v[144:147]
  ds_read_b64_tr_b16 v[192:193], v244 offset:61440
  v_add_f32 v252, 1.0, v252
  v_rcp_f32 v249, v249
  v_mfma_f32_16x16x32_bf16 v[148:151], v[176:179], v[124:127], v[148:151]
  ds_read_b64_tr_b16 v[194:195], v244 offset:63488
  v_rcp_f32 v250, v250
  v_rcp_f32 v251, v251
  s_waitcnt lgkmcnt(6)
  v_mfma_f32_16x16x32_bf16 v[152:155], v[180:183], v[52:55], v[152:155]
  ds_read_b64_tr_b16 v[176:177], v245 offset:61440
  v_rcp_f32 v252, v252
  v_mul_f32 v172, v172, v249
  v_mul_f32 v173, v173, v250
  v_mfma_f32_16x16x32_bf16 v[156:159], v[180:183], v[124:127], v[156:159]
  ds_read_b64_tr_b16 v[178:179], v245 offset:63488
  v_mul_f32 v174, v174, v251
  v_mul_f32 v175, v175, v252
  s_waitcnt lgkmcnt(6)
  v_mfma_f32_16x16x32_bf16 v[144:147], v[184:187], v[56:59], v[144:147]
  ds_read_b64_tr_b16 v[180:181], v246 offset:0
  v_cvt_pk_bf16_f32 v226, v172, v173
  v_cvt_pk_bf16_f32 v227, v174, v175
  v_mfma_f32_16x16x32_bf16 v[148:151], v[184:187], v[128:131], v[148:151]
  ds_read_b64_tr_b16 v[182:183], v246 offset:2048
  s_waitcnt lgkmcnt(6)
  v_mfma_f32_16x16x32_bf16 v[152:155], v[188:191], v[56:59], v[152:155]
  ds_read_b64_tr_b16 v[184:185], v247 offset:0
  ds_read_b128 v[160:163], v254 offset:1280
  v_mfma_f32_16x16x32_bf16 v[156:159], v[188:191], v[128:131], v[156:159]
  ds_read_b64_tr_b16 v[186:187], v247 offset:2048
  ds_read_b128 v[164:167], v254 offset:1280
  s_waitcnt lgkmcnt(8)
  v_mfma_f32_16x16x32_bf16 v[144:147], v[192:195], v[60:63], v[144:147]
  ds_read_b64_tr_b16 v[188:189], v246 offset:4096
  ds_read_b128 v[168:171], v254 offset:1344
  v_mfma_f32_16x16x32_bf16 v[148:151], v[192:195], v[132:135], v[148:151]
  ds_read_b64_tr_b16 v[190:191], v246 offset:6144
  ds_read_b128 v[172:175], v254 offset:1344
  s_waitcnt lgkmcnt(10)
  v_mfma_f32_16x16x32_bf16 v[152:155], v[176:179], v[60:63], v[152:155]
  ds_read_b64_tr_b16 v[192:193], v247 offset:4096
  v_mfma_f32_16x16x32_bf16 v[156:159], v[176:179], v[132:135], v[156:159]
  ds_read_b64_tr_b16 v[194:195], v247 offset:6144
  s_waitcnt lgkmcnt(0)
  s_waitcnt vmcnt(0)
  s_barrier
  v_add_u32 v244, 4294893568, v244
  v_add_u32 v245, 4294893568, v245
  v_add_u32 v246, 4294893568, v246
  v_add_u32 v247, 4294893568, v247
  v_mfma_f32_16x16x32_bf16 v[144:147], v[180:183], v[64:67], v[144:147]
  ds_read_b64_tr_b16 v[176:177], v244 offset:0
  v_mfma_f32_16x16x32_bf16 v[148:151], v[180:183], v[136:139], v[148:151]
  ds_read_b64_tr_b16 v[178:179], v244 offset:2048
  s_add_u32 m0, s38, 98304
  s_add_u32 s37, s40, 0
  buffer_load_dwordx4 v243, s[16:19], s37 offen lds
  v_mfma_f32_16x16x32_bf16 v[152:155], v[184:187], v[64:67], v[152:155]
  ds_read_b64_tr_b16 v[180:181], v245 offset:0
  v_mfma_f32_16x16x32_bf16 v[156:159], v[184:187], v[136:139], v[156:159]
  ds_read_b64_tr_b16 v[182:183], v245 offset:2048
  v_mfma_f32_16x16x32_bf16 v[144:147], v[188:191], v[68:71], v[144:147]
  ds_read_b64_tr_b16 v[184:185], v244 offset:4096
  s_add_u32 m0, s38, 106496
  s_add_u32 s37, s40, 73728
  buffer_load_dwordx4 v243, s[16:19], s37 offen lds
  v_mfma_f32_16x16x32_bf16 v[148:151], v[188:191], v[140:143], v[148:151]
  ds_read_b64_tr_b16 v[186:187], v244 offset:6144
  v_mfma_f32_16x16x32_bf16 v[152:155], v[192:195], v[68:71], v[152:155]
  ds_read_b64_tr_b16 v[188:189], v245 offset:4096
  v_mfma_f32_16x16x32_bf16 v[156:159], v[192:195], v[140:143], v[156:159]
  ds_read_b64_tr_b16 v[190:191], v245 offset:6144
  s_add_u32 m0, s38, 114688
  s_add_u32 s37, s40, 147456
  buffer_load_dwordx4 v243, s[16:19], s37 offen lds
  s_waitcnt lgkmcnt(6)
  v_mfma_f32_16x16x32_bf16 v[160:163], v[176:179], v[0:3], v[160:163]
  ds_read_b64_tr_b16 v[192:193], v244 offset:8192
  v_mfma_f32_16x16x32_bf16 v[164:167], v[176:179], v[72:75], v[164:167]
  ds_read_b64_tr_b16 v[194:195], v244 offset:10240
  s_waitcnt lgkmcnt(6)
  v_mfma_f32_16x16x32_bf16 v[168:171], v[180:183], v[0:3], v[168:171]
  ds_read_b64_tr_b16 v[176:177], v245 offset:8192
  s_add_u32 m0, s38, 122880
  s_add_u32 s37, s40, 221184
  buffer_load_dwordx4 v243, s[16:19], s37 offen lds
  v_mfma_f32_16x16x32_bf16 v[172:175], v[180:183], v[72:75], v[172:175]
  ds_read_b64_tr_b16 v[178:179], v245 offset:10240
  s_waitcnt lgkmcnt(6)
  v_mfma_f32_16x16x32_bf16 v[160:163], v[184:187], v[4:7], v[160:163]
  ds_read_b64_tr_b16 v[180:181], v244 offset:12288
  v_mfma_f32_16x16x32_bf16 v[164:167], v[184:187], v[76:79], v[164:167]
  ds_read_b64_tr_b16 v[182:183], v244 offset:14336
  s_add_u32 m0, s38, 131072
  s_add_u32 s37, s40, 294912
  buffer_load_dwordx4 v243, s[16:19], s37 offen lds
  s_waitcnt lgkmcnt(6)
  v_mfma_f32_16x16x32_bf16 v[168:171], v[188:191], v[4:7], v[168:171]
  ds_read_b64_tr_b16 v[184:185], v245 offset:12288
  v_mul_f32 v249, v144, v144
  v_mul_f32 v250, v145, v145
  v_mul_f32 v251, v146, v146
  v_mfma_f32_16x16x32_bf16 v[172:175], v[188:191], v[76:79], v[172:175]
  ds_read_b64_tr_b16 v[186:187], v245 offset:14336
  v_mul_f32 v252, v147, v147
  v_fma_f32 v249, v249, s44, v253
  s_waitcnt lgkmcnt(6)
  v_mfma_f32_16x16x32_bf16 v[160:163], v[192:195], v[8:11], v[160:163]
  ds_read_b64_tr_b16 v[188:189], v244 offset:16384
  s_add_u32 m0, s38, 139264
  s_add_u32 s37, s40, 368640
  buffer_load_dwordx4 v243, s[16:19], s37 offen lds
  v_fma_f32 v250, v250, s44, v253
  v_fma_f32 v251, v251, s44, v253
  v_fma_f32 v252, v252, s44, v253
  v_mfma_f32_16x16x32_bf16 v[164:167], v[192:195], v[80:83], v[164:167]
  ds_read_b64_tr_b16 v[190:191], v244 offset:18432
  v_mul_f32 v249, v144, v249
  v_mul_f32 v250, v145, v250
  s_waitcnt lgkmcnt(6)
  v_mfma_f32_16x16x32_bf16 v[168:171], v[176:179], v[8:11], v[168:171]
  ds_read_b64_tr_b16 v[192:193], v245 offset:16384
  v_mul_f32 v251, v146, v251
  v_mul_f32 v252, v147, v252
  v_mfma_f32_16x16x32_bf16 v[172:175], v[176:179], v[80:83], v[172:175]
  ds_read_b64_tr_b16 v[194:195], v245 offset:18432
  v_exp_f32 v249, v249
  v_exp_f32 v250, v250
  v_exp_f32 v251, v251
  s_waitcnt lgkmcnt(6)
  v_mfma_f32_16x16x32_bf16 v[160:163], v[180:183], v[12:15], v[160:163]
  ds_read_b64_tr_b16 v[176:177], v244 offset:20480
  v_exp_f32 v252, v252
  v_add_f32 v249, 1.0, v249
  v_mfma_f32_16x16x32_bf16 v[164:167], v[180:183], v[84:87], v[164:167]
  ds_read_b64_tr_b16 v[178:179], v244 offset:22528
  v_add_f32 v250, 1.0, v250
  v_add_f32 v251, 1.0, v251
  s_waitcnt lgkmcnt(6)
  v_mfma_f32_16x16x32_bf16 v[168:171], v[184:187], v[12:15], v[168:171]
  ds_read_b64_tr_b16 v[180:181], v245 offset:20480
  v_add_f32 v252, 1.0, v252
  v_rcp_f32 v249, v249
  v_rcp_f32 v250, v250
  v_mfma_f32_16x16x32_bf16 v[172:175], v[184:187], v[84:87], v[172:175]
  ds_read_b64_tr_b16 v[182:183], v245 offset:22528
  v_rcp_f32 v251, v251
  v_rcp_f32 v252, v252
  s_waitcnt lgkmcnt(6)
  v_mfma_f32_16x16x32_bf16 v[160:163], v[188:191], v[16:19], v[160:163]
  ds_read_b64_tr_b16 v[184:185], v244 offset:24576
  v_mul_f32 v144, v144, v249
  v_mul_f32 v145, v145, v250
  v_mfma_f32_16x16x32_bf16 v[164:167], v[188:191], v[88:91], v[164:167]
  ds_read_b64_tr_b16 v[186:187], v244 offset:26624
  v_mul_f32 v146, v146, v251
  v_mul_f32 v147, v147, v252
  v_cvt_pk_bf16_f32 v228, v144, v145
  s_waitcnt lgkmcnt(6)
  v_mfma_f32_16x16x32_bf16 v[168:171], v[192:195], v[16:19], v[168:171]
  ds_read_b64_tr_b16 v[188:189], v245 offset:24576
  v_cvt_pk_bf16_f32 v229, v146, v147
  v_mul_f32 v249, v148, v148
  v_mfma_f32_16x16x32_bf16 v[172:175], v[192:195], v[88:91], v[172:175]
  ds_read_b64_tr_b16 v[190:191], v245 offset:26624
  v_mul_f32 v250, v149, v149
  v_mul_f32 v251, v150, v150
  s_waitcnt lgkmcnt(6)
  v_mfma_f32_16x16x32_bf16 v[160:163], v[176:179], v[20:23], v[160:163]
  ds_read_b64_tr_b16 v[192:193], v244 offset:28672
  v_mul_f32 v252, v151, v151
  v_fma_f32 v249, v249, s44, v253
  v_fma_f32 v250, v250, s44, v253
  v_mfma_f32_16x16x32_bf16 v[164:167], v[176:179], v[92:95], v[164:167]
  ds_read_b64_tr_b16 v[194:195], v244 offset:30720
  v_fma_f32 v251, v251, s44, v253
  v_fma_f32 v252, v252, s44, v253
  s_waitcnt lgkmcnt(6)
  v_mfma_f32_16x16x32_bf16 v[168:171], v[180:183], v[20:23], v[168:171]
  ds_read_b64_tr_b16 v[176:177], v245 offset:28672
  v_mul_f32 v249, v148, v249
  v_mul_f32 v250, v149, v250
  v_mfma_f32_16x16x32_bf16 v[172:175], v[180:183], v[92:95], v[172:175]
  ds_read_b64_tr_b16 v[178:179], v245 offset:30720
  v_mul_f32 v251, v150, v251
  v_mul_f32 v252, v151, v252
  v_exp_f32 v249, v249
  s_waitcnt lgkmcnt(6)
  v_mfma_f32_16x16x32_bf16 v[160:163], v[184:187], v[24:27], v[160:163]
  ds_read_b64_tr_b16 v[180:181], v244 offset:32768
  v_exp_f32 v250, v250
  v_exp_f32 v251, v251
  v_mfma_f32_16x16x32_bf16 v[164:167], v[184:187], v[96:99], v[164:167]
  ds_read_b64_tr_b16 v[182:183], v244 offset:34816
  v_exp_f32 v252, v252
  v_add_f32 v249, 1.0, v249
  v_add_f32 v250, 1.0, v250
  s_waitcnt lgkmcnt(6)
  v_mfma_f32_16x16x32_bf16 v[168:171], v[188:191], v[24:27], v[168:171]
  ds_read_b64_tr_b16 v[184:185], v245 offset:32768
  v_add_f32 v251, 1.0, v251
  v_add_f32 v252, 1.0, v252
  v_mfma_f32_16x16x32_bf16 v[172:175], v[188:191], v[96:99], v[172:175]
  ds_read_b64_tr_b16 v[186:187], v245 offset:34816
  v_rcp_f32 v249, v249
  v_rcp_f32 v250, v250
  s_waitcnt lgkmcnt(6)
  v_mfma_f32_16x16x32_bf16 v[160:163], v[192:195], v[28:31], v[160:163]
  ds_read_b64_tr_b16 v[188:189], v244 offset:36864
  v_rcp_f32 v251, v251
  v_rcp_f32 v252, v252
  v_mul_f32 v148, v148, v249
  v_mfma_f32_16x16x32_bf16 v[164:167], v[192:195], v[100:103], v[164:167]
  ds_read_b64_tr_b16 v[190:191], v244 offset:38912
  v_mul_f32 v149, v149, v250
  v_mul_f32 v150, v150, v251
  s_waitcnt lgkmcnt(6)
  v_mfma_f32_16x16x32_bf16 v[168:171], v[176:179], v[28:31], v[168:171]
  ds_read_b64_tr_b16 v[192:193], v245 offset:36864
  v_mul_f32 v151, v151, v252
  v_cvt_pk_bf16_f32 v232, v148, v149
  v_mfma_f32_16x16x32_bf16 v[172:175], v[176:179], v[100:103], v[172:175]
  ds_read_b64_tr_b16 v[194:195], v245 offset:38912
  v_cvt_pk_bf16_f32 v233, v150, v151
  v_mul_f32 v249, v152, v152
  v_mul_f32 v250, v153, v153
  s_waitcnt lgkmcnt(6)
  v_mfma_f32_16x16x32_bf16 v[160:163], v[180:183], v[32:35], v[160:163]
  ds_read_b64_tr_b16 v[176:177], v244 offset:40960
  v_mul_f32 v251, v154, v154
  v_mul_f32 v252, v155, v155
  v_mfma_f32_16x16x32_bf16 v[164:167], v[180:183], v[104:107], v[164:167]
  ds_read_b64_tr_b16 v[178:179], v244 offset:43008
  v_fma_f32 v249, v249, s44, v253
  v_fma_f32 v250, v250, s44, v253
  s_waitcnt lgkmcnt(6)
  v_mfma_f32_16x16x32_bf16 v[168:171], v[184:187], v[32:35], v[168:171]
  ds_read_b64_tr_b16 v[180:181], v245 offset:40960
  v_fma_f32 v251, v251, s44, v253
  v_fma_f32 v252, v252, s44, v253
  v_mul_f32 v249, v152, v249
  v_mfma_f32_16x16x32_bf16 v[172:175], v[184:187], v[104:107], v[172:175]
  ds_read_b64_tr_b16 v[182:183], v245 offset:43008
  v_mul_f32 v250, v153, v250
  v_mul_f32 v251, v154, v251
  s_waitcnt lgkmcnt(6)
  v_mfma_f32_16x16x32_bf16 v[160:163], v[188:191], v[36:39], v[160:163]
  ds_read_b64_tr_b16 v[184:185], v244 offset:45056
  v_mul_f32 v252, v155, v252
  v_exp_f32 v249, v249
  v_mfma_f32_16x16x32_bf16 v[164:167], v[188:191], v[108:111], v[164:167]
  ds_read_b64_tr_b16 v[186:187], v244 offset:47104
  v_exp_f32 v250, v250
  v_exp_f32 v251, v251
  v_exp_f32 v252, v252
  s_waitcnt lgkmcnt(6)
  v_mfma_f32_16x16x32_bf16 v[168:171], v[192:195], v[36:39], v[168:171]
  ds_read_b64_tr_b16 v[188:189], v245 offset:45056
  v_add_f32 v249, 1.0, v249
  v_add_f32 v250, 1.0, v250
  v_mfma_f32_16x16x32_bf16 v[172:175], v[192:195], v[108:111], v[172:175]
  ds_read_b64_tr_b16 v[190:191], v245 offset:47104
  v_add_f32 v251, 1.0, v251
  v_add_f32 v252, 1.0, v252
  s_waitcnt lgkmcnt(6)
  v_mfma_f32_16x16x32_bf16 v[160:163], v[176:179], v[40:43], v[160:163]
  ds_read_b64_tr_b16 v[192:193], v244 offset:49152
  v_rcp_f32 v249, v249
  v_rcp_f32 v250, v250
  v_rcp_f32 v251, v251
  v_mfma_f32_16x16x32_bf16 v[164:167], v[176:179], v[112:115], v[164:167]
  ds_read_b64_tr_b16 v[194:195], v244 offset:51200
  v_rcp_f32 v252, v252
  v_mul_f32 v152, v152, v249
  s_waitcnt lgkmcnt(6)
  v_mfma_f32_16x16x32_bf16 v[168:171], v[180:183], v[40:43], v[168:171]
  ds_read_b64_tr_b16 v[176:177], v245 offset:49152
  v_mul_f32 v153, v153, v250
  v_mul_f32 v154, v154, v251
  v_mul_f32 v155, v155, v252
  v_mfma_f32_16x16x32_bf16 v[172:175], v[180:183], v[112:115], v[172:175]
  ds_read_b64_tr_b16 v[178:179], v245 offset:51200
  v_cvt_pk_bf16_f32 v230, v152, v153
  v_cvt_pk_bf16_f32 v231, v154, v155
  s_waitcnt lgkmcnt(6)
  v_mfma_f32_16x16x32_bf16 v[160:163], v[184:187], v[44:47], v[160:163]
  ds_read_b64_tr_b16 v[180:181], v244 offset:53248
  v_mul_f32 v249, v156, v156
  v_mul_f32 v250, v157, v157
  v_mfma_f32_16x16x32_bf16 v[164:167], v[184:187], v[116:119], v[164:167]
  ds_read_b64_tr_b16 v[182:183], v244 offset:55296
  v_mul_f32 v251, v158, v158
  v_mul_f32 v252, v159, v159
  v_fma_f32 v249, v249, s44, v253
  s_waitcnt lgkmcnt(6)
  v_mfma_f32_16x16x32_bf16 v[168:171], v[188:191], v[44:47], v[168:171]
  ds_read_b64_tr_b16 v[184:185], v245 offset:53248
  v_fma_f32 v250, v250, s44, v253
  v_fma_f32 v251, v251, s44, v253
  v_mfma_f32_16x16x32_bf16 v[172:175], v[188:191], v[116:119], v[172:175]
  ds_read_b64_tr_b16 v[186:187], v245 offset:55296
  v_fma_f32 v252, v252, s44, v253
  v_mul_f32 v249, v156, v249
  s_waitcnt lgkmcnt(6)
  v_mfma_f32_16x16x32_bf16 v[160:163], v[192:195], v[48:51], v[160:163]
  ds_read_b64_tr_b16 v[188:189], v244 offset:57344
  v_mul_f32 v250, v157, v250
  v_mul_f32 v251, v158, v251
  v_mul_f32 v252, v159, v252
  v_mfma_f32_16x16x32_bf16 v[164:167], v[192:195], v[120:123], v[164:167]
  ds_read_b64_tr_b16 v[190:191], v244 offset:59392
  v_exp_f32 v249, v249
  v_exp_f32 v250, v250
  s_waitcnt lgkmcnt(6)
  v_mfma_f32_16x16x32_bf16 v[168:171], v[176:179], v[48:51], v[168:171]
  ds_read_b64_tr_b16 v[192:193], v245 offset:57344
  v_exp_f32 v251, v251
  v_exp_f32 v252, v252
  v_mfma_f32_16x16x32_bf16 v[172:175], v[176:179], v[120:123], v[172:175]
  ds_read_b64_tr_b16 v[194:195], v245 offset:59392
  v_add_f32 v249, 1.0, v249
  v_add_f32 v250, 1.0, v250
  v_add_f32 v251, 1.0, v251
  s_waitcnt lgkmcnt(6)
  v_mfma_f32_16x16x32_bf16 v[160:163], v[180:183], v[52:55], v[160:163]
  ds_read_b64_tr_b16 v[176:177], v244 offset:61440
  v_add_f32 v252, 1.0, v252
  v_rcp_f32 v249, v249
  v_mfma_f32_16x16x32_bf16 v[164:167], v[180:183], v[124:127], v[164:167]
  ds_read_b64_tr_b16 v[178:179], v244 offset:63488
  v_rcp_f32 v250, v250
  v_rcp_f32 v251, v251
  s_waitcnt lgkmcnt(6)
  v_mfma_f32_16x16x32_bf16 v[168:171], v[184:187], v[52:55], v[168:171]
  ds_read_b64_tr_b16 v[180:181], v245 offset:61440
  v_rcp_f32 v252, v252
  v_mul_f32 v156, v156, v249
  v_mul_f32 v157, v157, v250
  v_mfma_f32_16x16x32_bf16 v[172:175], v[184:187], v[124:127], v[172:175]
  ds_read_b64_tr_b16 v[182:183], v245 offset:63488
  v_mul_f32 v158, v158, v251
  v_mul_f32 v159, v159, v252
  s_waitcnt lgkmcnt(6)
  v_mfma_f32_16x16x32_bf16 v[160:163], v[188:191], v[56:59], v[160:163]
  ds_read_b64_tr_b16 v[184:185], v246 offset:0
  v_cvt_pk_bf16_f32 v234, v156, v157
  v_cvt_pk_bf16_f32 v235, v158, v159
  v_mfma_f32_16x16x32_bf16 v[164:167], v[188:191], v[128:131], v[164:167]
  ds_read_b64_tr_b16 v[186:187], v246 offset:2048
  s_waitcnt lgkmcnt(6)
  v_mfma_f32_16x16x32_bf16 v[168:171], v[192:195], v[56:59], v[168:171]
  ds_read_b64_tr_b16 v[188:189], v247 offset:0
  v_mfma_f32_16x16x32_bf16 v[172:175], v[192:195], v[128:131], v[172:175]
  ds_read_b64_tr_b16 v[190:191], v247 offset:2048
  s_waitcnt lgkmcnt(6)
  v_mfma_f32_16x16x32_bf16 v[160:163], v[176:179], v[60:63], v[160:163]
  ds_read_b64_tr_b16 v[192:193], v246 offset:4096
  v_mfma_f32_16x16x32_bf16 v[164:167], v[176:179], v[132:135], v[164:167]
  ds_read_b64_tr_b16 v[194:195], v246 offset:6144
  s_waitcnt lgkmcnt(6)
  v_mfma_f32_16x16x32_bf16 v[168:171], v[180:183], v[60:63], v[168:171]
  ds_read_b64_tr_b16 v[176:177], v247 offset:4096
  v_mfma_f32_16x16x32_bf16 v[172:175], v[180:183], v[132:135], v[172:175]
  ds_read_b64_tr_b16 v[178:179], v247 offset:6144
  s_waitcnt lgkmcnt(6)
  v_mfma_f32_16x16x32_bf16 v[160:163], v[184:187], v[64:67], v[160:163]
  v_mfma_f32_16x16x32_bf16 v[164:167], v[184:187], v[136:139], v[164:167]
  s_waitcnt lgkmcnt(4)
  v_mfma_f32_16x16x32_bf16 v[168:171], v[188:191], v[64:67], v[168:171]
  v_mfma_f32_16x16x32_bf16 v[172:175], v[188:191], v[136:139], v[172:175]
  s_waitcnt lgkmcnt(2)
  v_mfma_f32_16x16x32_bf16 v[160:163], v[192:195], v[68:71], v[160:163]
  v_mfma_f32_16x16x32_bf16 v[164:167], v[192:195], v[140:143], v[164:167]
  s_waitcnt lgkmcnt(0)
  v_mfma_f32_16x16x32_bf16 v[168:171], v[176:179], v[68:71], v[168:171]
  v_mfma_f32_16x16x32_bf16 v[172:175], v[176:179], v[140:143], v[172:175]
  s_barrier
  v_mov_b32 v248, v243
  s_nop 7
  v_mul_f32 v249, v160, v160
  v_mul_f32 v250, v161, v161
  v_mul_f32 v251, v162, v162
  v_mul_f32 v252, v163, v163
  v_fma_f32 v249, v249, s44, v253
  v_fma_f32 v250, v250, s44, v253
  v_fma_f32 v251, v251, s44, v253
  v_fma_f32 v252, v252, s44, v253
  v_mul_f32 v249, v160, v249
  v_mul_f32 v250, v161, v250
  v_mul_f32 v251, v162, v251
  v_mul_f32 v252, v163, v252
  v_exp_f32 v249, v249
  v_exp_f32 v250, v250
  v_exp_f32 v251, v251
  v_exp_f32 v252, v252
  v_add_f32 v249, 1.0, v249
  v_add_f32 v250, 1.0, v250
  v_add_f32 v251, 1.0, v251
  v_add_f32 v252, 1.0, v252
  v_rcp_f32 v249, v249
  v_rcp_f32 v250, v250
  v_rcp_f32 v251, v251
  v_rcp_f32 v252, v252
  v_mul_f32 v160, v160, v249
  v_mul_f32 v161, v161, v250
  v_mul_f32 v162, v162, v251
  v_mul_f32 v163, v163, v252
  v_cvt_pk_bf16_f32 v236, v160, v161
  v_cvt_pk_bf16_f32 v237, v162, v163
  v_mul_f32 v249, v164, v164
  v_mul_f32 v250, v165, v165
  v_mul_f32 v251, v166, v166
  v_mul_f32 v252, v167, v167
  v_fma_f32 v249, v249, s44, v253
  v_fma_f32 v250, v250, s44, v253
  v_fma_f32 v251, v251, s44, v253
  v_fma_f32 v252, v252, s44, v253
  v_mul_f32 v249, v164, v249
  v_mul_f32 v250, v165, v250
  v_mul_f32 v251, v166, v251
  v_mul_f32 v252, v167, v252
  v_exp_f32 v249, v249
  v_exp_f32 v250, v250
  v_exp_f32 v251, v251
  v_exp_f32 v252, v252
  v_add_f32 v249, 1.0, v249
  v_add_f32 v250, 1.0, v250
  v_add_f32 v251, 1.0, v251
  v_add_f32 v252, 1.0, v252
  v_rcp_f32 v249, v249
  v_rcp_f32 v250, v250
  v_rcp_f32 v251, v251
  v_rcp_f32 v252, v252
  v_mul_f32 v164, v164, v249
  v_mul_f32 v165, v165, v250
  v_mul_f32 v166, v166, v251
  v_mul_f32 v167, v167, v252
  v_cvt_pk_bf16_f32 v240, v164, v165
  v_cvt_pk_bf16_f32 v241, v166, v167
  v_mul_f32 v249, v168, v168
  v_mul_f32 v250, v169, v169
  v_mul_f32 v251, v170, v170
  v_mul_f32 v252, v171, v171
  v_fma_f32 v249, v249, s44, v253
  v_fma_f32 v250, v250, s44, v253
  v_fma_f32 v251, v251, s44, v253
  v_fma_f32 v252, v252, s44, v253
  v_mul_f32 v249, v168, v249
  v_mul_f32 v250, v169, v250
  v_mul_f32 v251, v170, v251
  v_mul_f32 v252, v171, v252
  v_exp_f32 v249, v249
  v_exp_f32 v250, v250
  v_exp_f32 v251, v251
  v_exp_f32 v252, v252
  v_add_f32 v249, 1.0, v249
  v_add_f32 v250, 1.0, v250
  v_add_f32 v251, 1.0, v251
  v_add_f32 v252, 1.0, v252
  v_rcp_f32 v249, v249
  v_rcp_f32 v250, v250
  v_rcp_f32 v251, v251
  v_rcp_f32 v252, v252
  v_mul_f32 v168, v168, v249
  v_mul_f32 v169, v169, v250
  v_mul_f32 v170, v170, v251
  v_mul_f32 v171, v171, v252
  v_cvt_pk_bf16_f32 v238, v168, v169
  v_cvt_pk_bf16_f32 v239, v170, v171
  v_mul_f32 v249, v172, v172
  v_mul_f32 v250, v173, v173
  v_mul_f32 v251, v174, v174
  v_mul_f32 v252, v175, v175
  v_fma_f32 v249, v249, s44, v253
  v_fma_f32 v250, v250, s44, v253
  v_fma_f32 v251, v251, s44, v253
  v_fma_f32 v252, v252, s44, v253
  v_mul_f32 v249, v172, v249
  v_mul_f32 v250, v173, v250
  v_mul_f32 v251, v174, v251
  v_mul_f32 v252, v175, v252
  v_exp_f32 v249, v249
  v_exp_f32 v250, v250
  v_exp_f32 v251, v251
  v_exp_f32 v252, v252
  v_add_f32 v249, 1.0, v249
  v_add_f32 v250, 1.0, v250
  v_add_f32 v251, 1.0, v251
  v_add_f32 v252, 1.0, v252
  v_rcp_f32 v249, v249
  v_rcp_f32 v250, v250
  v_rcp_f32 v251, v251
  v_rcp_f32 v252, v252
  v_mul_f32 v172, v172, v249
  v_mul_f32 v173, v173, v250
  v_mul_f32 v174, v174, v251
  v_mul_f32 v175, v175, v252
  v_cvt_pk_bf16_f32 v242, v172, v173
  v_cvt_pk_bf16_f32 v243, v174, v175
  v_lshlrev_b32 v246, 4, v255
  s_mul_i32 s33, s28, 12288
  v_add_u32 v247, s33, v246
  s_xor_b32 s34, s28, 4
  s_mul_i32 s34, s34, 12288
  v_add_u32 v246, s34, v246
  s_nop 0
  ds_write_b128 v247, v[196:199] offset:0
  ds_write_b128 v247, v[200:203] offset:1024
  ds_write_b128 v247, v[204:207] offset:2048
  ds_write_b128 v247, v[208:211] offset:3072
  ds_write_b128 v247, v[212:215] offset:4096
  ds_write_b128 v247, v[216:219] offset:5120
  ds_write_b128 v247, v[220:223] offset:6144
  ds_write_b128 v247, v[224:227] offset:7168
  ds_write_b128 v247, v[228:231] offset:8192
  ds_write_b128 v247, v[232:235] offset:9216
  ds_write_b128 v247, v[236:239] offset:10240
  ds_write_b128 v247, v[240:243] offset:11264
  s_waitcnt lgkmcnt(0) vmcnt(0)
  s_barrier
  ds_read_b128 v[0:3], v246 offset:0
  ds_read_b128 v[4:7], v246 offset:1024
  ds_read_b128 v[8:11], v246 offset:2048
  ds_read_b128 v[12:15], v246 offset:3072
  ds_read_b128 v[16:19], v246 offset:4096
  ds_read_b128 v[20:23], v246 offset:5120
  ds_read_b128 v[24:27], v246 offset:6144
  ds_read_b128 v[28:31], v246 offset:7168
  ds_read_b128 v[32:35], v246 offset:8192
  ds_read_b128 v[36:39], v246 offset:9216
  ds_read_b128 v[40:43], v246 offset:10240
  ds_read_b128 v[44:47], v246 offset:11264
  s_waitcnt lgkmcnt(0)
  s_barrier
  v_lshrrev_b32 v249, 4, v255
  v_and_b32 v250, 15, v255
  v_lshlrev_b32 v244, 2, v249
  v_lshrrev_b32 v245, 2, v250
  v_add_u32 v244, v244, v245
  v_lshlrev_b32 v244, 7, v244
  v_and_b32 v245, 3, v250
  v_lshlrev_b32 v245, 3, v245
  v_add_u32 v244, v244, v245
  v_and_b32 v249, 1, v249
  v_lshlrev_b32 v249, 1, v249
  v_lshrrev_b32 v250, 3, v250
  v_add_u32 v249, v249, v250
  s_lshl_b32 s33, s32, 1
  v_xor_b32 v249, s33, v249
  v_lshlrev_b32 v249, 5, v249
  v_add_u32 v244, v244, v249
  v_xor_b32 v245, 32, v244
  s_lshl_b32 s33, s32, 12
  s_xor_b32 s34, s33, 4096
  s_add_u32 s33, s33, 98304
  s_add_u32 s34, s34, 98304
  v_add_u32 v246, s34, v244
  v_add_u32 v247, s34, v245
  v_add_u32 v244, s33, v244
  v_add_u32 v245, s33, v245
  v_lshlrev_b32 v254, 4, v255
  s_mul_i32 s33, s30, 2359296
  s_mul_i32 s34, s29, 147456
  s_add_u32 s33, s33, s34
  s_lshl_b32 s34, s31, 12
  s_add_u32 s33, s33, s34
  s_lshl_b32 s34, s32, 11
  s_add_u32 s39, s33, s34
  s_lshl_b32 s60, s29, 8
  s_add_u32 s60, s60, 37904448
  s_mov_b32 s61, 0
  s_mul_i32 s62, s29, 147456
  ds_read_b64_tr_b16 v[128:129], v244 offset:0
  ds_read_b64_tr_b16 v[130:131], v244 offset:2048
  ds_read_b64_tr_b16 v[132:133], v245 offset:0
  ds_read_b64_tr_b16 v[134:135], v245 offset:2048
  ds_read_b64_tr_b16 v[136:137], v246 offset:0
  ds_read_b64_tr_b16 v[138:139], v246 offset:2048
  ds_read_b64_tr_b16 v[140:141], v247 offset:0
  ds_read_b64_tr_b16 v[142:143], v247 offset:2048
  s_waitcnt lgkmcnt(6)
  v_mfma_f32_16x16x32_bf16 v[96:99], v[128:131], v[196:199], 0
  ds_read_b64_tr_b16 v[144:145], v244 offset:8192
  v_mfma_f32_16x16x32_bf16 v[100:103], v[128:131], v[200:203], 0
  ds_read_b64_tr_b16 v[146:147], v244 offset:10240
  s_add_u32 m0, s38, 0
  s_add_u32 s37, s40, 128
  buffer_load_dwordx4 v248, s[16:19], s37 offen lds
  s_waitcnt lgkmcnt(6)
  v_mfma_f32_16x16x32_bf16 v[104:107], v[132:135], v[196:199], 0
  ds_read_b64_tr_b16 v[148:149], v245 offset:8192
  v_mfma_f32_16x16x32_bf16 v[108:111], v[132:135], v[200:203], 0
  ds_read_b64_tr_b16 v[150:151], v245 offset:10240
  s_waitcnt lgkmcnt(6)
  v_mfma_f32_16x16x32_bf16 v[96:99], v[136:139], v[0:3], v[96:99]
  ds_read_b64_tr_b16 v[128:129], v246 offset:8192
  s_add_u32 m0, s38, 8192
  s_add_u32 s37, s40, 73856
  buffer_load_dwordx4 v248, s[16:19], s37 offen lds
  v_mfma_f32_16x16x32_bf16 v[100:103], v[136:139], v[4:7], v[100:103]
  ds_read_b64_tr_b16 v[130:131], v246 offset:10240
  s_waitcnt lgkmcnt(6)
  v_mfma_f32_16x16x32_bf16 v[104:107], v[140:143], v[0:3], v[104:107]
  ds_read_b64_tr_b16 v[132:133], v247 offset:8192
  v_mfma_f32_16x16x32_bf16 v[108:111], v[140:143], v[4:7], v[108:111]
  ds_read_b64_tr_b16 v[134:135], v247 offset:10240
  s_add_u32 m0, s38, 16384
  s_add_u32 s37, s40, 147584
  buffer_load_dwordx4 v248, s[16:19], s37 offen lds
  s_waitcnt lgkmcnt(6)
  v_mfma_f32_16x16x32_bf16 v[96:99], v[144:147], v[204:207], v[96:99]
  ds_read_b64_tr_b16 v[136:137], v244 offset:16384
  v_mfma_f32_16x16x32_bf16 v[100:103], v[144:147], v[208:211], v[100:103]
  ds_read_b64_tr_b16 v[138:139], v244 offset:18432
  s_waitcnt lgkmcnt(6)
  v_mfma_f32_16x16x32_bf16 v[104:107], v[148:151], v[204:207], v[104:107]
  ds_read_b64_tr_b16 v[140:141], v245 offset:16384
  s_add_u32 m0, s38, 24576
  s_add_u32 s37, s40, 221312
  buffer_load_dwordx4 v248, s[16:19], s37 offen lds
  v_mfma_f32_16x16x32_bf16 v[108:111], v[148:151], v[208:211], v[108:111]
  ds_read_b64_tr_b16 v[142:143], v245 offset:18432
  s_waitcnt lgkmcnt(6)
  v_mfma_f32_16x16x32_bf16 v[96:99], v[128:131], v[8:11], v[96:99]
  ds_read_b64_tr_b16 v[144:145], v246 offset:16384
  v_mfma_f32_16x16x32_bf16 v[100:103], v[128:131], v[12:15], v[100:103]
  ds_read_b64_tr_b16 v[146:147], v246 offset:18432
  s_add_u32 m0, s38, 32768
  s_add_u32 s37, s40, 295040
  buffer_load_dwordx4 v248, s[16:19], s37 offen lds
  s_waitcnt lgkmcnt(6)
  v_mfma_f32_16x16x32_bf16 v[104:107], v[132:135], v[8:11], v[104:107]
  ds_read_b64_tr_b16 v[148:149], v247 offset:16384
  v_mfma_f32_16x16x32_bf16 v[108:111], v[132:135], v[12:15], v[108:111]
  ds_read_b64_tr_b16 v[150:151], v247 offset:18432
  s_waitcnt lgkmcnt(6)
  v_mfma_f32_16x16x32_bf16 v[96:99], v[136:139], v[212:215], v[96:99]
  ds_read_b64_tr_b16 v[128:129], v244 offset:24576
  s_add_u32 m0, s38, 40960
  s_add_u32 s37, s40, 368768
  buffer_load_dwordx4 v248, s[16:19], s37 offen lds
  v_mfma_f32_16x16x32_bf16 v[100:103], v[136:139], v[216:219], v[100:103]
  ds_read_b64_tr_b16 v[130:131], v244 offset:26624
  s_waitcnt lgkmcnt(6)
  v_mfma_f32_16x16x32_bf16 v[104:107], v[140:143], v[212:215], v[104:107]
  ds_read_b64_tr_b16 v[132:133], v245 offset:24576
  v_mfma_f32_16x16x32_bf16 v[108:111], v[140:143], v[216:219], v[108:111]
  ds_read_b64_tr_b16 v[134:135], v245 offset:26624
  s_add_u32 m0, s38, 49152
  s_add_u32 s37, s40, 256
  buffer_load_dwordx4 v248, s[16:19], s37 offen lds
  s_waitcnt lgkmcnt(6)
  v_mfma_f32_16x16x32_bf16 v[96:99], v[144:147], v[16:19], v[96:99]
  ds_read_b64_tr_b16 v[136:137], v246 offset:24576
  v_mfma_f32_16x16x32_bf16 v[100:103], v[144:147], v[20:23], v[100:103]
  ds_read_b64_tr_b16 v[138:139], v246 offset:26624
  s_waitcnt lgkmcnt(6)
  v_mfma_f32_16x16x32_bf16 v[104:107], v[148:151], v[16:19], v[104:107]
  ds_read_b64_tr_b16 v[140:141], v247 offset:24576
  s_add_u32 m0, s38, 57344
  s_add_u32 s37, s40, 73984
  buffer_load_dwordx4 v248, s[16:19], s37 offen lds
  v_mfma_f32_16x16x32_bf16 v[108:111], v[148:151], v[20:23], v[108:111]
  ds_read_b64_tr_b16 v[142:143], v247 offset:26624
  s_waitcnt lgkmcnt(6)
  v_mfma_f32_16x16x32_bf16 v[96:99], v[128:131], v[220:223], v[96:99]
  ds_read_b64_tr_b16 v[144:145], v244 offset:32768
  v_mfma_f32_16x16x32_bf16 v[100:103], v[128:131], v[224:227], v[100:103]
  ds_read_b64_tr_b16 v[146:147], v244 offset:34816
  s_add_u32 m0, s38, 65536
  s_add_u32 s37, s40, 147712
  buffer_load_dwordx4 v248, s[16:19], s37 offen lds
  s_waitcnt lgkmcnt(6)
  v_mfma_f32_16x16x32_bf16 v[104:107], v[132:135], v[220:223], v[104:107]
  ds_read_b64_tr_b16 v[148:149], v245 offset:32768
  v_mfma_f32_16x16x32_bf16 v[108:111], v[132:135], v[224:227], v[108:111]
  ds_read_b64_tr_b16 v[150:151], v245 offset:34816
  s_waitcnt lgkmcnt(6)
  v_mfma_f32_16x16x32_bf16 v[96:99], v[136:139], v[24:27], v[96:99]
  ds_read_b64_tr_b16 v[128:129], v246 offset:32768
  s_add_u32 m0, s38, 73728
  s_add_u32 s37, s40, 221440
  buffer_load_dwordx4 v248, s[16:19], s37 offen lds
  v_mfma_f32_16x16x32_bf16 v[100:103], v[136:139], v[28:31], v[100:103]
  ds_read_b64_tr_b16 v[130:131], v246 offset:34816
  s_waitcnt lgkmcnt(6)
  v_mfma_f32_16x16x32_bf16 v[104:107], v[140:143], v[24:27], v[104:107]
  ds_read_b64_tr_b16 v[132:133], v247 offset:32768
  v_mfma_f32_16x16x32_bf16 v[108:111], v[140:143], v[28:31], v[108:111]
  ds_read_b64_tr_b16 v[134:135], v247 offset:34816
  s_add_u32 m0, s38, 81920
  s_add_u32 s37, s40, 295168
  buffer_load_dwordx4 v248, s[16:19], s37 offen lds
  s_waitcnt lgkmcnt(6)
  v_mfma_f32_16x16x32_bf16 v[96:99], v[144:147], v[228:231], v[96:99]
  ds_read_b64_tr_b16 v[136:137], v244 offset:40960
  v_mfma_f32_16x16x32_bf16 v[100:103], v[144:147], v[232:235], v[100:103]
  ds_read_b64_tr_b16 v[138:139], v244 offset:43008
  s_waitcnt lgkmcnt(6)
  v_mfma_f32_16x16x32_bf16 v[104:107], v[148:151], v[228:231], v[104:107]
  ds_read_b64_tr_b16 v[140:141], v245 offset:40960
  s_add_u32 m0, s38, 90112
  s_add_u32 s37, s40, 368896
  buffer_load_dwordx4 v248, s[16:19], s37 offen lds
  v_mfma_f32_16x16x32_bf16 v[108:111], v[148:151], v[232:235], v[108:111]
  ds_read_b64_tr_b16 v[142:143], v245 offset:43008
  s_waitcnt lgkmcnt(6)
  v_mfma_f32_16x16x32_bf16 v[96:99], v[128:131], v[32:35], v[96:99]
  ds_read_b64_tr_b16 v[144:145], v246 offset:40960
  v_mfma_f32_16x16x32_bf16 v[100:103], v[128:131], v[36:39], v[100:103]
  ds_read_b64_tr_b16 v[146:147], v246 offset:43008
  s_waitcnt lgkmcnt(6)
  v_mfma_f32_16x16x32_bf16 v[104:107], v[132:135], v[32:35], v[104:107]
  ds_read_b64_tr_b16 v[148:149], v247 offset:40960
  v_mfma_f32_16x16x32_bf16 v[108:111], v[132:135], v[36:39], v[108:111]
  ds_read_b64_tr_b16 v[150:151], v247 offset:43008
  s_waitcnt lgkmcnt(0)
  s_waitcnt vmcnt(6)
  s_barrier
  v_add_u32 v244, 4294868992, v244
  v_add_u32 v245, 4294868992, v245
  v_add_u32 v246, 4294868992, v246
  v_add_u32 v247, 4294868992, v247
  v_mfma_f32_16x16x32_bf16 v[96:99], v[136:139], v[236:239], v[96:99]
  ds_read_b64_tr_b16 v[128:129], v244 offset:0
  v_mfma_f32_16x16x32_bf16 v[100:103], v[136:139], v[240:243], v[100:103]
  ds_read_b64_tr_b16 v[130:131], v244 offset:2048
  s_add_u32 m0, s38, 98304
  s_add_u32 s37, s40, 384
  buffer_load_dwordx4 v248, s[16:19], s37 offen lds
  v_mfma_f32_16x16x32_bf16 v[104:107], v[140:143], v[236:239], v[104:107]
  ds_read_b64_tr_b16 v[132:133], v245 offset:0
  v_mfma_f32_16x16x32_bf16 v[108:111], v[140:143], v[240:243], v[108:111]
  ds_read_b64_tr_b16 v[134:135], v245 offset:2048
  v_mfma_f32_16x16x32_bf16 v[96:99], v[144:147], v[40:43], v[96:99]
  ds_read_b64_tr_b16 v[136:137], v246 offset:0
  s_add_u32 m0, s38, 106496
  s_add_u32 s37, s40, 74112
  buffer_load_dwordx4 v248, s[16:19], s37 offen lds
  v_mfma_f32_16x16x32_bf16 v[100:103], v[144:147], v[44:47], v[100:103]
  ds_read_b64_tr_b16 v[138:139], v246 offset:2048
  v_mfma_f32_16x16x32_bf16 v[104:107], v[148:151], v[40:43], v[104:107]
  ds_read_b64_tr_b16 v[140:141], v247 offset:0
  v_mfma_f32_16x16x32_bf16 v[108:111], v[148:151], v[44:47], v[108:111]
  ds_read_b64_tr_b16 v[142:143], v247 offset:2048
  s_add_u32 m0, s38, 114688
  s_add_u32 s37, s40, 147840
  buffer_load_dwordx4 v248, s[16:19], s37 offen lds
  s_waitcnt lgkmcnt(6)
  v_mfma_f32_16x16x32_bf16 v[112:115], v[128:131], v[196:199], 0
  ds_read_b64_tr_b16 v[144:145], v244 offset:8192
  v_mfma_f32_16x16x32_bf16 v[116:119], v[128:131], v[200:203], 0
  ds_read_b64_tr_b16 v[146:147], v244 offset:10240
  s_waitcnt lgkmcnt(6)
  v_mfma_f32_16x16x32_bf16 v[120:123], v[132:135], v[196:199], 0
  ds_read_b64_tr_b16 v[148:149], v245 offset:8192
  s_add_u32 m0, s38, 122880
  s_add_u32 s37, s40, 221568
  buffer_load_dwordx4 v248, s[16:19], s37 offen lds
  v_mfma_f32_16x16x32_bf16 v[124:127], v[132:135], v[200:203], 0
  ds_read_b64_tr_b16 v[150:151], v245 offset:10240
  s_waitcnt lgkmcnt(6)
  v_mfma_f32_16x16x32_bf16 v[112:115], v[136:139], v[0:3], v[112:115]
  ds_read_b64_tr_b16 v[128:129], v246 offset:8192
  v_mfma_f32_16x16x32_bf16 v[116:119], v[136:139], v[4:7], v[116:119]
  ds_read_b64_tr_b16 v[130:131], v246 offset:10240
  s_add_u32 m0, s38, 131072
  s_add_u32 s37, s40, 295296
  buffer_load_dwordx4 v248, s[16:19], s37 offen lds
  s_waitcnt lgkmcnt(6)
  v_mfma_f32_16x16x32_bf16 v[120:123], v[140:143], v[0:3], v[120:123]
  ds_read_b64_tr_b16 v[132:133], v247 offset:8192
  v_mfma_f32_16x16x32_bf16 v[124:127], v[140:143], v[4:7], v[124:127]
  ds_read_b64_tr_b16 v[134:135], v247 offset:10240
  s_waitcnt lgkmcnt(6)
  v_mfma_f32_16x16x32_bf16 v[112:115], v[144:147], v[204:207], v[112:115]
  ds_read_b64_tr_b16 v[136:137], v244 offset:16384
  s_add_u32 m0, s38, 139264
  s_add_u32 s37, s40, 369024
  buffer_load_dwordx4 v248, s[16:19], s37 offen lds
  v_cvt_pk_bf16_f32 v160, v96, v97
  v_mfma_f32_16x16x32_bf16 v[116:119], v[144:147], v[208:211], v[116:119]
  ds_read_b64_tr_b16 v[138:139], v244 offset:18432
  v_cvt_pk_bf16_f32 v161, v98, v99
  s_waitcnt lgkmcnt(6)
  v_mfma_f32_16x16x32_bf16 v[120:123], v[148:151], v[204:207], v[120:123]
  ds_read_b64_tr_b16 v[140:141], v245 offset:16384
  v_cvt_pk_bf16_f32 v162, v104, v105
  v_mfma_f32_16x16x32_bf16 v[124:127], v[148:151], v[208:211], v[124:127]
  ds_read_b64_tr_b16 v[142:143], v245 offset:18432
  v_cvt_pk_bf16_f32 v163, v106, v107
  s_waitcnt lgkmcnt(6)
  v_mfma_f32_16x16x32_bf16 v[112:115], v[128:131], v[8:11], v[112:115]
  ds_read_b64_tr_b16 v[144:145], v246 offset:16384
  v_cvt_pk_bf16_f32 v164, v100, v101
  v_mfma_f32_16x16x32_bf16 v[116:119], v[128:131], v[12:15], v[116:119]
  ds_read_b64_tr_b16 v[146:147], v246 offset:18432
  v_cvt_pk_bf16_f32 v165, v102, v103
  s_waitcnt lgkmcnt(6)
  v_mfma_f32_16x16x32_bf16 v[120:123], v[132:135], v[8:11], v[120:123]
  ds_read_b64_tr_b16 v[148:149], v247 offset:16384
  v_cvt_pk_bf16_f32 v166, v108, v109
  v_mfma_f32_16x16x32_bf16 v[124:127], v[132:135], v[12:15], v[124:127]
  ds_read_b64_tr_b16 v[150:151], v247 offset:18432
  v_cvt_pk_bf16_f32 v167, v110, v111
  s_waitcnt lgkmcnt(6)
  v_mfma_f32_16x16x32_bf16 v[112:115], v[136:139], v[212:215], v[112:115]
  ds_read_b64_tr_b16 v[128:129], v244 offset:24576
  v_mfma_f32_16x16x32_bf16 v[116:119], v[136:139], v[216:219], v[116:119]
  ds_read_b64_tr_b16 v[130:131], v244 offset:26624
  s_waitcnt lgkmcnt(6)
  v_mfma_f32_16x16x32_bf16 v[120:123], v[140:143], v[212:215], v[120:123]
  ds_read_b64_tr_b16 v[132:133], v245 offset:24576
  v_mfma_f32_16x16x32_bf16 v[124:127], v[140:143], v[216:219], v[124:127]
  ds_read_b64_tr_b16 v[134:135], v245 offset:26624
  s_waitcnt lgkmcnt(6)
  v_mfma_f32_16x16x32_bf16 v[112:115], v[144:147], v[16:19], v[112:115]
  ds_read_b64_tr_b16 v[136:137], v246 offset:24576
  s_add_u32 s35, s39, 0
  buffer_store_dwordx4 v[160:163], v254, s[20:23], s35 offen offset:0 sc1
  buffer_store_dwordx4 v[164:167], v254, s[20:23], s35 offen offset:1024 sc1
  v_mfma_f32_16x16x32_bf16 v[116:119], v[144:147], v[20:23], v[116:119]
  ds_read_b64_tr_b16 v[138:139], v246 offset:26624
  s_waitcnt lgkmcnt(6)
  v_mfma_f32_16x16x32_bf16 v[120:123], v[148:151], v[16:19], v[120:123]
  ds_read_b64_tr_b16 v[140:141], v247 offset:24576
  v_mfma_f32_16x16x32_bf16 v[124:127], v[148:151], v[20:23], v[124:127]
  ds_read_b64_tr_b16 v[142:143], v247 offset:26624
  s_waitcnt lgkmcnt(6)
  v_mfma_f32_16x16x32_bf16 v[112:115], v[128:131], v[220:223], v[112:115]
  ds_read_b64_tr_b16 v[144:145], v244 offset:32768
  v_mfma_f32_16x16x32_bf16 v[116:119], v[128:131], v[224:227], v[116:119]
  ds_read_b64_tr_b16 v[146:147], v244 offset:34816
  s_waitcnt lgkmcnt(6)
  v_mfma_f32_16x16x32_bf16 v[120:123], v[132:135], v[220:223], v[120:123]
  ds_read_b64_tr_b16 v[148:149], v245 offset:32768
  v_mfma_f32_16x16x32_bf16 v[124:127], v[132:135], v[224:227], v[124:127]
  ds_read_b64_tr_b16 v[150:151], v245 offset:34816
  s_waitcnt lgkmcnt(6)
  v_mfma_f32_16x16x32_bf16 v[112:115], v[136:139], v[24:27], v[112:115]
  ds_read_b64_tr_b16 v[128:129], v246 offset:32768
  v_mfma_f32_16x16x32_bf16 v[116:119], v[136:139], v[28:31], v[116:119]
  ds_read_b64_tr_b16 v[130:131], v246 offset:34816
  s_waitcnt lgkmcnt(6)
  v_mfma_f32_16x16x32_bf16 v[120:123], v[140:143], v[24:27], v[120:123]
  ds_read_b64_tr_b16 v[132:133], v247 offset:32768
  v_mfma_f32_16x16x32_bf16 v[124:127], v[140:143], v[28:31], v[124:127]
  ds_read_b64_tr_b16 v[134:135], v247 offset:34816
  s_waitcnt lgkmcnt(6)
  v_mfma_f32_16x16x32_bf16 v[112:115], v[144:147], v[228:231], v[112:115]
  ds_read_b64_tr_b16 v[136:137], v244 offset:40960
  v_mfma_f32_16x16x32_bf16 v[116:119], v[144:147], v[232:235], v[116:119]
  ds_read_b64_tr_b16 v[138:139], v244 offset:43008
  s_waitcnt lgkmcnt(6)
  v_mfma_f32_16x16x32_bf16 v[120:123], v[148:151], v[228:231], v[120:123]
  ds_read_b64_tr_b16 v[140:141], v245 offset:40960
  v_mfma_f32_16x16x32_bf16 v[124:127], v[148:151], v[232:235], v[124:127]
  ds_read_b64_tr_b16 v[142:143], v245 offset:43008
  s_waitcnt lgkmcnt(6)
  v_mfma_f32_16x16x32_bf16 v[112:115], v[128:131], v[32:35], v[112:115]
  ds_read_b64_tr_b16 v[144:145], v246 offset:40960
  v_mfma_f32_16x16x32_bf16 v[116:119], v[128:131], v[36:39], v[116:119]
  ds_read_b64_tr_b16 v[146:147], v246 offset:43008
  s_waitcnt lgkmcnt(6)
  v_mfma_f32_16x16x32_bf16 v[120:123], v[132:135], v[32:35], v[120:123]
  ds_read_b64_tr_b16 v[148:149], v247 offset:40960
  v_mfma_f32_16x16x32_bf16 v[124:127], v[132:135], v[36:39], v[124:127]
  ds_read_b64_tr_b16 v[150:151], v247 offset:43008
  s_waitcnt lgkmcnt(0)
  s_waitcnt vmcnt(8)
  s_barrier
  v_add_u32 v244, 49152, v244
  v_add_u32 v245, 49152, v245
  v_add_u32 v246, 49152, v246
  v_add_u32 v247, 49152, v247
  v_mfma_f32_16x16x32_bf16 v[112:115], v[136:139], v[236:239], v[112:115]
  ds_read_b64_tr_b16 v[128:129], v244 offset:0
  v_mfma_f32_16x16x32_bf16 v[116:119], v[136:139], v[240:243], v[116:119]
  ds_read_b64_tr_b16 v[130:131], v244 offset:2048
  s_add_u32 m0, s38, 0
  s_add_u32 s37, s40, 512
  buffer_load_dwordx4 v248, s[16:19], s37 offen lds
  v_mfma_f32_16x16x32_bf16 v[120:123], v[140:143], v[236:239], v[120:123]
  ds_read_b64_tr_b16 v[132:133], v245 offset:0
  v_mfma_f32_16x16x32_bf16 v[124:127], v[140:143], v[240:243], v[124:127]
  ds_read_b64_tr_b16 v[134:135], v245 offset:2048
  v_mfma_f32_16x16x32_bf16 v[112:115], v[144:147], v[40:43], v[112:115]
  ds_read_b64_tr_b16 v[136:137], v246 offset:0
  s_add_u32 m0, s38, 8192
  s_add_u32 s37, s40, 74240
  buffer_load_dwordx4 v248, s[16:19], s37 offen lds
  v_mfma_f32_16x16x32_bf16 v[116:119], v[144:147], v[44:47], v[116:119]
  ds_read_b64_tr_b16 v[138:139], v246 offset:2048
  v_mfma_f32_16x16x32_bf16 v[120:123], v[148:151], v[40:43], v[120:123]
  ds_read_b64_tr_b16 v[140:141], v247 offset:0
  v_mfma_f32_16x16x32_bf16 v[124:127], v[148:151], v[44:47], v[124:127]
  ds_read_b64_tr_b16 v[142:143], v247 offset:2048
  s_add_u32 m0, s38, 16384
  s_add_u32 s37, s40, 147968
  buffer_load_dwordx4 v248, s[16:19], s37 offen lds
  s_waitcnt lgkmcnt(6)
  v_mfma_f32_16x16x32_bf16 v[96:99], v[128:131], v[196:199], 0
  ds_read_b64_tr_b16 v[144:145], v244 offset:8192
  v_mfma_f32_16x16x32_bf16 v[100:103], v[128:131], v[200:203], 0
  ds_read_b64_tr_b16 v[146:147], v244 offset:10240
  s_waitcnt lgkmcnt(6)
  v_mfma_f32_16x16x32_bf16 v[104:107], v[132:135], v[196:199], 0
  ds_read_b64_tr_b16 v[148:149], v245 offset:8192
  s_add_u32 m0, s38, 24576
  s_add_u32 s37, s40, 221696
  buffer_load_dwordx4 v248, s[16:19], s37 offen lds
  v_mfma_f32_16x16x32_bf16 v[108:111], v[132:135], v[200:203], 0
  ds_read_b64_tr_b16 v[150:151], v245 offset:10240
  s_waitcnt lgkmcnt(6)
  v_mfma_f32_16x16x32_bf16 v[96:99], v[136:139], v[0:3], v[96:99]
  ds_read_b64_tr_b16 v[128:129], v246 offset:8192
  v_mfma_f32_16x16x32_bf16 v[100:103], v[136:139], v[4:7], v[100:103]
  ds_read_b64_tr_b16 v[130:131], v246 offset:10240
  s_add_u32 m0, s38, 32768
  s_add_u32 s37, s40, 295424
  buffer_load_dwordx4 v248, s[16:19], s37 offen lds
  s_waitcnt lgkmcnt(6)
  v_mfma_f32_16x16x32_bf16 v[104:107], v[140:143], v[0:3], v[104:107]
  ds_read_b64_tr_b16 v[132:133], v247 offset:8192
  v_mfma_f32_16x16x32_bf16 v[108:111], v[140:143], v[4:7], v[108:111]
  ds_read_b64_tr_b16 v[134:135], v247 offset:10240
  s_waitcnt lgkmcnt(6)
  v_mfma_f32_16x16x32_bf16 v[96:99], v[144:147], v[204:207], v[96:99]
  ds_read_b64_tr_b16 v[136:137], v244 offset:16384
  s_add_u32 m0, s38, 40960
  s_add_u32 s37, s40, 369152
  buffer_load_dwordx4 v248, s[16:19], s37 offen lds
  v_cvt_pk_bf16_f32 v168, v112, v113
  v_mfma_f32_16x16x32_bf16 v[100:103], v[144:147], v[208:211], v[100:103]
  ds_read_b64_tr_b16 v[138:139], v244 offset:18432
  v_cvt_pk_bf16_f32 v169, v114, v115
  s_waitcnt lgkmcnt(6)
  v_mfma_f32_16x16x32_bf16 v[104:107], v[148:151], v[204:207], v[104:107]
  ds_read_b64_tr_b16 v[140:141], v245 offset:16384
  v_cvt_pk_bf16_f32 v170, v120, v121
  v_mfma_f32_16x16x32_bf16 v[108:111], v[148:151], v[208:211], v[108:111]
  ds_read_b64_tr_b16 v[142:143], v245 offset:18432
  v_cvt_pk_bf16_f32 v171, v122, v123
  s_waitcnt lgkmcnt(6)
  v_mfma_f32_16x16x32_bf16 v[96:99], v[128:131], v[8:11], v[96:99]
  ds_read_b64_tr_b16 v[144:145], v246 offset:16384
  v_cvt_pk_bf16_f32 v172, v116, v117
  v_mfma_f32_16x16x32_bf16 v[100:103], v[128:131], v[12:15], v[100:103]
  ds_read_b64_tr_b16 v[146:147], v246 offset:18432
  v_cvt_pk_bf16_f32 v173, v118, v119
  s_waitcnt lgkmcnt(6)
  v_mfma_f32_16x16x32_bf16 v[104:107], v[132:135], v[8:11], v[104:107]
  ds_read_b64_tr_b16 v[148:149], v247 offset:16384
  v_cvt_pk_bf16_f32 v174, v124, v125
  v_mfma_f32_16x16x32_bf16 v[108:111], v[132:135], v[12:15], v[108:111]
  ds_read_b64_tr_b16 v[150:151], v247 offset:18432
  v_cvt_pk_bf16_f32 v175, v126, v127
  s_waitcnt lgkmcnt(6)
  v_mfma_f32_16x16x32_bf16 v[96:99], v[136:139], v[212:215], v[96:99]
  ds_read_b64_tr_b16 v[128:129], v244 offset:24576
  v_mfma_f32_16x16x32_bf16 v[100:103], v[136:139], v[216:219], v[100:103]
  ds_read_b64_tr_b16 v[130:131], v244 offset:26624
  s_waitcnt lgkmcnt(6)
  v_mfma_f32_16x16x32_bf16 v[104:107], v[140:143], v[212:215], v[104:107]
  ds_read_b64_tr_b16 v[132:133], v245 offset:24576
  v_mfma_f32_16x16x32_bf16 v[108:111], v[140:143], v[216:219], v[108:111]
  ds_read_b64_tr_b16 v[134:135], v245 offset:26624
  s_waitcnt lgkmcnt(6)
  v_mfma_f32_16x16x32_bf16 v[96:99], v[144:147], v[16:19], v[96:99]
  ds_read_b64_tr_b16 v[136:137], v246 offset:24576
  s_add_u32 s35, s39, 16384
  buffer_store_dwordx4 v[168:171], v254, s[20:23], s35 offen offset:0 sc1
  buffer_store_dwordx4 v[172:175], v254, s[20:23], s35 offen offset:1024 sc1
  v_mfma_f32_16x16x32_bf16 v[100:103], v[144:147], v[20:23], v[100:103]
  ds_read_b64_tr_b16 v[138:139], v246 offset:26624
  s_waitcnt lgkmcnt(6)
  v_mfma_f32_16x16x32_bf16 v[104:107], v[148:151], v[16:19], v[104:107]
  ds_read_b64_tr_b16 v[140:141], v247 offset:24576
  v_mfma_f32_16x16x32_bf16 v[108:111], v[148:151], v[20:23], v[108:111]
  ds_read_b64_tr_b16 v[142:143], v247 offset:26624
  s_waitcnt lgkmcnt(6)
  v_mfma_f32_16x16x32_bf16 v[96:99], v[128:131], v[220:223], v[96:99]
  ds_read_b64_tr_b16 v[144:145], v244 offset:32768
  v_mfma_f32_16x16x32_bf16 v[100:103], v[128:131], v[224:227], v[100:103]
  ds_read_b64_tr_b16 v[146:147], v244 offset:34816
  s_waitcnt lgkmcnt(6)
  v_mfma_f32_16x16x32_bf16 v[104:107], v[132:135], v[220:223], v[104:107]
  ds_read_b64_tr_b16 v[148:149], v245 offset:32768
  v_mfma_f32_16x16x32_bf16 v[108:111], v[132:135], v[224:227], v[108:111]
  ds_read_b64_tr_b16 v[150:151], v245 offset:34816
  s_waitcnt lgkmcnt(6)
  v_mfma_f32_16x16x32_bf16 v[96:99], v[136:139], v[24:27], v[96:99]
  ds_read_b64_tr_b16 v[128:129], v246 offset:32768
  v_mfma_f32_16x16x32_bf16 v[100:103], v[136:139], v[28:31], v[100:103]
  ds_read_b64_tr_b16 v[130:131], v246 offset:34816
  s_waitcnt lgkmcnt(6)
  v_mfma_f32_16x16x32_bf16 v[104:107], v[140:143], v[24:27], v[104:107]
  ds_read_b64_tr_b16 v[132:133], v247 offset:32768
  v_mfma_f32_16x16x32_bf16 v[108:111], v[140:143], v[28:31], v[108:111]
  ds_read_b64_tr_b16 v[134:135], v247 offset:34816
  s_waitcnt lgkmcnt(6)
  v_mfma_f32_16x16x32_bf16 v[96:99], v[144:147], v[228:231], v[96:99]
  ds_read_b64_tr_b16 v[136:137], v244 offset:40960
  v_mfma_f32_16x16x32_bf16 v[100:103], v[144:147], v[232:235], v[100:103]
  ds_read_b64_tr_b16 v[138:139], v244 offset:43008
  s_waitcnt lgkmcnt(6)
  v_mfma_f32_16x16x32_bf16 v[104:107], v[148:151], v[228:231], v[104:107]
  ds_read_b64_tr_b16 v[140:141], v245 offset:40960
  v_mfma_f32_16x16x32_bf16 v[108:111], v[148:151], v[232:235], v[108:111]
  ds_read_b64_tr_b16 v[142:143], v245 offset:43008
  s_waitcnt lgkmcnt(6)
  v_mfma_f32_16x16x32_bf16 v[96:99], v[128:131], v[32:35], v[96:99]
  ds_read_b64_tr_b16 v[144:145], v246 offset:40960
  v_mfma_f32_16x16x32_bf16 v[100:103], v[128:131], v[36:39], v[100:103]
  ds_read_b64_tr_b16 v[146:147], v246 offset:43008
  s_waitcnt lgkmcnt(6)
  v_mfma_f32_16x16x32_bf16 v[104:107], v[132:135], v[32:35], v[104:107]
  ds_read_b64_tr_b16 v[148:149], v247 offset:40960
  v_mfma_f32_16x16x32_bf16 v[108:111], v[132:135], v[36:39], v[108:111]
  ds_read_b64_tr_b16 v[150:151], v247 offset:43008
  s_waitcnt lgkmcnt(0)
  s_waitcnt vmcnt(10)
  s_barrier
  v_add_u32 v244, 49152, v244
  v_add_u32 v245, 49152, v245
  v_add_u32 v246, 49152, v246
  v_add_u32 v247, 49152, v247
  v_mfma_f32_16x16x32_bf16 v[96:99], v[136:139], v[236:239], v[96:99]
  ds_read_b64_tr_b16 v[128:129], v244 offset:0
  v_mfma_f32_16x16x32_bf16 v[100:103], v[136:139], v[240:243], v[100:103]
  ds_read_b64_tr_b16 v[130:131], v244 offset:2048
  s_add_u32 m0, s38, 49152
  s_add_u32 s37, s40, 640
  buffer_load_dwordx4 v248, s[16:19], s37 offen lds
  v_mfma_f32_16x16x32_bf16 v[104:107], v[140:143], v[236:239], v[104:107]
  ds_read_b64_tr_b16 v[132:133], v245 offset:0
  v_mfma_f32_16x16x32_bf16 v[108:111], v[140:143], v[240:243], v[108:111]
  ds_read_b64_tr_b16 v[134:135], v245 offset:2048
  v_mfma_f32_16x16x32_bf16 v[96:99], v[144:147], v[40:43], v[96:99]
  ds_read_b64_tr_b16 v[136:137], v246 offset:0
  s_add_u32 m0, s38, 57344
  s_add_u32 s37, s40, 74368
  buffer_load_dwordx4 v248, s[16:19], s37 offen lds
  v_mfma_f32_16x16x32_bf16 v[100:103], v[144:147], v[44:47], v[100:103]
  ds_read_b64_tr_b16 v[138:139], v246 offset:2048
  v_mfma_f32_16x16x32_bf16 v[104:107], v[148:151], v[40:43], v[104:107]
  ds_read_b64_tr_b16 v[140:141], v247 offset:0
  v_mfma_f32_16x16x32_bf16 v[108:111], v[148:151], v[44:47], v[108:111]
  ds_read_b64_tr_b16 v[142:143], v247 offset:2048
  s_add_u32 m0, s38, 65536
  s_add_u32 s37, s40, 148096
  buffer_load_dwordx4 v248, s[16:19], s37 offen lds
  s_waitcnt lgkmcnt(6)
  v_mfma_f32_16x16x32_bf16 v[112:115], v[128:131], v[196:199], 0
  ds_read_b64_tr_b16 v[144:145], v244 offset:8192
  v_mfma_f32_16x16x32_bf16 v[116:119], v[128:131], v[200:203], 0
  ds_read_b64_tr_b16 v[146:147], v244 offset:10240
  s_waitcnt lgkmcnt(6)
  v_mfma_f32_16x16x32_bf16 v[120:123], v[132:135], v[196:199], 0
  ds_read_b64_tr_b16 v[148:149], v245 offset:8192
  s_add_u32 m0, s38, 73728
  s_add_u32 s37, s40, 221824
  buffer_load_dwordx4 v248, s[16:19], s37 offen lds
  v_mfma_f32_16x16x32_bf16 v[124:127], v[132:135], v[200:203], 0
  ds_read_b64_tr_b16 v[150:151], v245 offset:10240
  s_waitcnt lgkmcnt(6)
  v_mfma_f32_16x16x32_bf16 v[112:115], v[136:139], v[0:3], v[112:115]
  ds_read_b64_tr_b16 v[128:129], v246 offset:8192
  v_mfma_f32_16x16x32_bf16 v[116:119], v[136:139], v[4:7], v[116:119]
  ds_read_b64_tr_b16 v[130:131], v246 offset:10240
  s_add_u32 m0, s38, 81920
  s_add_u32 s37, s40, 295552
  buffer_load_dwordx4 v248, s[16:19], s37 offen lds
  s_waitcnt lgkmcnt(6)
  v_mfma_f32_16x16x32_bf16 v[120:123], v[140:143], v[0:3], v[120:123]
  ds_read_b64_tr_b16 v[132:133], v247 offset:8192
  v_mfma_f32_16x16x32_bf16 v[124:127], v[140:143], v[4:7], v[124:127]
  ds_read_b64_tr_b16 v[134:135], v247 offset:10240
  s_waitcnt lgkmcnt(6)
  v_mfma_f32_16x16x32_bf16 v[112:115], v[144:147], v[204:207], v[112:115]
  ds_read_b64_tr_b16 v[136:137], v244 offset:16384
  s_add_u32 m0, s38, 90112
  s_add_u32 s37, s40, 369280
  buffer_load_dwordx4 v248, s[16:19], s37 offen lds
  v_cvt_pk_bf16_f32 v160, v96, v97
  v_mfma_f32_16x16x32_bf16 v[116:119], v[144:147], v[208:211], v[116:119]
  ds_read_b64_tr_b16 v[138:139], v244 offset:18432
  v_cvt_pk_bf16_f32 v161, v98, v99
  s_waitcnt lgkmcnt(6)
  v_mfma_f32_16x16x32_bf16 v[120:123], v[148:151], v[204:207], v[120:123]
  ds_read_b64_tr_b16 v[140:141], v245 offset:16384
  v_cvt_pk_bf16_f32 v162, v104, v105
  v_mfma_f32_16x16x32_bf16 v[124:127], v[148:151], v[208:211], v[124:127]
  ds_read_b64_tr_b16 v[142:143], v245 offset:18432
  v_cvt_pk_bf16_f32 v163, v106, v107
  s_waitcnt lgkmcnt(6)
  v_mfma_f32_16x16x32_bf16 v[112:115], v[128:131], v[8:11], v[112:115]
  ds_read_b64_tr_b16 v[144:145], v246 offset:16384
  v_cvt_pk_bf16_f32 v164, v100, v101
  v_mfma_f32_16x16x32_bf16 v[116:119], v[128:131], v[12:15], v[116:119]
  ds_read_b64_tr_b16 v[146:147], v246 offset:18432
  v_cvt_pk_bf16_f32 v165, v102, v103
  s_waitcnt lgkmcnt(6)
  v_mfma_f32_16x16x32_bf16 v[120:123], v[132:135], v[8:11], v[120:123]
  ds_read_b64_tr_b16 v[148:149], v247 offset:16384
  v_cvt_pk_bf16_f32 v166, v108, v109
  v_mfma_f32_16x16x32_bf16 v[124:127], v[132:135], v[12:15], v[124:127]
  ds_read_b64_tr_b16 v[150:151], v247 offset:18432
  v_cvt_pk_bf16_f32 v167, v110, v111
  s_waitcnt lgkmcnt(6)
  v_mfma_f32_16x16x32_bf16 v[112:115], v[136:139], v[212:215], v[112:115]
  ds_read_b64_tr_b16 v[128:129], v244 offset:24576
  v_mfma_f32_16x16x32_bf16 v[116:119], v[136:139], v[216:219], v[116:119]
  ds_read_b64_tr_b16 v[130:131], v244 offset:26624
  s_waitcnt lgkmcnt(6)
  v_mfma_f32_16x16x32_bf16 v[120:123], v[140:143], v[212:215], v[120:123]
  ds_read_b64_tr_b16 v[132:133], v245 offset:24576
  v_mfma_f32_16x16x32_bf16 v[124:127], v[140:143], v[216:219], v[124:127]
  ds_read_b64_tr_b16 v[134:135], v245 offset:26624
  s_waitcnt lgkmcnt(6)
  v_mfma_f32_16x16x32_bf16 v[112:115], v[144:147], v[16:19], v[112:115]
  ds_read_b64_tr_b16 v[136:137], v246 offset:24576
  s_add_u32 s35, s39, 32768
  buffer_store_dwordx4 v[160:163], v254, s[20:23], s35 offen offset:0 sc1
  buffer_store_dwordx4 v[164:167], v254, s[20:23], s35 offen offset:1024 sc1
  v_mfma_f32_16x16x32_bf16 v[116:119], v[144:147], v[20:23], v[116:119]
  ds_read_b64_tr_b16 v[138:139], v246 offset:26624
  s_waitcnt lgkmcnt(6)
  v_mfma_f32_16x16x32_bf16 v[120:123], v[148:151], v[16:19], v[120:123]
  ds_read_b64_tr_b16 v[140:141], v247 offset:24576
  v_mfma_f32_16x16x32_bf16 v[124:127], v[148:151], v[20:23], v[124:127]
  ds_read_b64_tr_b16 v[142:143], v247 offset:26624
  s_waitcnt lgkmcnt(6)
  v_mfma_f32_16x16x32_bf16 v[112:115], v[128:131], v[220:223], v[112:115]
  ds_read_b64_tr_b16 v[144:145], v244 offset:32768
  v_mfma_f32_16x16x32_bf16 v[116:119], v[128:131], v[224:227], v[116:119]
  ds_read_b64_tr_b16 v[146:147], v244 offset:34816
  s_waitcnt lgkmcnt(6)
  v_mfma_f32_16x16x32_bf16 v[120:123], v[132:135], v[220:223], v[120:123]
  ds_read_b64_tr_b16 v[148:149], v245 offset:32768
  v_mfma_f32_16x16x32_bf16 v[124:127], v[132:135], v[224:227], v[124:127]
  ds_read_b64_tr_b16 v[150:151], v245 offset:34816
  s_waitcnt lgkmcnt(6)
  v_mfma_f32_16x16x32_bf16 v[112:115], v[136:139], v[24:27], v[112:115]
  ds_read_b64_tr_b16 v[128:129], v246 offset:32768
  v_mfma_f32_16x16x32_bf16 v[116:119], v[136:139], v[28:31], v[116:119]
  ds_read_b64_tr_b16 v[130:131], v246 offset:34816
  s_waitcnt lgkmcnt(6)
  v_mfma_f32_16x16x32_bf16 v[120:123], v[140:143], v[24:27], v[120:123]
  ds_read_b64_tr_b16 v[132:133], v247 offset:32768
  v_mfma_f32_16x16x32_bf16 v[124:127], v[140:143], v[28:31], v[124:127]
  ds_read_b64_tr_b16 v[134:135], v247 offset:34816
  s_waitcnt lgkmcnt(6)
  v_mfma_f32_16x16x32_bf16 v[112:115], v[144:147], v[228:231], v[112:115]
  ds_read_b64_tr_b16 v[136:137], v244 offset:40960
  v_mfma_f32_16x16x32_bf16 v[116:119], v[144:147], v[232:235], v[116:119]
  ds_read_b64_tr_b16 v[138:139], v244 offset:43008
  s_waitcnt lgkmcnt(6)
  v_mfma_f32_16x16x32_bf16 v[120:123], v[148:151], v[228:231], v[120:123]
  ds_read_b64_tr_b16 v[140:141], v245 offset:40960
  v_mfma_f32_16x16x32_bf16 v[124:127], v[148:151], v[232:235], v[124:127]
  ds_read_b64_tr_b16 v[142:143], v245 offset:43008
  s_waitcnt lgkmcnt(6)
  v_mfma_f32_16x16x32_bf16 v[112:115], v[128:131], v[32:35], v[112:115]
  ds_read_b64_tr_b16 v[144:145], v246 offset:40960
  v_mfma_f32_16x16x32_bf16 v[116:119], v[128:131], v[36:39], v[116:119]
  ds_read_b64_tr_b16 v[146:147], v246 offset:43008
  s_waitcnt lgkmcnt(6)
  v_mfma_f32_16x16x32_bf16 v[120:123], v[132:135], v[32:35], v[120:123]
  ds_read_b64_tr_b16 v[148:149], v247 offset:40960
  v_mfma_f32_16x16x32_bf16 v[124:127], v[132:135], v[36:39], v[124:127]
  ds_read_b64_tr_b16 v[150:151], v247 offset:43008
  s_waitcnt lgkmcnt(0)
  s_waitcnt vmcnt(10)
  s_barrier
  v_add_u32 v244, 4294868992, v244
  v_add_u32 v245, 4294868992, v245
  v_add_u32 v246, 4294868992, v246
  v_add_u32 v247, 4294868992, v247
  v_mfma_f32_16x16x32_bf16 v[112:115], v[136:139], v[236:239], v[112:115]
  ds_read_b64_tr_b16 v[128:129], v244 offset:0
  v_mfma_f32_16x16x32_bf16 v[116:119], v[136:139], v[240:243], v[116:119]
  ds_read_b64_tr_b16 v[130:131], v244 offset:2048
  s_add_u32 m0, s38, 98304
  s_add_u32 s37, s40, 768
  buffer_load_dwordx4 v248, s[16:19], s37 offen lds
  v_mfma_f32_16x16x32_bf16 v[120:123], v[140:143], v[236:239], v[120:123]
  ds_read_b64_tr_b16 v[132:133], v245 offset:0
  v_mfma_f32_16x16x32_bf16 v[124:127], v[140:143], v[240:243], v[124:127]
  ds_read_b64_tr_b16 v[134:135], v245 offset:2048
  v_mfma_f32_16x16x32_bf16 v[112:115], v[144:147], v[40:43], v[112:115]
  ds_read_b64_tr_b16 v[136:137], v246 offset:0
  s_add_u32 m0, s38, 106496
  s_add_u32 s37, s40, 74496
  buffer_load_dwordx4 v248, s[16:19], s37 offen lds
  v_mfma_f32_16x16x32_bf16 v[116:119], v[144:147], v[44:47], v[116:119]
  ds_read_b64_tr_b16 v[138:139], v246 offset:2048
  v_mfma_f32_16x16x32_bf16 v[120:123], v[148:151], v[40:43], v[120:123]
  ds_read_b64_tr_b16 v[140:141], v247 offset:0
  v_mfma_f32_16x16x32_bf16 v[124:127], v[148:151], v[44:47], v[124:127]
  ds_read_b64_tr_b16 v[142:143], v247 offset:2048
  s_add_u32 m0, s38, 114688
  s_add_u32 s37, s40, 148224
  buffer_load_dwordx4 v248, s[16:19], s37 offen lds
  s_waitcnt lgkmcnt(6)
  v_mfma_f32_16x16x32_bf16 v[96:99], v[128:131], v[196:199], 0
  ds_read_b64_tr_b16 v[144:145], v244 offset:8192
  v_mfma_f32_16x16x32_bf16 v[100:103], v[128:131], v[200:203], 0
  ds_read_b64_tr_b16 v[146:147], v244 offset:10240
  s_waitcnt lgkmcnt(6)
  v_mfma_f32_16x16x32_bf16 v[104:107], v[132:135], v[196:199], 0
  ds_read_b64_tr_b16 v[148:149], v245 offset:8192
  s_add_u32 m0, s38, 122880
  s_add_u32 s37, s40, 221952
  buffer_load_dwordx4 v248, s[16:19], s37 offen lds
  v_mfma_f32_16x16x32_bf16 v[108:111], v[132:135], v[200:203], 0
  ds_read_b64_tr_b16 v[150:151], v245 offset:10240
  s_waitcnt lgkmcnt(6)
  v_mfma_f32_16x16x32_bf16 v[96:99], v[136:139], v[0:3], v[96:99]
  ds_read_b64_tr_b16 v[128:129], v246 offset:8192
  v_mfma_f32_16x16x32_bf16 v[100:103], v[136:139], v[4:7], v[100:103]
  ds_read_b64_tr_b16 v[130:131], v246 offset:10240
  s_add_u32 m0, s38, 131072
  s_add_u32 s37, s40, 295680
  buffer_load_dwordx4 v248, s[16:19], s37 offen lds
  s_waitcnt lgkmcnt(6)
  v_mfma_f32_16x16x32_bf16 v[104:107], v[140:143], v[0:3], v[104:107]
  ds_read_b64_tr_b16 v[132:133], v247 offset:8192
  v_mfma_f32_16x16x32_bf16 v[108:111], v[140:143], v[4:7], v[108:111]
  ds_read_b64_tr_b16 v[134:135], v247 offset:10240
  s_waitcnt lgkmcnt(6)
  v_mfma_f32_16x16x32_bf16 v[96:99], v[144:147], v[204:207], v[96:99]
  ds_read_b64_tr_b16 v[136:137], v244 offset:16384
  s_add_u32 m0, s38, 139264
  s_add_u32 s37, s40, 369408
  buffer_load_dwordx4 v248, s[16:19], s37 offen lds
  v_cvt_pk_bf16_f32 v168, v112, v113
  v_mfma_f32_16x16x32_bf16 v[100:103], v[144:147], v[208:211], v[100:103]
  ds_read_b64_tr_b16 v[138:139], v244 offset:18432
  v_cvt_pk_bf16_f32 v169, v114, v115
  s_waitcnt lgkmcnt(6)
  v_mfma_f32_16x16x32_bf16 v[104:107], v[148:151], v[204:207], v[104:107]
  ds_read_b64_tr_b16 v[140:141], v245 offset:16384
  v_cvt_pk_bf16_f32 v170, v120, v121
  v_mfma_f32_16x16x32_bf16 v[108:111], v[148:151], v[208:211], v[108:111]
  ds_read_b64_tr_b16 v[142:143], v245 offset:18432
  v_cvt_pk_bf16_f32 v171, v122, v123
  s_waitcnt lgkmcnt(6)
  v_mfma_f32_16x16x32_bf16 v[96:99], v[128:131], v[8:11], v[96:99]
  ds_read_b64_tr_b16 v[144:145], v246 offset:16384
  v_cvt_pk_bf16_f32 v172, v116, v117
  v_mfma_f32_16x16x32_bf16 v[100:103], v[128:131], v[12:15], v[100:103]
  ds_read_b64_tr_b16 v[146:147], v246 offset:18432
  v_cvt_pk_bf16_f32 v173, v118, v119
  s_waitcnt lgkmcnt(6)
  v_mfma_f32_16x16x32_bf16 v[104:107], v[132:135], v[8:11], v[104:107]
  ds_read_b64_tr_b16 v[148:149], v247 offset:16384
  v_cvt_pk_bf16_f32 v174, v124, v125
  v_mfma_f32_16x16x32_bf16 v[108:111], v[132:135], v[12:15], v[108:111]
  ds_read_b64_tr_b16 v[150:151], v247 offset:18432
  v_cvt_pk_bf16_f32 v175, v126, v127
  s_waitcnt lgkmcnt(6)
  v_mfma_f32_16x16x32_bf16 v[96:99], v[136:139], v[212:215], v[96:99]
  ds_read_b64_tr_b16 v[128:129], v244 offset:24576
  v_mfma_f32_16x16x32_bf16 v[100:103], v[136:139], v[216:219], v[100:103]
  ds_read_b64_tr_b16 v[130:131], v244 offset:26624
  s_waitcnt lgkmcnt(6)
  v_mfma_f32_16x16x32_bf16 v[104:107], v[140:143], v[212:215], v[104:107]
  ds_read_b64_tr_b16 v[132:133], v245 offset:24576
  v_mfma_f32_16x16x32_bf16 v[108:111], v[140:143], v[216:219], v[108:111]
  ds_read_b64_tr_b16 v[134:135], v245 offset:26624
  s_waitcnt lgkmcnt(6)
  v_mfma_f32_16x16x32_bf16 v[96:99], v[144:147], v[16:19], v[96:99]
  ds_read_b64_tr_b16 v[136:137], v246 offset:24576
  s_add_u32 s35, s39, 49152
  buffer_store_dwordx4 v[168:171], v254, s[20:23], s35 offen offset:0 sc1
  buffer_store_dwordx4 v[172:175], v254, s[20:23], s35 offen offset:1024 sc1
  v_mfma_f32_16x16x32_bf16 v[100:103], v[144:147], v[20:23], v[100:103]
  ds_read_b64_tr_b16 v[138:139], v246 offset:26624
  s_waitcnt lgkmcnt(6)
  v_mfma_f32_16x16x32_bf16 v[104:107], v[148:151], v[16:19], v[104:107]
  ds_read_b64_tr_b16 v[140:141], v247 offset:24576
  v_mfma_f32_16x16x32_bf16 v[108:111], v[148:151], v[20:23], v[108:111]
  ds_read_b64_tr_b16 v[142:143], v247 offset:26624
  s_waitcnt lgkmcnt(6)
  v_mfma_f32_16x16x32_bf16 v[96:99], v[128:131], v[220:223], v[96:99]
  ds_read_b64_tr_b16 v[144:145], v244 offset:32768
  v_mfma_f32_16x16x32_bf16 v[100:103], v[128:131], v[224:227], v[100:103]
  ds_read_b64_tr_b16 v[146:147], v244 offset:34816
  s_waitcnt lgkmcnt(6)
  v_mfma_f32_16x16x32_bf16 v[104:107], v[132:135], v[220:223], v[104:107]
  ds_read_b64_tr_b16 v[148:149], v245 offset:32768
  v_mfma_f32_16x16x32_bf16 v[108:111], v[132:135], v[224:227], v[108:111]
  ds_read_b64_tr_b16 v[150:151], v245 offset:34816
  s_waitcnt lgkmcnt(6)
  v_mfma_f32_16x16x32_bf16 v[96:99], v[136:139], v[24:27], v[96:99]
  ds_read_b64_tr_b16 v[128:129], v246 offset:32768
  v_mfma_f32_16x16x32_bf16 v[100:103], v[136:139], v[28:31], v[100:103]
  ds_read_b64_tr_b16 v[130:131], v246 offset:34816
  s_waitcnt lgkmcnt(6)
  v_mfma_f32_16x16x32_bf16 v[104:107], v[140:143], v[24:27], v[104:107]
  ds_read_b64_tr_b16 v[132:133], v247 offset:32768
  v_mfma_f32_16x16x32_bf16 v[108:111], v[140:143], v[28:31], v[108:111]
  ds_read_b64_tr_b16 v[134:135], v247 offset:34816
  s_waitcnt lgkmcnt(6)
  v_mfma_f32_16x16x32_bf16 v[96:99], v[144:147], v[228:231], v[96:99]
  ds_read_b64_tr_b16 v[136:137], v244 offset:40960
  v_mfma_f32_16x16x32_bf16 v[100:103], v[144:147], v[232:235], v[100:103]
  ds_read_b64_tr_b16 v[138:139], v244 offset:43008
  s_waitcnt lgkmcnt(6)
  v_mfma_f32_16x16x32_bf16 v[104:107], v[148:151], v[228:231], v[104:107]
  ds_read_b64_tr_b16 v[140:141], v245 offset:40960
  v_mfma_f32_16x16x32_bf16 v[108:111], v[148:151], v[232:235], v[108:111]
  ds_read_b64_tr_b16 v[142:143], v245 offset:43008
  s_waitcnt lgkmcnt(6)
  v_mfma_f32_16x16x32_bf16 v[96:99], v[128:131], v[32:35], v[96:99]
  ds_read_b64_tr_b16 v[144:145], v246 offset:40960
  v_mfma_f32_16x16x32_bf16 v[100:103], v[128:131], v[36:39], v[100:103]
  ds_read_b64_tr_b16 v[146:147], v246 offset:43008
  s_waitcnt lgkmcnt(6)
  v_mfma_f32_16x16x32_bf16 v[104:107], v[132:135], v[32:35], v[104:107]
  ds_read_b64_tr_b16 v[148:149], v247 offset:40960
  v_mfma_f32_16x16x32_bf16 v[108:111], v[132:135], v[36:39], v[108:111]
  ds_read_b64_tr_b16 v[150:151], v247 offset:43008
  s_waitcnt lgkmcnt(0)
  s_waitcnt vmcnt(10)
  s_barrier
  v_add_u32 v244, 49152, v244
  v_add_u32 v245, 49152, v245
  v_add_u32 v246, 49152, v246
  v_add_u32 v247, 49152, v247
  v_mfma_f32_16x16x32_bf16 v[96:99], v[136:139], v[236:239], v[96:99]
  ds_read_b64_tr_b16 v[128:129], v244 offset:0
  v_mfma_f32_16x16x32_bf16 v[100:103], v[136:139], v[240:243], v[100:103]
  ds_read_b64_tr_b16 v[130:131], v244 offset:2048
  s_add_u32 m0, s38, 0
  s_add_u32 s37, s40, 896
  buffer_load_dwordx4 v248, s[16:19], s37 offen lds
  v_mfma_f32_16x16x32_bf16 v[104:107], v[140:143], v[236:239], v[104:107]
  ds_read_b64_tr_b16 v[132:133], v245 offset:0
  v_mfma_f32_16x16x32_bf16 v[108:111], v[140:143], v[240:243], v[108:111]
  ds_read_b64_tr_b16 v[134:135], v245 offset:2048
  v_mfma_f32_16x16x32_bf16 v[96:99], v[144:147], v[40:43], v[96:99]
  ds_read_b64_tr_b16 v[136:137], v246 offset:0
  s_add_u32 m0, s38, 8192
  s_add_u32 s37, s40, 74624
  buffer_load_dwordx4 v248, s[16:19], s37 offen lds
  v_mfma_f32_16x16x32_bf16 v[100:103], v[144:147], v[44:47], v[100:103]
  ds_read_b64_tr_b16 v[138:139], v246 offset:2048
  v_mfma_f32_16x16x32_bf16 v[104:107], v[148:151], v[40:43], v[104:107]
  ds_read_b64_tr_b16 v[140:141], v247 offset:0
  v_mfma_f32_16x16x32_bf16 v[108:111], v[148:151], v[44:47], v[108:111]
  ds_read_b64_tr_b16 v[142:143], v247 offset:2048
  s_add_u32 m0, s38, 16384
  s_add_u32 s37, s40, 148352
  buffer_load_dwordx4 v248, s[16:19], s37 offen lds
  s_waitcnt lgkmcnt(6)
  v_mfma_f32_16x16x32_bf16 v[112:115], v[128:131], v[196:199], 0
  ds_read_b64_tr_b16 v[144:145], v244 offset:8192
  v_mfma_f32_16x16x32_bf16 v[116:119], v[128:131], v[200:203], 0
  ds_read_b64_tr_b16 v[146:147], v244 offset:10240
  s_waitcnt lgkmcnt(6)
  v_mfma_f32_16x16x32_bf16 v[120:123], v[132:135], v[196:199], 0
  ds_read_b64_tr_b16 v[148:149], v245 offset:8192
  s_add_u32 m0, s38, 24576
  s_add_u32 s37, s40, 222080
  buffer_load_dwordx4 v248, s[16:19], s37 offen lds
  v_mfma_f32_16x16x32_bf16 v[124:127], v[132:135], v[200:203], 0
  ds_read_b64_tr_b16 v[150:151], v245 offset:10240
  s_waitcnt lgkmcnt(6)
  v_mfma_f32_16x16x32_bf16 v[112:115], v[136:139], v[0:3], v[112:115]
  ds_read_b64_tr_b16 v[128:129], v246 offset:8192
  v_mfma_f32_16x16x32_bf16 v[116:119], v[136:139], v[4:7], v[116:119]
  ds_read_b64_tr_b16 v[130:131], v246 offset:10240
  s_add_u32 m0, s38, 32768
  s_add_u32 s37, s40, 295808
  buffer_load_dwordx4 v248, s[16:19], s37 offen lds
  s_waitcnt lgkmcnt(6)
  v_mfma_f32_16x16x32_bf16 v[120:123], v[140:143], v[0:3], v[120:123]
  ds_read_b64_tr_b16 v[132:133], v247 offset:8192
  v_mfma_f32_16x16x32_bf16 v[124:127], v[140:143], v[4:7], v[124:127]
  ds_read_b64_tr_b16 v[134:135], v247 offset:10240
  s_waitcnt lgkmcnt(6)
  v_mfma_f32_16x16x32_bf16 v[112:115], v[144:147], v[204:207], v[112:115]
  ds_read_b64_tr_b16 v[136:137], v244 offset:16384
  s_add_u32 m0, s38, 40960
  s_add_u32 s37, s40, 369536
  buffer_load_dwordx4 v248, s[16:19], s37 offen lds
  v_cvt_pk_bf16_f32 v160, v96, v97
  v_mfma_f32_16x16x32_bf16 v[116:119], v[144:147], v[208:211], v[116:119]
  ds_read_b64_tr_b16 v[138:139], v244 offset:18432
  v_cvt_pk_bf16_f32 v161, v98, v99
  s_waitcnt lgkmcnt(6)
  v_mfma_f32_16x16x32_bf16 v[120:123], v[148:151], v[204:207], v[120:123]
  ds_read_b64_tr_b16 v[140:141], v245 offset:16384
  v_cvt_pk_bf16_f32 v162, v104, v105
  v_mfma_f32_16x16x32_bf16 v[124:127], v[148:151], v[208:211], v[124:127]
  ds_read_b64_tr_b16 v[142:143], v245 offset:18432
  v_cvt_pk_bf16_f32 v163, v106, v107
  s_waitcnt lgkmcnt(6)
  v_mfma_f32_16x16x32_bf16 v[112:115], v[128:131], v[8:11], v[112:115]
  ds_read_b64_tr_b16 v[144:145], v246 offset:16384
  v_cvt_pk_bf16_f32 v164, v100, v101
  v_mfma_f32_16x16x32_bf16 v[116:119], v[128:131], v[12:15], v[116:119]
  ds_read_b64_tr_b16 v[146:147], v246 offset:18432
  v_cvt_pk_bf16_f32 v165, v102, v103
  s_waitcnt lgkmcnt(6)
  v_mfma_f32_16x16x32_bf16 v[120:123], v[132:135], v[8:11], v[120:123]
  ds_read_b64_tr_b16 v[148:149], v247 offset:16384
  v_cvt_pk_bf16_f32 v166, v108, v109
  v_mfma_f32_16x16x32_bf16 v[124:127], v[132:135], v[12:15], v[124:127]
  ds_read_b64_tr_b16 v[150:151], v247 offset:18432
  v_cvt_pk_bf16_f32 v167, v110, v111
  s_waitcnt lgkmcnt(6)
  v_mfma_f32_16x16x32_bf16 v[112:115], v[136:139], v[212:215], v[112:115]
  ds_read_b64_tr_b16 v[128:129], v244 offset:24576
  v_mfma_f32_16x16x32_bf16 v[116:119], v[136:139], v[216:219], v[116:119]
  ds_read_b64_tr_b16 v[130:131], v244 offset:26624
  s_waitcnt lgkmcnt(6)
  v_mfma_f32_16x16x32_bf16 v[120:123], v[140:143], v[212:215], v[120:123]
  ds_read_b64_tr_b16 v[132:133], v245 offset:24576
  v_mfma_f32_16x16x32_bf16 v[124:127], v[140:143], v[216:219], v[124:127]
  ds_read_b64_tr_b16 v[134:135], v245 offset:26624
  s_waitcnt lgkmcnt(6)
  v_mfma_f32_16x16x32_bf16 v[112:115], v[144:147], v[16:19], v[112:115]
  ds_read_b64_tr_b16 v[136:137], v246 offset:24576
  s_add_u32 s35, s39, 65536
  buffer_store_dwordx4 v[160:163], v254, s[20:23], s35 offen offset:0 sc1
  buffer_store_dwordx4 v[164:167], v254, s[20:23], s35 offen offset:1024 sc1
  v_mfma_f32_16x16x32_bf16 v[116:119], v[144:147], v[20:23], v[116:119]
  ds_read_b64_tr_b16 v[138:139], v246 offset:26624
  s_waitcnt lgkmcnt(6)
  v_mfma_f32_16x16x32_bf16 v[120:123], v[148:151], v[16:19], v[120:123]
  ds_read_b64_tr_b16 v[140:141], v247 offset:24576
  v_mfma_f32_16x16x32_bf16 v[124:127], v[148:151], v[20:23], v[124:127]
  ds_read_b64_tr_b16 v[142:143], v247 offset:26624
  s_waitcnt lgkmcnt(6)
  v_mfma_f32_16x16x32_bf16 v[112:115], v[128:131], v[220:223], v[112:115]
  ds_read_b64_tr_b16 v[144:145], v244 offset:32768
  v_mfma_f32_16x16x32_bf16 v[116:119], v[128:131], v[224:227], v[116:119]
  ds_read_b64_tr_b16 v[146:147], v244 offset:34816
  s_waitcnt lgkmcnt(6)
  v_mfma_f32_16x16x32_bf16 v[120:123], v[132:135], v[220:223], v[120:123]
  ds_read_b64_tr_b16 v[148:149], v245 offset:32768
  v_mfma_f32_16x16x32_bf16 v[124:127], v[132:135], v[224:227], v[124:127]
  ds_read_b64_tr_b16 v[150:151], v245 offset:34816
  s_waitcnt lgkmcnt(6)
  v_mfma_f32_16x16x32_bf16 v[112:115], v[136:139], v[24:27], v[112:115]
  ds_read_b64_tr_b16 v[128:129], v246 offset:32768
  v_mfma_f32_16x16x32_bf16 v[116:119], v[136:139], v[28:31], v[116:119]
  ds_read_b64_tr_b16 v[130:131], v246 offset:34816
  s_waitcnt lgkmcnt(6)
  v_mfma_f32_16x16x32_bf16 v[120:123], v[140:143], v[24:27], v[120:123]
  ds_read_b64_tr_b16 v[132:133], v247 offset:32768
  v_mfma_f32_16x16x32_bf16 v[124:127], v[140:143], v[28:31], v[124:127]
  ds_read_b64_tr_b16 v[134:135], v247 offset:34816
  s_waitcnt lgkmcnt(6)
  v_mfma_f32_16x16x32_bf16 v[112:115], v[144:147], v[228:231], v[112:115]
  ds_read_b64_tr_b16 v[136:137], v244 offset:40960
  v_mfma_f32_16x16x32_bf16 v[116:119], v[144:147], v[232:235], v[116:119]
  ds_read_b64_tr_b16 v[138:139], v244 offset:43008
  s_waitcnt lgkmcnt(6)
  v_mfma_f32_16x16x32_bf16 v[120:123], v[148:151], v[228:231], v[120:123]
  ds_read_b64_tr_b16 v[140:141], v245 offset:40960
  v_mfma_f32_16x16x32_bf16 v[124:127], v[148:151], v[232:235], v[124:127]
  ds_read_b64_tr_b16 v[142:143], v245 offset:43008
  s_waitcnt lgkmcnt(6)
  v_mfma_f32_16x16x32_bf16 v[112:115], v[128:131], v[32:35], v[112:115]
  ds_read_b64_tr_b16 v[144:145], v246 offset:40960
  v_mfma_f32_16x16x32_bf16 v[116:119], v[128:131], v[36:39], v[116:119]
  ds_read_b64_tr_b16 v[146:147], v246 offset:43008
  s_waitcnt lgkmcnt(6)
  v_mfma_f32_16x16x32_bf16 v[120:123], v[132:135], v[32:35], v[120:123]
  ds_read_b64_tr_b16 v[148:149], v247 offset:40960
  v_mfma_f32_16x16x32_bf16 v[124:127], v[132:135], v[36:39], v[124:127]
  ds_read_b64_tr_b16 v[150:151], v247 offset:43008
  s_waitcnt lgkmcnt(0)
  s_waitcnt vmcnt(10)
  s_barrier
  v_add_u32 v244, 49152, v244
  v_add_u32 v245, 49152, v245
  v_add_u32 v246, 49152, v246
  v_add_u32 v247, 49152, v247
  v_mfma_f32_16x16x32_bf16 v[112:115], v[136:139], v[236:239], v[112:115]
  ds_read_b64_tr_b16 v[128:129], v244 offset:0
  v_mfma_f32_16x16x32_bf16 v[116:119], v[136:139], v[240:243], v[116:119]
  ds_read_b64_tr_b16 v[130:131], v244 offset:2048
  s_add_u32 m0, s38, 49152
  s_add_u32 s37, s40, 1024
  buffer_load_dwordx4 v248, s[16:19], s37 offen lds
  v_mfma_f32_16x16x32_bf16 v[120:123], v[140:143], v[236:239], v[120:123]
  ds_read_b64_tr_b16 v[132:133], v245 offset:0
  v_mfma_f32_16x16x32_bf16 v[124:127], v[140:143], v[240:243], v[124:127]
  ds_read_b64_tr_b16 v[134:135], v245 offset:2048
  v_mfma_f32_16x16x32_bf16 v[112:115], v[144:147], v[40:43], v[112:115]
  ds_read_b64_tr_b16 v[136:137], v246 offset:0
  s_add_u32 m0, s38, 57344
  s_add_u32 s37, s40, 74752
  buffer_load_dwordx4 v248, s[16:19], s37 offen lds
  v_mfma_f32_16x16x32_bf16 v[116:119], v[144:147], v[44:47], v[116:119]
  ds_read_b64_tr_b16 v[138:139], v246 offset:2048
  v_mfma_f32_16x16x32_bf16 v[120:123], v[148:151], v[40:43], v[120:123]
  ds_read_b64_tr_b16 v[140:141], v247 offset:0
  v_mfma_f32_16x16x32_bf16 v[124:127], v[148:151], v[44:47], v[124:127]
  ds_read_b64_tr_b16 v[142:143], v247 offset:2048
  s_add_u32 m0, s38, 65536
  s_add_u32 s37, s40, 148480
  buffer_load_dwordx4 v248, s[16:19], s37 offen lds
  s_waitcnt lgkmcnt(6)
  v_mfma_f32_16x16x32_bf16 v[96:99], v[128:131], v[196:199], 0
  ds_read_b64_tr_b16 v[144:145], v244 offset:8192
  v_mfma_f32_16x16x32_bf16 v[100:103], v[128:131], v[200:203], 0
  ds_read_b64_tr_b16 v[146:147], v244 offset:10240
  s_waitcnt lgkmcnt(6)
  v_mfma_f32_16x16x32_bf16 v[104:107], v[132:135], v[196:199], 0
  ds_read_b64_tr_b16 v[148:149], v245 offset:8192
  s_add_u32 m0, s38, 73728
  s_add_u32 s37, s40, 222208
  buffer_load_dwordx4 v248, s[16:19], s37 offen lds
  v_mfma_f32_16x16x32_bf16 v[108:111], v[132:135], v[200:203], 0
  ds_read_b64_tr_b16 v[150:151], v245 offset:10240
  s_waitcnt lgkmcnt(6)
  v_mfma_f32_16x16x32_bf16 v[96:99], v[136:139], v[0:3], v[96:99]
  ds_read_b64_tr_b16 v[128:129], v246 offset:8192
  v_mfma_f32_16x16x32_bf16 v[100:103], v[136:139], v[4:7], v[100:103]
  ds_read_b64_tr_b16 v[130:131], v246 offset:10240
  s_add_u32 m0, s38, 81920
  s_add_u32 s37, s40, 295936
  buffer_load_dwordx4 v248, s[16:19], s37 offen lds
  s_waitcnt lgkmcnt(6)
  v_mfma_f32_16x16x32_bf16 v[104:107], v[140:143], v[0:3], v[104:107]
  ds_read_b64_tr_b16 v[132:133], v247 offset:8192
  v_mfma_f32_16x16x32_bf16 v[108:111], v[140:143], v[4:7], v[108:111]
  ds_read_b64_tr_b16 v[134:135], v247 offset:10240
  s_waitcnt lgkmcnt(6)
  v_mfma_f32_16x16x32_bf16 v[96:99], v[144:147], v[204:207], v[96:99]
  ds_read_b64_tr_b16 v[136:137], v244 offset:16384
  s_add_u32 m0, s38, 90112
  s_add_u32 s37, s40, 369664
  buffer_load_dwordx4 v248, s[16:19], s37 offen lds
  v_cvt_pk_bf16_f32 v168, v112, v113
  v_mfma_f32_16x16x32_bf16 v[100:103], v[144:147], v[208:211], v[100:103]
  ds_read_b64_tr_b16 v[138:139], v244 offset:18432
  v_cvt_pk_bf16_f32 v169, v114, v115
  s_waitcnt lgkmcnt(6)
  v_mfma_f32_16x16x32_bf16 v[104:107], v[148:151], v[204:207], v[104:107]
  ds_read_b64_tr_b16 v[140:141], v245 offset:16384
  v_cvt_pk_bf16_f32 v170, v120, v121
  v_mfma_f32_16x16x32_bf16 v[108:111], v[148:151], v[208:211], v[108:111]
  ds_read_b64_tr_b16 v[142:143], v245 offset:18432
  v_cvt_pk_bf16_f32 v171, v122, v123
  s_waitcnt lgkmcnt(6)
  v_mfma_f32_16x16x32_bf16 v[96:99], v[128:131], v[8:11], v[96:99]
  ds_read_b64_tr_b16 v[144:145], v246 offset:16384
  v_cvt_pk_bf16_f32 v172, v116, v117
  v_mfma_f32_16x16x32_bf16 v[100:103], v[128:131], v[12:15], v[100:103]
  ds_read_b64_tr_b16 v[146:147], v246 offset:18432
  v_cvt_pk_bf16_f32 v173, v118, v119
  s_waitcnt lgkmcnt(6)
  v_mfma_f32_16x16x32_bf16 v[104:107], v[132:135], v[8:11], v[104:107]
  ds_read_b64_tr_b16 v[148:149], v247 offset:16384
  v_cvt_pk_bf16_f32 v174, v124, v125
  v_mfma_f32_16x16x32_bf16 v[108:111], v[132:135], v[12:15], v[108:111]
  ds_read_b64_tr_b16 v[150:151], v247 offset:18432
  v_cvt_pk_bf16_f32 v175, v126, v127
  s_waitcnt lgkmcnt(6)
  v_mfma_f32_16x16x32_bf16 v[96:99], v[136:139], v[212:215], v[96:99]
  ds_read_b64_tr_b16 v[128:129], v244 offset:24576
  v_mfma_f32_16x16x32_bf16 v[100:103], v[136:139], v[216:219], v[100:103]
  ds_read_b64_tr_b16 v[130:131], v244 offset:26624
  s_waitcnt lgkmcnt(6)
  v_mfma_f32_16x16x32_bf16 v[104:107], v[140:143], v[212:215], v[104:107]
  ds_read_b64_tr_b16 v[132:133], v245 offset:24576
  v_mfma_f32_16x16x32_bf16 v[108:111], v[140:143], v[216:219], v[108:111]
  ds_read_b64_tr_b16 v[134:135], v245 offset:26624
  s_waitcnt lgkmcnt(6)
  v_mfma_f32_16x16x32_bf16 v[96:99], v[144:147], v[16:19], v[96:99]
  ds_read_b64_tr_b16 v[136:137], v246 offset:24576
  s_add_u32 s35, s39, 81920
  buffer_store_dwordx4 v[168:171], v254, s[20:23], s35 offen offset:0 sc1
  buffer_store_dwordx4 v[172:175], v254, s[20:23], s35 offen offset:1024 sc1
  v_mfma_f32_16x16x32_bf16 v[100:103], v[144:147], v[20:23], v[100:103]
  ds_read_b64_tr_b16 v[138:139], v246 offset:26624
  s_waitcnt lgkmcnt(6)
  v_mfma_f32_16x16x32_bf16 v[104:107], v[148:151], v[16:19], v[104:107]
  ds_read_b64_tr_b16 v[140:141], v247 offset:24576
  v_mfma_f32_16x16x32_bf16 v[108:111], v[148:151], v[20:23], v[108:111]
  ds_read_b64_tr_b16 v[142:143], v247 offset:26624
  s_waitcnt lgkmcnt(6)
  v_mfma_f32_16x16x32_bf16 v[96:99], v[128:131], v[220:223], v[96:99]
  ds_read_b64_tr_b16 v[144:145], v244 offset:32768
  v_mfma_f32_16x16x32_bf16 v[100:103], v[128:131], v[224:227], v[100:103]
  ds_read_b64_tr_b16 v[146:147], v244 offset:34816
  s_waitcnt lgkmcnt(6)
  v_mfma_f32_16x16x32_bf16 v[104:107], v[132:135], v[220:223], v[104:107]
  ds_read_b64_tr_b16 v[148:149], v245 offset:32768
  v_mfma_f32_16x16x32_bf16 v[108:111], v[132:135], v[224:227], v[108:111]
  ds_read_b64_tr_b16 v[150:151], v245 offset:34816
  s_waitcnt lgkmcnt(6)
  v_mfma_f32_16x16x32_bf16 v[96:99], v[136:139], v[24:27], v[96:99]
  ds_read_b64_tr_b16 v[128:129], v246 offset:32768
  v_mfma_f32_16x16x32_bf16 v[100:103], v[136:139], v[28:31], v[100:103]
  ds_read_b64_tr_b16 v[130:131], v246 offset:34816
  s_waitcnt lgkmcnt(6)
  v_mfma_f32_16x16x32_bf16 v[104:107], v[140:143], v[24:27], v[104:107]
  ds_read_b64_tr_b16 v[132:133], v247 offset:32768
  v_mfma_f32_16x16x32_bf16 v[108:111], v[140:143], v[28:31], v[108:111]
  ds_read_b64_tr_b16 v[134:135], v247 offset:34816
  s_waitcnt lgkmcnt(6)
  v_mfma_f32_16x16x32_bf16 v[96:99], v[144:147], v[228:231], v[96:99]
  ds_read_b64_tr_b16 v[136:137], v244 offset:40960
  v_mfma_f32_16x16x32_bf16 v[100:103], v[144:147], v[232:235], v[100:103]
  ds_read_b64_tr_b16 v[138:139], v244 offset:43008
  s_waitcnt lgkmcnt(6)
  v_mfma_f32_16x16x32_bf16 v[104:107], v[148:151], v[228:231], v[104:107]
  ds_read_b64_tr_b16 v[140:141], v245 offset:40960
  v_mfma_f32_16x16x32_bf16 v[108:111], v[148:151], v[232:235], v[108:111]
  ds_read_b64_tr_b16 v[142:143], v245 offset:43008
  s_waitcnt lgkmcnt(6)
  v_mfma_f32_16x16x32_bf16 v[96:99], v[128:131], v[32:35], v[96:99]
  ds_read_b64_tr_b16 v[144:145], v246 offset:40960
  v_mfma_f32_16x16x32_bf16 v[100:103], v[128:131], v[36:39], v[100:103]
  ds_read_b64_tr_b16 v[146:147], v246 offset:43008
  s_waitcnt lgkmcnt(6)
  v_mfma_f32_16x16x32_bf16 v[104:107], v[132:135], v[32:35], v[104:107]
  ds_read_b64_tr_b16 v[148:149], v247 offset:40960
  v_mfma_f32_16x16x32_bf16 v[108:111], v[132:135], v[36:39], v[108:111]
  ds_read_b64_tr_b16 v[150:151], v247 offset:43008
  s_waitcnt lgkmcnt(0)
  s_waitcnt vmcnt(10)
  s_barrier
  v_add_u32 v244, 4294868992, v244
  v_add_u32 v245, 4294868992, v245
  v_add_u32 v246, 4294868992, v246
  v_add_u32 v247, 4294868992, v247
  v_mfma_f32_16x16x32_bf16 v[96:99], v[136:139], v[236:239], v[96:99]
  ds_read_b64_tr_b16 v[128:129], v244 offset:0
  v_mfma_f32_16x16x32_bf16 v[100:103], v[136:139], v[240:243], v[100:103]
  ds_read_b64_tr_b16 v[130:131], v244 offset:2048
  v_mfma_f32_16x16x32_bf16 v[104:107], v[140:143], v[236:239], v[104:107]
  ds_read_b64_tr_b16 v[132:133], v245 offset:0
  v_mfma_f32_16x16x32_bf16 v[108:111], v[140:143], v[240:243], v[108:111]
  ds_read_b64_tr_b16 v[134:135], v245 offset:2048
  v_mfma_f32_16x16x32_bf16 v[96:99], v[144:147], v[40:43], v[96:99]
  ds_read_b64_tr_b16 v[136:137], v246 offset:0
  v_mfma_f32_16x16x32_bf16 v[100:103], v[144:147], v[44:47], v[100:103]
  ds_read_b64_tr_b16 v[138:139], v246 offset:2048
  v_mfma_f32_16x16x32_bf16 v[104:107], v[148:151], v[40:43], v[104:107]
  ds_read_b64_tr_b16 v[140:141], v247 offset:0
  v_mfma_f32_16x16x32_bf16 v[108:111], v[148:151], v[44:47], v[108:111]
  ds_read_b64_tr_b16 v[142:143], v247 offset:2048
  s_waitcnt lgkmcnt(6)
  v_mfma_f32_16x16x32_bf16 v[112:115], v[128:131], v[196:199], 0
  ds_read_b64_tr_b16 v[144:145], v244 offset:8192
  v_mfma_f32_16x16x32_bf16 v[116:119], v[128:131], v[200:203], 0
  ds_read_b64_tr_b16 v[146:147], v244 offset:10240
  s_waitcnt lgkmcnt(6)
  v_mfma_f32_16x16x32_bf16 v[120:123], v[132:135], v[196:199], 0
  ds_read_b64_tr_b16 v[148:149], v245 offset:8192
  v_mfma_f32_16x16x32_bf16 v[124:127], v[132:135], v[200:203], 0
  ds_read_b64_tr_b16 v[150:151], v245 offset:10240
  s_waitcnt lgkmcnt(6)
  v_mfma_f32_16x16x32_bf16 v[112:115], v[136:139], v[0:3], v[112:115]
  ds_read_b64_tr_b16 v[128:129], v246 offset:8192
  v_mfma_f32_16x16x32_bf16 v[116:119], v[136:139], v[4:7], v[116:119]
  ds_read_b64_tr_b16 v[130:131], v246 offset:10240
  s_waitcnt lgkmcnt(6)
  v_mfma_f32_16x16x32_bf16 v[120:123], v[140:143], v[0:3], v[120:123]
  ds_read_b64_tr_b16 v[132:133], v247 offset:8192
  v_mfma_f32_16x16x32_bf16 v[124:127], v[140:143], v[4:7], v[124:127]
  ds_read_b64_tr_b16 v[134:135], v247 offset:10240
  s_waitcnt lgkmcnt(6)
  v_mfma_f32_16x16x32_bf16 v[112:115], v[144:147], v[204:207], v[112:115]
  ds_read_b64_tr_b16 v[136:137], v244 offset:16384
  v_cvt_pk_bf16_f32 v160, v96, v97
  v_mfma_f32_16x16x32_bf16 v[116:119], v[144:147], v[208:211], v[116:119]
  ds_read_b64_tr_b16 v[138:139], v244 offset:18432
  v_cvt_pk_bf16_f32 v161, v98, v99
  s_waitcnt lgkmcnt(6)
  v_mfma_f32_16x16x32_bf16 v[120:123], v[148:151], v[204:207], v[120:123]
  ds_read_b64_tr_b16 v[140:141], v245 offset:16384
  v_cvt_pk_bf16_f32 v162, v104, v105
  v_mfma_f32_16x16x32_bf16 v[124:127], v[148:151], v[208:211], v[124:127]
  ds_read_b64_tr_b16 v[142:143], v245 offset:18432
  v_cvt_pk_bf16_f32 v163, v106, v107
  s_waitcnt lgkmcnt(6)
  v_mfma_f32_16x16x32_bf16 v[112:115], v[128:131], v[8:11], v[112:115]
  ds_read_b64_tr_b16 v[144:145], v246 offset:16384
  v_cvt_pk_bf16_f32 v164, v100, v101
  v_mfma_f32_16x16x32_bf16 v[116:119], v[128:131], v[12:15], v[116:119]
  ds_read_b64_tr_b16 v[146:147], v246 offset:18432
  v_cvt_pk_bf16_f32 v165, v102, v103
  s_waitcnt lgkmcnt(6)
  v_mfma_f32_16x16x32_bf16 v[120:123], v[132:135], v[8:11], v[120:123]
  ds_read_b64_tr_b16 v[148:149], v247 offset:16384
  v_cvt_pk_bf16_f32 v166, v108, v109
  v_mfma_f32_16x16x32_bf16 v[124:127], v[132:135], v[12:15], v[124:127]
  ds_read_b64_tr_b16 v[150:151], v247 offset:18432
  v_cvt_pk_bf16_f32 v167, v110, v111
  s_waitcnt lgkmcnt(6)
  v_mfma_f32_16x16x32_bf16 v[112:115], v[136:139], v[212:215], v[112:115]
  ds_read_b64_tr_b16 v[128:129], v244 offset:24576
  v_mfma_f32_16x16x32_bf16 v[116:119], v[136:139], v[216:219], v[116:119]
  ds_read_b64_tr_b16 v[130:131], v244 offset:26624
  s_waitcnt lgkmcnt(6)
  v_mfma_f32_16x16x32_bf16 v[120:123], v[140:143], v[212:215], v[120:123]
  ds_read_b64_tr_b16 v[132:133], v245 offset:24576
  v_mfma_f32_16x16x32_bf16 v[124:127], v[140:143], v[216:219], v[124:127]
  ds_read_b64_tr_b16 v[134:135], v245 offset:26624
  s_waitcnt lgkmcnt(6)
  v_mfma_f32_16x16x32_bf16 v[112:115], v[144:147], v[16:19], v[112:115]
  ds_read_b64_tr_b16 v[136:137], v246 offset:24576
  s_add_u32 s35, s39, 98304
  buffer_store_dwordx4 v[160:163], v254, s[20:23], s35 offen offset:0 sc1
  buffer_store_dwordx4 v[164:167], v254, s[20:23], s35 offen offset:1024 sc1
  v_mfma_f32_16x16x32_bf16 v[116:119], v[144:147], v[20:23], v[116:119]
  ds_read_b64_tr_b16 v[138:139], v246 offset:26624
  s_waitcnt lgkmcnt(6)
  v_mfma_f32_16x16x32_bf16 v[120:123], v[148:151], v[16:19], v[120:123]
  ds_read_b64_tr_b16 v[140:141], v247 offset:24576
  v_mfma_f32_16x16x32_bf16 v[124:127], v[148:151], v[20:23], v[124:127]
  ds_read_b64_tr_b16 v[142:143], v247 offset:26624
  s_waitcnt lgkmcnt(6)
  v_mfma_f32_16x16x32_bf16 v[112:115], v[128:131], v[220:223], v[112:115]
  ds_read_b64_tr_b16 v[144:145], v244 offset:32768
  v_mfma_f32_16x16x32_bf16 v[116:119], v[128:131], v[224:227], v[116:119]
  ds_read_b64_tr_b16 v[146:147], v244 offset:34816
  s_waitcnt lgkmcnt(6)
  v_mfma_f32_16x16x32_bf16 v[120:123], v[132:135], v[220:223], v[120:123]
  ds_read_b64_tr_b16 v[148:149], v245 offset:32768
  v_mfma_f32_16x16x32_bf16 v[124:127], v[132:135], v[224:227], v[124:127]
  ds_read_b64_tr_b16 v[150:151], v245 offset:34816
  s_waitcnt lgkmcnt(6)
  v_mfma_f32_16x16x32_bf16 v[112:115], v[136:139], v[24:27], v[112:115]
  ds_read_b64_tr_b16 v[128:129], v246 offset:32768
  v_mfma_f32_16x16x32_bf16 v[116:119], v[136:139], v[28:31], v[116:119]
  ds_read_b64_tr_b16 v[130:131], v246 offset:34816
  s_waitcnt lgkmcnt(6)
  v_mfma_f32_16x16x32_bf16 v[120:123], v[140:143], v[24:27], v[120:123]
  ds_read_b64_tr_b16 v[132:133], v247 offset:32768
  v_mfma_f32_16x16x32_bf16 v[124:127], v[140:143], v[28:31], v[124:127]
  ds_read_b64_tr_b16 v[134:135], v247 offset:34816
  s_waitcnt lgkmcnt(6)
  v_mfma_f32_16x16x32_bf16 v[112:115], v[144:147], v[228:231], v[112:115]
  ds_read_b64_tr_b16 v[136:137], v244 offset:40960
  v_mfma_f32_16x16x32_bf16 v[116:119], v[144:147], v[232:235], v[116:119]
  ds_read_b64_tr_b16 v[138:139], v244 offset:43008
  s_waitcnt lgkmcnt(6)
  v_mfma_f32_16x16x32_bf16 v[120:123], v[148:151], v[228:231], v[120:123]
  ds_read_b64_tr_b16 v[140:141], v245 offset:40960
  v_mfma_f32_16x16x32_bf16 v[124:127], v[148:151], v[232:235], v[124:127]
  ds_read_b64_tr_b16 v[142:143], v245 offset:43008
  s_waitcnt lgkmcnt(6)
  v_mfma_f32_16x16x32_bf16 v[112:115], v[128:131], v[32:35], v[112:115]
  ds_read_b64_tr_b16 v[144:145], v246 offset:40960
  v_mfma_f32_16x16x32_bf16 v[116:119], v[128:131], v[36:39], v[116:119]
  ds_read_b64_tr_b16 v[146:147], v246 offset:43008
  s_waitcnt lgkmcnt(6)
  v_mfma_f32_16x16x32_bf16 v[120:123], v[132:135], v[32:35], v[120:123]
  ds_read_b64_tr_b16 v[148:149], v247 offset:40960
  v_mfma_f32_16x16x32_bf16 v[124:127], v[132:135], v[36:39], v[124:127]
  ds_read_b64_tr_b16 v[150:151], v247 offset:43008
  s_waitcnt lgkmcnt(0)
  s_waitcnt vmcnt(4)
  s_barrier
  v_add_u32 v244, 49152, v244
  v_add_u32 v245, 49152, v245
  v_add_u32 v246, 49152, v246
  v_add_u32 v247, 49152, v247
  v_mfma_f32_16x16x32_bf16 v[112:115], v[136:139], v[236:239], v[112:115]
  ds_read_b64_tr_b16 v[128:129], v244 offset:0
  v_mfma_f32_16x16x32_bf16 v[116:119], v[136:139], v[240:243], v[116:119]
  ds_read_b64_tr_b16 v[130:131], v244 offset:2048
  v_mfma_f32_16x16x32_bf16 v[120:123], v[140:143], v[236:239], v[120:123]
  ds_read_b64_tr_b16 v[132:133], v245 offset:0
  v_mfma_f32_16x16x32_bf16 v[124:127], v[140:143], v[240:243], v[124:127]
  ds_read_b64_tr_b16 v[134:135], v245 offset:2048
  v_mfma_f32_16x16x32_bf16 v[112:115], v[144:147], v[40:43], v[112:115]
  ds_read_b64_tr_b16 v[136:137], v246 offset:0
  v_mfma_f32_16x16x32_bf16 v[116:119], v[144:147], v[44:47], v[116:119]
  ds_read_b64_tr_b16 v[138:139], v246 offset:2048
  v_mfma_f32_16x16x32_bf16 v[120:123], v[148:151], v[40:43], v[120:123]
  ds_read_b64_tr_b16 v[140:141], v247 offset:0
  v_mfma_f32_16x16x32_bf16 v[124:127], v[148:151], v[44:47], v[124:127]
  ds_read_b64_tr_b16 v[142:143], v247 offset:2048
  s_waitcnt lgkmcnt(6)
  v_mfma_f32_16x16x32_bf16 v[96:99], v[128:131], v[196:199], 0
  ds_read_b64_tr_b16 v[144:145], v244 offset:8192
  v_mfma_f32_16x16x32_bf16 v[100:103], v[128:131], v[200:203], 0
  ds_read_b64_tr_b16 v[146:147], v244 offset:10240
  s_waitcnt lgkmcnt(6)
  v_mfma_f32_16x16x32_bf16 v[104:107], v[132:135], v[196:199], 0
  ds_read_b64_tr_b16 v[148:149], v245 offset:8192
  v_mfma_f32_16x16x32_bf16 v[108:111], v[132:135], v[200:203], 0
  ds_read_b64_tr_b16 v[150:151], v245 offset:10240
  s_waitcnt lgkmcnt(6)
  v_mfma_f32_16x16x32_bf16 v[96:99], v[136:139], v[0:3], v[96:99]
  ds_read_b64_tr_b16 v[128:129], v246 offset:8192
  v_mfma_f32_16x16x32_bf16 v[100:103], v[136:139], v[4:7], v[100:103]
  ds_read_b64_tr_b16 v[130:131], v246 offset:10240
  s_waitcnt lgkmcnt(6)
  v_mfma_f32_16x16x32_bf16 v[104:107], v[140:143], v[0:3], v[104:107]
  ds_read_b64_tr_b16 v[132:133], v247 offset:8192
  v_mfma_f32_16x16x32_bf16 v[108:111], v[140:143], v[4:7], v[108:111]
  ds_read_b64_tr_b16 v[134:135], v247 offset:10240
  s_waitcnt lgkmcnt(6)
  v_mfma_f32_16x16x32_bf16 v[96:99], v[144:147], v[204:207], v[96:99]
  ds_read_b64_tr_b16 v[136:137], v244 offset:16384
  v_cvt_pk_bf16_f32 v168, v112, v113
  v_mfma_f32_16x16x32_bf16 v[100:103], v[144:147], v[208:211], v[100:103]
  ds_read_b64_tr_b16 v[138:139], v244 offset:18432
  v_cvt_pk_bf16_f32 v169, v114, v115
  s_waitcnt lgkmcnt(6)
  v_mfma_f32_16x16x32_bf16 v[104:107], v[148:151], v[204:207], v[104:107]
  ds_read_b64_tr_b16 v[140:141], v245 offset:16384
  v_cvt_pk_bf16_f32 v170, v120, v121
  v_mfma_f32_16x16x32_bf16 v[108:111], v[148:151], v[208:211], v[108:111]
  ds_read_b64_tr_b16 v[142:143], v245 offset:18432
  v_cvt_pk_bf16_f32 v171, v122, v123
  s_waitcnt lgkmcnt(6)
  v_mfma_f32_16x16x32_bf16 v[96:99], v[128:131], v[8:11], v[96:99]
  ds_read_b64_tr_b16 v[144:145], v246 offset:16384
  v_cvt_pk_bf16_f32 v172, v116, v117
  v_mfma_f32_16x16x32_bf16 v[100:103], v[128:131], v[12:15], v[100:103]
  ds_read_b64_tr_b16 v[146:147], v246 offset:18432
  v_cvt_pk_bf16_f32 v173, v118, v119
  s_waitcnt lgkmcnt(6)
  v_mfma_f32_16x16x32_bf16 v[104:107], v[132:135], v[8:11], v[104:107]
  ds_read_b64_tr_b16 v[148:149], v247 offset:16384
  v_cvt_pk_bf16_f32 v174, v124, v125
  v_mfma_f32_16x16x32_bf16 v[108:111], v[132:135], v[12:15], v[108:111]
  ds_read_b64_tr_b16 v[150:151], v247 offset:18432
  v_cvt_pk_bf16_f32 v175, v126, v127
  s_waitcnt lgkmcnt(6)
  v_mfma_f32_16x16x32_bf16 v[96:99], v[136:139], v[212:215], v[96:99]
  ds_read_b64_tr_b16 v[128:129], v244 offset:24576
  v_mfma_f32_16x16x32_bf16 v[100:103], v[136:139], v[216:219], v[100:103]
  ds_read_b64_tr_b16 v[130:131], v244 offset:26624
  s_waitcnt lgkmcnt(6)
  v_mfma_f32_16x16x32_bf16 v[104:107], v[140:143], v[212:215], v[104:107]
  ds_read_b64_tr_b16 v[132:133], v245 offset:24576
  v_mfma_f32_16x16x32_bf16 v[108:111], v[140:143], v[216:219], v[108:111]
  ds_read_b64_tr_b16 v[134:135], v245 offset:26624
  s_waitcnt lgkmcnt(6)
  v_mfma_f32_16x16x32_bf16 v[96:99], v[144:147], v[16:19], v[96:99]
  ds_read_b64_tr_b16 v[136:137], v246 offset:24576
  s_add_u32 s35, s39, 114688
  buffer_store_dwordx4 v[168:171], v254, s[20:23], s35 offen offset:0 sc1
  buffer_store_dwordx4 v[172:175], v254, s[20:23], s35 offen offset:1024 sc1
  v_mfma_f32_16x16x32_bf16 v[100:103], v[144:147], v[20:23], v[100:103]
  ds_read_b64_tr_b16 v[138:139], v246 offset:26624
  s_waitcnt lgkmcnt(6)
  v_mfma_f32_16x16x32_bf16 v[104:107], v[148:151], v[16:19], v[104:107]
  ds_read_b64_tr_b16 v[140:141], v247 offset:24576
  v_mfma_f32_16x16x32_bf16 v[108:111], v[148:151], v[20:23], v[108:111]
  ds_read_b64_tr_b16 v[142:143], v247 offset:26624
  s_waitcnt lgkmcnt(6)
  v_mfma_f32_16x16x32_bf16 v[96:99], v[128:131], v[220:223], v[96:99]
  ds_read_b64_tr_b16 v[144:145], v244 offset:32768
  v_mfma_f32_16x16x32_bf16 v[100:103], v[128:131], v[224:227], v[100:103]
  ds_read_b64_tr_b16 v[146:147], v244 offset:34816
  s_waitcnt lgkmcnt(6)
  v_mfma_f32_16x16x32_bf16 v[104:107], v[132:135], v[220:223], v[104:107]
  ds_read_b64_tr_b16 v[148:149], v245 offset:32768
  v_mfma_f32_16x16x32_bf16 v[108:111], v[132:135], v[224:227], v[108:111]
  ds_read_b64_tr_b16 v[150:151], v245 offset:34816
  s_waitcnt lgkmcnt(6)
  v_mfma_f32_16x16x32_bf16 v[96:99], v[136:139], v[24:27], v[96:99]
  ds_read_b64_tr_b16 v[128:129], v246 offset:32768
  v_mfma_f32_16x16x32_bf16 v[100:103], v[136:139], v[28:31], v[100:103]
  ds_read_b64_tr_b16 v[130:131], v246 offset:34816
  s_waitcnt lgkmcnt(6)
  v_mfma_f32_16x16x32_bf16 v[104:107], v[140:143], v[24:27], v[104:107]
  ds_read_b64_tr_b16 v[132:133], v247 offset:32768
  v_mfma_f32_16x16x32_bf16 v[108:111], v[140:143], v[28:31], v[108:111]
  ds_read_b64_tr_b16 v[134:135], v247 offset:34816
  s_waitcnt lgkmcnt(6)
  v_mfma_f32_16x16x32_bf16 v[96:99], v[144:147], v[228:231], v[96:99]
  ds_read_b64_tr_b16 v[136:137], v244 offset:40960
  v_mfma_f32_16x16x32_bf16 v[100:103], v[144:147], v[232:235], v[100:103]
  ds_read_b64_tr_b16 v[138:139], v244 offset:43008
  s_waitcnt lgkmcnt(6)
  v_mfma_f32_16x16x32_bf16 v[104:107], v[148:151], v[228:231], v[104:107]
  ds_read_b64_tr_b16 v[140:141], v245 offset:40960
  v_mfma_f32_16x16x32_bf16 v[108:111], v[148:151], v[232:235], v[108:111]
  ds_read_b64_tr_b16 v[142:143], v245 offset:43008
  s_waitcnt lgkmcnt(6)
  v_mfma_f32_16x16x32_bf16 v[96:99], v[128:131], v[32:35], v[96:99]
  ds_read_b64_tr_b16 v[144:145], v246 offset:40960
  v_mfma_f32_16x16x32_bf16 v[100:103], v[128:131], v[36:39], v[100:103]
  ds_read_b64_tr_b16 v[146:147], v246 offset:43008
  s_waitcnt lgkmcnt(6)
  v_mfma_f32_16x16x32_bf16 v[104:107], v[132:135], v[32:35], v[104:107]
  ds_read_b64_tr_b16 v[148:149], v247 offset:40960
  v_mfma_f32_16x16x32_bf16 v[108:111], v[132:135], v[36:39], v[108:111]
  ds_read_b64_tr_b16 v[150:151], v247 offset:43008
  s_waitcnt lgkmcnt(6)
  v_mfma_f32_16x16x32_bf16 v[96:99], v[136:139], v[236:239], v[96:99]
  v_mfma_f32_16x16x32_bf16 v[100:103], v[136:139], v[240:243], v[100:103]
  s_waitcnt lgkmcnt(4)
  v_mfma_f32_16x16x32_bf16 v[104:107], v[140:143], v[236:239], v[104:107]
  v_mfma_f32_16x16x32_bf16 v[108:111], v[140:143], v[240:243], v[108:111]
  s_waitcnt lgkmcnt(2)
  v_mfma_f32_16x16x32_bf16 v[96:99], v[144:147], v[40:43], v[96:99]
  v_mfma_f32_16x16x32_bf16 v[100:103], v[144:147], v[44:47], v[100:103]
  s_waitcnt lgkmcnt(0)
  v_mfma_f32_16x16x32_bf16 v[104:107], v[148:151], v[40:43], v[104:107]
  v_mfma_f32_16x16x32_bf16 v[108:111], v[148:151], v[44:47], v[108:111]
  s_nop 7
  v_cvt_pk_bf16_f32 v160, v96, v97
  v_cvt_pk_bf16_f32 v161, v98, v99
  v_cvt_pk_bf16_f32 v162, v104, v105
  v_cvt_pk_bf16_f32 v163, v106, v107
  v_cvt_pk_bf16_f32 v164, v100, v101
  v_cvt_pk_bf16_f32 v165, v102, v103
  v_cvt_pk_bf16_f32 v166, v108, v109
  v_cvt_pk_bf16_f32 v167, v110, v111
  s_add_u32 s35, s39, 131072
  buffer_store_dwordx4 v[160:163], v254, s[20:23], s35 offen offset:0 sc1
  buffer_store_dwordx4 v[164:167], v254, s[20:23], s35 offen offset:1024 sc1
  s_lshl_b32 s58, s29, 8
  s_add_u32 s58, s58, 37904384
  s_add_u32 s59, s58, 128
  s_mov_b32 s35, 0
  s_cmp_lg_u32 s28, 0
  s_cbranch_scc1 L_zq1
  v_mov_b32 v2, 0
  buffer_load_dword v2, v2, s[48:51], s35 offen sc1
L_zq1:
  s_waitcnt vmcnt(0)
  s_cmp_lg_u32 s28, 0
  s_cbranch_scc1 L_zq2
  s_mov_b32 s52, 0
L_pc3:
  v_readfirstlane_b32 s36, v2
  s_add_u32 s52, s52, 1
  s_nop 3
  s_cmp_ge_u32 s36, 16
  s_cbranch_scc1 L_pcd4
  s_cmp_ge_u32 s52, 0x40000
  s_cbranch_scc1 L_pcd4
  s_sleep 2
  v_mov_b32 v2, 0
  buffer_load_dword v2, v2, s[48:51], s35 offen sc1
  s_waitcnt vmcnt(0)
  s_branch L_pc3
L_pcd4:
L_zq2:
  s_barrier
  s_cmp_lg_u32 s28, 0
  s_cbranch_scc1 L_sig5
  v_mov_b32 v0, 1
  v_mov_b32 v1, 0
  s_mov_b64 exec, 1
  buffer_atomic_add v0, v1, s[20:23], s58 offen
  s_mov_b64 exec, -1
L_sig5:
  s_lshl_b32 s33, s30, 13
  s_lshl_b32 s34, s28, 10
  s_add_u32 s33, s33, s34
  v_lshlrev_b32 v2, 4, v255
  v_add_u32 v2, s33, v2
  s_lshl_b32 s33, s30, 12
  s_lshl_b32 s34, s28, 9
  s_add_u32 s33, s33, s34
  s_add_u32 s33, s33, 98304
  v_and_b32 v3, 31, v255
  v_lshlrev_b32 v3, 4, v3
  v_add_u32 v3, s33, v3
  v_mov_b32 v5, v2
  v_lshrrev_b32 v4, 5, v255
  s_mov_b32 s34, 2359296
  v_mul_lo_u32 v4, v4, s34
  v_add_u32 v6, v3, v4
  s_mul_i32 s40, s29, 147456
  v_lshrrev_b32 v12, 10, v2
  v_lshrrev_b32 v8, 4, v12
  v_lshlrev_b32 v8, 7, v8
  v_bfe_u32 v13, v12, 1, 1
  v_lshl_add_u32 v8, v13, 6, v8
  v_bfe_u32 v13, v2, 8, 2
  v_lshl_add_u32 v8, v13, 3, v8
  v_bfe_u32 v7, v12, 2, 2
  v_lshlrev_b32 v7, 5, v7
  v_and_b32 v13, 1, v12
  v_lshl_add_u32 v7, v13, 4, v7
  v_bfe_u32 v13, v2, 4, 4
  v_add_u32 v7, v7, v13
  s_lshl_b32 s33, s29, 7
  v_add_u32 v7, s33, v7
  s_movk_i32 s34, 1152
  v_mul_lo_u32 v9, v7, s34
  v_add_u32 v9, v9, v8
  v_lshrrev_b32 v12, 10, v3
  v_lshrrev_b32 v11, 4, v12
  v_lshlrev_b32 v11, 7, v11
  v_bfe_u32 v13, v12, 1, 1
  v_lshl_add_u32 v11, v13, 6, v11
  v_bfe_u32 v13, v3, 8, 2
  v_lshl_add_u32 v11, v13, 3, v11
  v_bfe_u32 v10, v12, 2, 2
  v_lshlrev_b32 v10, 5, v10
  v_and_b32 v13, 1, v12
  v_lshl_add_u32 v10, v13, 4, v10
  v_bfe_u32 v13, v3, 4, 4
  v_add_u32 v10, v10, v13
  s_lshl_b32 s33, s29, 7
  v_add_u32 v10, s33, v10
  s_movk_i32 s34, 1152
  v_mul_lo_u32 v14, v10, s34
  v_add_u32 v14, v14, v11
  v_lshlrev_b32 v7, 2, v7
  v_lshlrev_b32 v10, 2, v10
  s_mov_b32 s8, s88
  s_and_b32 s9, s89, 0xffff
  s_mov_b32 s10, 1152
  s_mov_b32 s11, 0x20000
  s_mov_b32 s12, s90
  s_and_b32 s13, s91, 0xffff
  s_mov_b32 s14, 2359296
  s_mov_b32 s15, 0x20000
  buffer_load_dwordx2 v[16:17], v8, s[8:11], 0 offen
  buffer_load_dwordx2 v[18:19], v8, s[8:11], 0 offen offset:32
  buffer_load_dwordx2 v[20:21], v11, s[8:11], 0 offen
  buffer_load_dwordx2 v[22:23], v11, s[8:11], 0 offen offset:32
  v_mov_b32 v160, 0
  v_mov_b32 v161, 0
  v_mov_b32 v162, 0
  v_mov_b32 v163, 0
  v_mov_b32 v164, 0
  v_mov_b32 v165, 0
  v_mov_b32 v166, 0
  v_mov_b32 v167, 0
  v_mov_b32 v168, 0
  v_mov_b32 v169, 0
  v_mov_b32 v170, 0
  v_mov_b32 v171, 0
  v_mov_b32 v172, 0
  v_mov_b32 v173, 0
  v_mov_b32 v174, 0
  v_mov_b32 v175, 0
  v_mov_b32 v176, 0
  v_mov_b32 v177, 0
  v_mov_b32 v178, 0
  v_mov_b32 v179, 0
  v_mov_b32 v180, 0
  v_mov_b32 v181, 0
  v_mov_b32 v182, 0
  v_mov_b32 v183, 0
  v_mov_b32 v184, 0
  v_mov_b32 v185, 0
  v_mov_b32 v186, 0
  v_mov_b32 v187, 0
  v_mov_b32 v188, 0
  v_mov_b32 v189, 0
  v_mov_b32 v190, 0
  v_mov_b32 v191, 0
  s_cmp_lg_u32 s28, 0
  s_cbranch_scc1 L_tw6
  s_mov_b32 s52, 0
L_pq7:
  v_mov_b32 v13, 0
  buffer_load_dword v13, v13, s[20:23], s58 offen sc1
  v_mov_b32 v15, 0
  buffer_load_dword v15, v15, s[20:23], s59 offen sc1
  s_waitcnt vmcnt(0)
  v_readfirstlane_b32 s36, v13
  s_add_u32 s52, s52, 1
  s_nop 3
  s_cmp_ge_u32 s36, 12
  s_cbranch_scc1 L_pq8
  s_cmp_ge_u32 s52, 0x40000
  s_cbranch_scc1 L_pq8
  s_sleep 2
  s_branch L_pq7
L_pq8:
  v_mov_b32 v13, 147456
  ds_write_b32 v13, v15
  s_waitcnt lgkmcnt(0)
L_tw6:
  s_barrier
  v_mov_b32 v13, 147456
  ds_read_b32 v15, v13
  s_waitcnt lgkmcnt(0)
  v_readfirstlane_b32 s36, v15
  s_nop 2
  s_cmp_ge_u32 s36, 4
  s_cselect_b32 s58, 1, 0
  s_mov_b32 s33, s58
  s_cmp_eq_u32 s33, 1
  s_cbranch_scc1 L_tc10
L_tc11:
  s_add_u32 s35, s40, 0
  buffer_load_dwordx4 v[48:51], v5, s[20:23], s35 offen sc1
  s_add_u32 s35, s40, 2359296
  buffer_load_dwordx4 v[52:55], v5, s[20:23], s35 offen sc1
  s_add_u32 s35, s40, 4718592
  buffer_load_dwordx4 v[56:59], v5, s[20:23], s35 offen sc1
  s_add_u32 s35, s40, 7077888
  buffer_load_dwordx4 v[60:63], v5, s[20:23], s35 offen sc1
  s_add_u32 s35, s40, 9437184
  buffer_load_dwordx4 v[64:67], v5, s[20:23], s35 offen sc1
  s_add_u32 s35, s40, 11796480
  buffer_load_dwordx4 v[68:71], v5, s[20:23], s35 offen sc1
  s_add_u32 s35, s40, 14155776
  buffer_load_dwordx4 v[72:75], v5, s[20:23], s35 offen sc1
  s_add_u32 s35, s40, 16515072
  buffer_load_dwordx4 v[76:79], v5, s[20:23], s35 offen sc1
  s_add_u32 s35, s40, 18874368
  buffer_load_dwordx4 v[80:83], v5, s[20:23], s35 offen sc1
  s_add_u32 s35, s40, 21233664
  buffer_load_dwordx4 v[84:87], v5, s[20:23], s35 offen sc1
  s_add_u32 s35, s40, 23592960
  buffer_load_dwordx4 v[88:91], v5, s[20:23], s35 offen sc1
  s_add_u32 s35, s40, 25952256
  buffer_load_dwordx4 v[92:95], v5, s[20:23], s35 offen sc1
  s_add_u32 s35, s40, 0
  buffer_load_dwordx4 v[96:99], v6, s[20:23], s35 offen sc1
  s_add_u32 s35, s40, 4718592
  buffer_load_dwordx4 v[100:103], v6, s[20:23], s35 offen sc1
  s_add_u32 s35, s40, 9437184
  buffer_load_dwordx4 v[104:107], v6, s[20:23], s35 offen sc1
  s_add_u32 s35, s40, 14155776
  buffer_load_dwordx4 v[108:111], v6, s[20:23], s35 offen sc1
  s_add_u32 s35, s40, 18874368
  buffer_load_dwordx4 v[112:115], v6, s[20:23], s35 offen sc1
  s_add_u32 s35, s40, 23592960
  buffer_load_dwordx4 v[116:119], v6, s[20:23], s35 offen sc1
  s_cmp_lg_u32 s28, 0
  s_cbranch_scc1 L_pw12
  v_mov_b32 v13, 0
  buffer_load_dword v13, v13, s[20:23], s59 offen sc1
  L_pw12:
  s_waitcnt vmcnt(17)
  v_lshlrev_b32 v144, 16, v48
  v_and_b32 v145, 0xffff0000, v48
  v_lshlrev_b32 v146, 16, v49
  v_and_b32 v147, 0xffff0000, v49
  v_lshlrev_b32 v148, 16, v50
  v_and_b32 v149, 0xffff0000, v50
  v_lshlrev_b32 v150, 16, v51
  v_and_b32 v151, 0xffff0000, v51
  v_pk_add_f32 v[160:161], v[160:161], v[144:145]
  v_pk_add_f32 v[162:163], v[162:163], v[146:147]
  v_pk_add_f32 v[164:165], v[164:165], v[148:149]
  v_pk_add_f32 v[166:167], v[166:167], v[150:151]
  s_waitcnt vmcnt(16)
  v_lshlrev_b32 v144, 16, v52
  v_and_b32 v145, 0xffff0000, v52
  v_lshlrev_b32 v146, 16, v53
  v_and_b32 v147, 0xffff0000, v53
  v_lshlrev_b32 v148, 16, v54
  v_and_b32 v149, 0xffff0000, v54
  v_lshlrev_b32 v150, 16, v55
  v_and_b32 v151, 0xffff0000, v55
  v_pk_add_f32 v[160:161], v[160:161], v[144:145]
  v_pk_add_f32 v[162:163], v[162:163], v[146:147]
  v_pk_add_f32 v[164:165], v[164:165], v[148:149]
  v_pk_add_f32 v[166:167], v[166:167], v[150:151]
  s_waitcnt vmcnt(15)
  v_lshlrev_b32 v144, 16, v56
  v_and_b32 v145, 0xffff0000, v56
  v_lshlrev_b32 v146, 16, v57
  v_and_b32 v147, 0xffff0000, v57
  v_lshlrev_b32 v148, 16, v58
  v_and_b32 v149, 0xffff0000, v58
  v_lshlrev_b32 v150, 16, v59
  v_and_b32 v151, 0xffff0000, v59
  v_pk_add_f32 v[160:161], v[160:161], v[144:145]
  v_pk_add_f32 v[162:163], v[162:163], v[146:147]
  v_pk_add_f32 v[164:165], v[164:165], v[148:149]
  v_pk_add_f32 v[166:167], v[166:167], v[150:151]
  s_waitcnt vmcnt(14)
  v_lshlrev_b32 v144, 16, v60
  v_and_b32 v145, 0xffff0000, v60
  v_lshlrev_b32 v146, 16, v61
  v_and_b32 v147, 0xffff0000, v61
  v_lshlrev_b32 v148, 16, v62
  v_and_b32 v149, 0xffff0000, v62
  v_lshlrev_b32 v150, 16, v63
  v_and_b32 v151, 0xffff0000, v63
  v_pk_add_f32 v[160:161], v[160:161], v[144:145]
  v_pk_add_f32 v[162:163], v[162:163], v[146:147]
  v_pk_add_f32 v[164:165], v[164:165], v[148:149]
  v_pk_add_f32 v[166:167], v[166:167], v[150:151]
  s_waitcnt vmcnt(13)
  v_lshlrev_b32 v144, 16, v64
  v_and_b32 v145, 0xffff0000, v64
  v_lshlrev_b32 v146, 16, v65
  v_and_b32 v147, 0xffff0000, v65
  v_lshlrev_b32 v148, 16, v66
  v_and_b32 v149, 0xffff0000, v66
  v_lshlrev_b32 v150, 16, v67
  v_and_b32 v151, 0xffff0000, v67
  v_pk_add_f32 v[160:161], v[160:161], v[144:145]
  v_pk_add_f32 v[162:163], v[162:163], v[146:147]
  v_pk_add_f32 v[164:165], v[164:165], v[148:149]
  v_pk_add_f32 v[166:167], v[166:167], v[150:151]
  s_waitcnt vmcnt(12)
  v_lshlrev_b32 v144, 16, v68
  v_and_b32 v145, 0xffff0000, v68
  v_lshlrev_b32 v146, 16, v69
  v_and_b32 v147, 0xffff0000, v69
  v_lshlrev_b32 v148, 16, v70
  v_and_b32 v149, 0xffff0000, v70
  v_lshlrev_b32 v150, 16, v71
  v_and_b32 v151, 0xffff0000, v71
  v_pk_add_f32 v[160:161], v[160:161], v[144:145]
  v_pk_add_f32 v[162:163], v[162:163], v[146:147]
  v_pk_add_f32 v[164:165], v[164:165], v[148:149]
  v_pk_add_f32 v[166:167], v[166:167], v[150:151]
  s_waitcnt vmcnt(11)
  v_lshlrev_b32 v144, 16, v72
  v_and_b32 v145, 0xffff0000, v72
  v_lshlrev_b32 v146, 16, v73
  v_and_b32 v147, 0xffff0000, v73
  v_lshlrev_b32 v148, 16, v74
  v_and_b32 v149, 0xffff0000, v74
  v_lshlrev_b32 v150, 16, v75
  v_and_b32 v151, 0xffff0000, v75
  v_pk_add_f32 v[160:161], v[160:161], v[144:145]
  v_pk_add_f32 v[162:163], v[162:163], v[146:147]
  v_pk_add_f32 v[164:165], v[164:165], v[148:149]
  v_pk_add_f32 v[166:167], v[166:167], v[150:151]
  s_waitcnt vmcnt(10)
  v_lshlrev_b32 v144, 16, v76
  v_and_b32 v145, 0xffff0000, v76
  v_lshlrev_b32 v146, 16, v77
  v_and_b32 v147, 0xffff0000, v77
  v_lshlrev_b32 v148, 16, v78
  v_and_b32 v149, 0xffff0000, v78
  v_lshlrev_b32 v150, 16, v79
  v_and_b32 v151, 0xffff0000, v79
  v_pk_add_f32 v[160:161], v[160:161], v[144:145]
  v_pk_add_f32 v[162:163], v[162:163], v[146:147]
  v_pk_add_f32 v[164:165], v[164:165], v[148:149]
  v_pk_add_f32 v[166:167], v[166:167], v[150:151]
  s_waitcnt vmcnt(9)
  v_lshlrev_b32 v144, 16, v80
  v_and_b32 v145, 0xffff0000, v80
  v_lshlrev_b32 v146, 16, v81
  v_and_b32 v147, 0xffff0000, v81
  v_lshlrev_b32 v148, 16, v82
  v_and_b32 v149, 0xffff0000, v82
  v_lshlrev_b32 v150, 16, v83
  v_and_b32 v151, 0xffff0000, v83
  v_pk_add_f32 v[160:161], v[160:161], v[144:145]
  v_pk_add_f32 v[162:163], v[162:163], v[146:147]
  v_pk_add_f32 v[164:165], v[164:165], v[148:149]
  v_pk_add_f32 v[166:167], v[166:167], v[150:151]
  s_waitcnt vmcnt(8)
  v_lshlrev_b32 v144, 16, v84
  v_and_b32 v145, 0xffff0000, v84
  v_lshlrev_b32 v146, 16, v85
  v_and_b32 v147, 0xffff0000, v85
  v_lshlrev_b32 v148, 16, v86
  v_and_b32 v149, 0xffff0000, v86
  v_lshlrev_b32 v150, 16, v87
  v_and_b32 v151, 0xffff0000, v87
  v_pk_add_f32 v[160:161], v[160:161], v[144:145]
  v_pk_add_f32 v[162:163], v[162:163], v[146:147]
  v_pk_add_f32 v[164:165], v[164:165], v[148:149]
  v_pk_add_f32 v[166:167], v[166:167], v[150:151]
  s_waitcnt vmcnt(7)
  v_lshlrev_b32 v144, 16, v88
  v_and_b32 v145, 0xffff0000, v88
  v_lshlrev_b32 v146, 16, v89
  v_and_b32 v147, 0xffff0000, v89
  v_lshlrev_b32 v148, 16, v90
  v_and_b32 v149, 0xffff0000, v90
  v_lshlrev_b32 v150, 16, v91
  v_and_b32 v151, 0xffff0000, v91
  v_pk_add_f32 v[160:161], v[160:161], v[144:145]
  v_pk_add_f32 v[162:163], v[162:163], v[146:147]
  v_pk_add_f32 v[164:165], v[164:165], v[148:149]
  v_pk_add_f32 v[166:167], v[166:167], v[150:151]
  s_waitcnt vmcnt(6)
  v_lshlrev_b32 v144, 16, v92
  v_and_b32 v145, 0xffff0000, v92
  v_lshlrev_b32 v146, 16, v93
  v_and_b32 v147, 0xffff0000, v93
  v_lshlrev_b32 v148, 16, v94
  v_and_b32 v149, 0xffff0000, v94
  v_lshlrev_b32 v150, 16, v95
  v_and_b32 v151, 0xffff0000, v95
  v_pk_add_f32 v[160:161], v[160:161], v[144:145]
  v_pk_add_f32 v[162:163], v[162:163], v[146:147]
  v_pk_add_f32 v[164:165], v[164:165], v[148:149]
  v_pk_add_f32 v[166:167], v[166:167], v[150:151]
  s_waitcnt vmcnt(5)
  v_lshlrev_b32 v144, 16, v96
  v_and_b32 v145, 0xffff0000, v96
  v_lshlrev_b32 v146, 16, v97
  v_and_b32 v147, 0xffff0000, v97
  v_lshlrev_b32 v148, 16, v98
  v_and_b32 v149, 0xffff0000, v98
  v_lshlrev_b32 v150, 16, v99
  v_and_b32 v151, 0xffff0000, v99
  v_pk_add_f32 v[168:169], v[168:169], v[144:145]
  v_pk_add_f32 v[170:171], v[170:171], v[146:147]
  v_pk_add_f32 v[172:173], v[172:173], v[148:149]
  v_pk_add_f32 v[174:175], v[174:175], v[150:151]
  s_waitcnt vmcnt(4)
  v_lshlrev_b32 v144, 16, v100
  v_and_b32 v145, 0xffff0000, v100
  v_lshlrev_b32 v146, 16, v101
  v_and_b32 v147, 0xffff0000, v101
  v_lshlrev_b32 v148, 16, v102
  v_and_b32 v149, 0xffff0000, v102
  v_lshlrev_b32 v150, 16, v103
  v_and_b32 v151, 0xffff0000, v103
  v_pk_add_f32 v[168:169], v[168:169], v[144:145]
  v_pk_add_f32 v[170:171], v[170:171], v[146:147]
  v_pk_add_f32 v[172:173], v[172:173], v[148:149]
  v_pk_add_f32 v[174:175], v[174:175], v[150:151]
  s_waitcnt vmcnt(3)
  v_lshlrev_b32 v144, 16, v104
  v_and_b32 v145, 0xffff0000, v104
  v_lshlrev_b32 v146, 16, v105
  v_and_b32 v147, 0xffff0000, v105
  v_lshlrev_b32 v148, 16, v106
  v_and_b32 v149, 0xffff0000, v106
  v_lshlrev_b32 v150, 16, v107
  v_and_b32 v151, 0xffff0000, v107
  v_pk_add_f32 v[168:169], v[168:169], v[144:145]
  v_pk_add_f32 v[170:171], v[170:171], v[146:147]
  v_pk_add_f32 v[172:173], v[172:173], v[148:149]
  v_pk_add_f32 v[174:175], v[174:175], v[150:151]
  s_waitcnt vmcnt(2)
  v_lshlrev_b32 v144, 16, v108
  v_and_b32 v145, 0xffff0000, v108
  v_lshlrev_b32 v146, 16, v109
  v_and_b32 v147, 0xffff0000, v109
  v_lshlrev_b32 v148, 16, v110
  v_and_b32 v149, 0xffff0000, v110
  v_lshlrev_b32 v150, 16, v111
  v_and_b32 v151, 0xffff0000, v111
  v_pk_add_f32 v[168:169], v[168:169], v[144:145]
  v_pk_add_f32 v[170:171], v[170:171], v[146:147]
  v_pk_add_f32 v[172:173], v[172:173], v[148:149]
  v_pk_add_f32 v[174:175], v[174:175], v[150:151]
  s_waitcnt vmcnt(1)
  v_lshlrev_b32 v144, 16, v112
  v_and_b32 v145, 0xffff0000, v112
  v_lshlrev_b32 v146, 16, v113
  v_and_b32 v147, 0xffff0000, v113
  v_lshlrev_b32 v148, 16, v114
  v_and_b32 v149, 0xffff0000, v114
  v_lshlrev_b32 v150, 16, v115
  v_and_b32 v151, 0xffff0000, v115
  v_pk_add_f32 v[168:169], v[168:169], v[144:145]
  v_pk_add_f32 v[170:171], v[170:171], v[146:147]
  v_pk_add_f32 v[172:173], v[172:173], v[148:149]
  v_pk_add_f32 v[174:175], v[174:175], v[150:151]
  s_waitcnt vmcnt(0)
  v_lshlrev_b32 v144, 16, v116
  v_and_b32 v145, 0xffff0000, v116
  v_lshlrev_b32 v146, 16, v117
  v_and_b32 v147, 0xffff0000, v117
  v_lshlrev_b32 v148, 16, v118
  v_and_b32 v149, 0xffff0000, v118
  v_lshlrev_b32 v150, 16, v119
  v_and_b32 v151, 0xffff0000, v119
  v_pk_add_f32 v[168:169], v[168:169], v[144:145]
  v_pk_add_f32 v[170:171], v[170:171], v[146:147]
  v_pk_add_f32 v[172:173], v[172:173], v[148:149]
  v_pk_add_f32 v[174:175], v[174:175], v[150:151]
  s_cmp_lg_u32 s28, 0
  s_cbranch_scc1 L_aw13
  s_waitcnt vmcnt(0)
  s_mov_b32 s52, 0
L_pc14:
  v_readfirstlane_b32 s36, v13
  s_add_u32 s52, s52, 1
  s_nop 3
  s_cmp_ge_u32 s36, 4
  s_cbranch_scc1 L_pcd15
  s_cmp_ge_u32 s52, 0x40000
  s_cbranch_scc1 L_pcd15
  s_sleep 2
  v_mov_b32 v13, 0
  buffer_load_dword v13, v13, s[20:23], s59 offen sc1
  s_waitcnt vmcnt(0)
  s_branch L_pc14
L_pcd15:
L_aw13:
  s_barrier
  s_mov_b32 s35, 37748736
  buffer_load_dword v24, v7, s[20:23], s35 offen sc1
  buffer_load_dword v26, v10, s[20:23], s35 offen sc1
  s_add_u32 s35, s40, 28311552
  buffer_load_dwordx4 v[128:131], v5, s[20:23], s35 offen sc1
  s_add_u32 s35, s40, 30670848
  buffer_load_dwordx4 v[132:135], v5, s[20:23], s35 offen sc1
  s_add_u32 s35, s40, 33030144
  buffer_load_dwordx4 v[136:139], v5, s[20:23], s35 offen sc1
  s_add_u32 s35, s40, 35389440
  buffer_load_dwordx4 v[140:143], v5, s[20:23], s35 offen sc1
  s_add_u32 s35, s40, 28311552
  buffer_load_dwordx4 v[120:123], v6, s[20:23], s35 offen sc1
  s_add_u32 s35, s40, 33030144
  buffer_load_dwordx4 v[124:127], v6, s[20:23], s35 offen sc1
  s_waitcnt vmcnt(5)
  v_lshlrev_b32 v144, 16, v128
  v_and_b32 v145, 0xffff0000, v128
  v_lshlrev_b32 v146, 16, v129
  v_and_b32 v147, 0xffff0000, v129
  v_lshlrev_b32 v148, 16, v130
  v_and_b32 v149, 0xffff0000, v130
  v_lshlrev_b32 v150, 16, v131
  v_and_b32 v151, 0xffff0000, v131
  v_pk_add_f32 v[176:177], v[176:177], v[144:145]
  v_pk_add_f32 v[178:179], v[178:179], v[146:147]
  v_pk_add_f32 v[180:181], v[180:181], v[148:149]
  v_pk_add_f32 v[182:183], v[182:183], v[150:151]
  s_waitcnt vmcnt(4)
  v_lshlrev_b32 v144, 16, v132
  v_and_b32 v145, 0xffff0000, v132
  v_lshlrev_b32 v146, 16, v133
  v_and_b32 v147, 0xffff0000, v133
  v_lshlrev_b32 v148, 16, v134
  v_and_b32 v149, 0xffff0000, v134
  v_lshlrev_b32 v150, 16, v135
  v_and_b32 v151, 0xffff0000, v135
  v_pk_add_f32 v[176:177], v[176:177], v[144:145]
  v_pk_add_f32 v[178:179], v[178:179], v[146:147]
  v_pk_add_f32 v[180:181], v[180:181], v[148:149]
  v_pk_add_f32 v[182:183], v[182:183], v[150:151]
  s_waitcnt vmcnt(3)
  v_lshlrev_b32 v144, 16, v136
  v_and_b32 v145, 0xffff0000, v136
  v_lshlrev_b32 v146, 16, v137
  v_and_b32 v147, 0xffff0000, v137
  v_lshlrev_b32 v148, 16, v138
  v_and_b32 v149, 0xffff0000, v138
  v_lshlrev_b32 v150, 16, v139
  v_and_b32 v151, 0xffff0000, v139
  v_pk_add_f32 v[176:177], v[176:177], v[144:145]
  v_pk_add_f32 v[178:179], v[178:179], v[146:147]
  v_pk_add_f32 v[180:181], v[180:181], v[148:149]
  v_pk_add_f32 v[182:183], v[182:183], v[150:151]
  s_waitcnt vmcnt(2)
  v_lshlrev_b32 v144, 16, v140
  v_and_b32 v145, 0xffff0000, v140
  v_lshlrev_b32 v146, 16, v141
  v_and_b32 v147, 0xffff0000, v141
  v_lshlrev_b32 v148, 16, v142
  v_and_b32 v149, 0xffff0000, v142
  v_lshlrev_b32 v150, 16, v143
  v_and_b32 v151, 0xffff0000, v143
  v_pk_add_f32 v[176:177], v[176:177], v[144:145]
  v_pk_add_f32 v[178:179], v[178:179], v[146:147]
  v_pk_add_f32 v[180:181], v[180:181], v[148:149]
  v_pk_add_f32 v[182:183], v[182:183], v[150:151]
  s_waitcnt vmcnt(1)
  v_lshlrev_b32 v144, 16, v120
  v_and_b32 v145, 0xffff0000, v120
  v_lshlrev_b32 v146, 16, v121
  v_and_b32 v147, 0xffff0000, v121
  v_lshlrev_b32 v148, 16, v122
  v_and_b32 v149, 0xffff0000, v122
  v_lshlrev_b32 v150, 16, v123
  v_and_b32 v151, 0xffff0000, v123
  v_pk_add_f32 v[184:185], v[184:185], v[144:145]
  v_pk_add_f32 v[186:187], v[186:187], v[146:147]
  v_pk_add_f32 v[188:189], v[188:189], v[148:149]
  v_pk_add_f32 v[190:191], v[190:191], v[150:151]
  s_waitcnt vmcnt(0)
  v_lshlrev_b32 v144, 16, v124
  v_and_b32 v145, 0xffff0000, v124
  v_lshlrev_b32 v146, 16, v125
  v_and_b32 v147, 0xffff0000, v125
  v_lshlrev_b32 v148, 16, v126
  v_and_b32 v149, 0xffff0000, v126
  v_lshlrev_b32 v150, 16, v127
  v_and_b32 v151, 0xffff0000, v127
  v_pk_add_f32 v[184:185], v[184:185], v[144:145]
  v_pk_add_f32 v[186:187], v[186:187], v[146:147]
  v_pk_add_f32 v[188:189], v[188:189], v[148:149]
  v_pk_add_f32 v[190:191], v[190:191], v[150:151]
  s_branch L_join9
L_tc10:
  s_mov_b32 s35, 37748736
  buffer_load_dword v24, v7, s[20:23], s35 offen sc1
  buffer_load_dword v26, v10, s[20:23], s35 offen sc1
  s_add_u32 s35, s40, 0
  buffer_load_dwordx4 v[48:51], v5, s[20:23], s35 offen sc1
  s_add_u32 s35, s40, 2359296
  buffer_load_dwordx4 v[52:55], v5, s[20:23], s35 offen sc1
  s_add_u32 s35, s40, 4718592
  buffer_load_dwordx4 v[56:59], v5, s[20:23], s35 offen sc1
  s_add_u32 s35, s40, 7077888
  buffer_load_dwordx4 v[60:63], v5, s[20:23], s35 offen sc1
  s_add_u32 s35, s40, 9437184
  buffer_load_dwordx4 v[64:67], v5, s[20:23], s35 offen sc1
  s_add_u32 s35, s40, 11796480
  buffer_load_dwordx4 v[68:71], v5, s[20:23], s35 offen sc1
  s_add_u32 s35, s40, 14155776
  buffer_load_dwordx4 v[72:75], v5, s[20:23], s35 offen sc1
  s_add_u32 s35, s40, 16515072
  buffer_load_dwordx4 v[76:79], v5, s[20:23], s35 offen sc1
  s_add_u32 s35, s40, 18874368
  buffer_load_dwordx4 v[80:83], v5, s[20:23], s35 offen sc1
  s_add_u32 s35, s40, 21233664
  buffer_load_dwordx4 v[84:87], v5, s[20:23], s35 offen sc1
  s_add_u32 s35, s40, 23592960
  buffer_load_dwordx4 v[88:91], v5, s[20:23], s35 offen sc1
  s_add_u32 s35, s40, 25952256
  buffer_load_dwordx4 v[92:95], v5, s[20:23], s35 offen sc1
  s_add_u32 s35, s40, 0
  buffer_load_dwordx4 v[96:99], v6, s[20:23], s35 offen sc1
  s_add_u32 s35, s40, 4718592
  buffer_load_dwordx4 v[100:103], v6, s[20:23], s35 offen sc1
  s_add_u32 s35, s40, 9437184
  buffer_load_dwordx4 v[104:107], v6, s[20:23], s35 offen sc1
  s_add_u32 s35, s40, 14155776
  buffer_load_dwordx4 v[108:111], v6, s[20:23], s35 offen sc1
  s_add_u32 s35, s40, 18874368
  buffer_load_dwordx4 v[112:115], v6, s[20:23], s35 offen sc1
  s_add_u32 s35, s40, 23592960
  buffer_load_dwordx4 v[116:119], v6, s[20:23], s35 offen sc1
  s_add_u32 s35, s40, 28311552
  buffer_load_dwordx4 v[128:131], v5, s[20:23], s35 offen sc1
  s_add_u32 s35, s40, 30670848
  buffer_load_dwordx4 v[132:135], v5, s[20:23], s35 offen sc1
  s_add_u32 s35, s40, 33030144
  buffer_load_dwordx4 v[136:139], v5, s[20:23], s35 offen sc1
  s_add_u32 s35, s40, 35389440
  buffer_load_dwordx4 v[140:143], v5, s[20:23], s35 offen sc1
  s_add_u32 s35, s40, 28311552
  buffer_load_dwordx4 v[120:123], v6, s[20:23], s35 offen sc1
  s_add_u32 s35, s40, 33030144
  buffer_load_dwordx4 v[124:127], v6, s[20:23], s35 offen sc1
  s_waitcnt vmcnt(23)
  v_lshlrev_b32 v144, 16, v48
  v_and_b32 v145, 0xffff0000, v48
  v_lshlrev_b32 v146, 16, v49
  v_and_b32 v147, 0xffff0000, v49
  v_lshlrev_b32 v148, 16, v50
  v_and_b32 v149, 0xffff0000, v50
  v_lshlrev_b32 v150, 16, v51
  v_and_b32 v151, 0xffff0000, v51
  v_pk_add_f32 v[160:161], v[160:161], v[144:145]
  v_pk_add_f32 v[162:163], v[162:163], v[146:147]
  v_pk_add_f32 v[164:165], v[164:165], v[148:149]
  v_pk_add_f32 v[166:167], v[166:167], v[150:151]
  s_waitcnt vmcnt(22)
  v_lshlrev_b32 v144, 16, v52
  v_and_b32 v145, 0xffff0000, v52
  v_lshlrev_b32 v146, 16, v53
  v_and_b32 v147, 0xffff0000, v53
  v_lshlrev_b32 v148, 16, v54
  v_and_b32 v149, 0xffff0000, v54
  v_lshlrev_b32 v150, 16, v55
  v_and_b32 v151, 0xffff0000, v55
  v_pk_add_f32 v[160:161], v[160:161], v[144:145]
  v_pk_add_f32 v[162:163], v[162:163], v[146:147]
  v_pk_add_f32 v[164:165], v[164:165], v[148:149]
  v_pk_add_f32 v[166:167], v[166:167], v[150:151]
  s_waitcnt vmcnt(21)
  v_lshlrev_b32 v144, 16, v56
  v_and_b32 v145, 0xffff0000, v56
  v_lshlrev_b32 v146, 16, v57
  v_and_b32 v147, 0xffff0000, v57
  v_lshlrev_b32 v148, 16, v58
  v_and_b32 v149, 0xffff0000, v58
  v_lshlrev_b32 v150, 16, v59
  v_and_b32 v151, 0xffff0000, v59
  v_pk_add_f32 v[160:161], v[160:161], v[144:145]
  v_pk_add_f32 v[162:163], v[162:163], v[146:147]
  v_pk_add_f32 v[164:165], v[164:165], v[148:149]
  v_pk_add_f32 v[166:167], v[166:167], v[150:151]
  s_waitcnt vmcnt(20)
  v_lshlrev_b32 v144, 16, v60
  v_and_b32 v145, 0xffff0000, v60
  v_lshlrev_b32 v146, 16, v61
  v_and_b32 v147, 0xffff0000, v61
  v_lshlrev_b32 v148, 16, v62
  v_and_b32 v149, 0xffff0000, v62
  v_lshlrev_b32 v150, 16, v63
  v_and_b32 v151, 0xffff0000, v63
  v_pk_add_f32 v[160:161], v[160:161], v[144:145]
  v_pk_add_f32 v[162:163], v[162:163], v[146:147]
  v_pk_add_f32 v[164:165], v[164:165], v[148:149]
  v_pk_add_f32 v[166:167], v[166:167], v[150:151]
  s_waitcnt vmcnt(19)
  v_lshlrev_b32 v144, 16, v64
  v_and_b32 v145, 0xffff0000, v64
  v_lshlrev_b32 v146, 16, v65
  v_and_b32 v147, 0xffff0000, v65
  v_lshlrev_b32 v148, 16, v66
  v_and_b32 v149, 0xffff0000, v66
  v_lshlrev_b32 v150, 16, v67
  v_and_b32 v151, 0xffff0000, v67
  v_pk_add_f32 v[160:161], v[160:161], v[144:145]
  v_pk_add_f32 v[162:163], v[162:163], v[146:147]
  v_pk_add_f32 v[164:165], v[164:165], v[148:149]
  v_pk_add_f32 v[166:167], v[166:167], v[150:151]
  s_waitcnt vmcnt(18)
  v_lshlrev_b32 v144, 16, v68
  v_and_b32 v145, 0xffff0000, v68
  v_lshlrev_b32 v146, 16, v69
  v_and_b32 v147, 0xffff0000, v69
  v_lshlrev_b32 v148, 16, v70
  v_and_b32 v149, 0xffff0000, v70
  v_lshlrev_b32 v150, 16, v71
  v_and_b32 v151, 0xffff0000, v71
  v_pk_add_f32 v[160:161], v[160:161], v[144:145]
  v_pk_add_f32 v[162:163], v[162:163], v[146:147]
  v_pk_add_f32 v[164:165], v[164:165], v[148:149]
  v_pk_add_f32 v[166:167], v[166:167], v[150:151]
  s_waitcnt vmcnt(17)
  v_lshlrev_b32 v144, 16, v72
  v_and_b32 v145, 0xffff0000, v72
  v_lshlrev_b32 v146, 16, v73
  v_and_b32 v147, 0xffff0000, v73
  v_lshlrev_b32 v148, 16, v74
  v_and_b32 v149, 0xffff0000, v74
  v_lshlrev_b32 v150, 16, v75
  v_and_b32 v151, 0xffff0000, v75
  v_pk_add_f32 v[160:161], v[160:161], v[144:145]
  v_pk_add_f32 v[162:163], v[162:163], v[146:147]
  v_pk_add_f32 v[164:165], v[164:165], v[148:149]
  v_pk_add_f32 v[166:167], v[166:167], v[150:151]
  s_waitcnt vmcnt(16)
  v_lshlrev_b32 v144, 16, v76
  v_and_b32 v145, 0xffff0000, v76
  v_lshlrev_b32 v146, 16, v77
  v_and_b32 v147, 0xffff0000, v77
  v_lshlrev_b32 v148, 16, v78
  v_and_b32 v149, 0xffff0000, v78
  v_lshlrev_b32 v150, 16, v79
  v_and_b32 v151, 0xffff0000, v79
  v_pk_add_f32 v[160:161], v[160:161], v[144:145]
  v_pk_add_f32 v[162:163], v[162:163], v[146:147]
  v_pk_add_f32 v[164:165], v[164:165], v[148:149]
  v_pk_add_f32 v[166:167], v[166:167], v[150:151]
  s_waitcnt vmcnt(15)
  v_lshlrev_b32 v144, 16, v80
  v_and_b32 v145, 0xffff0000, v80
  v_lshlrev_b32 v146, 16, v81
  v_and_b32 v147, 0xffff0000, v81
  v_lshlrev_b32 v148, 16, v82
  v_and_b32 v149, 0xffff0000, v82
  v_lshlrev_b32 v150, 16, v83
  v_and_b32 v151, 0xffff0000, v83
  v_pk_add_f32 v[160:161], v[160:161], v[144:145]
  v_pk_add_f32 v[162:163], v[162:163], v[146:147]
  v_pk_add_f32 v[164:165], v[164:165], v[148:149]
  v_pk_add_f32 v[166:167], v[166:167], v[150:151]
  s_waitcnt vmcnt(14)
  v_lshlrev_b32 v144, 16, v84
  v_and_b32 v145, 0xffff0000, v84
  v_lshlrev_b32 v146, 16, v85
  v_and_b32 v147, 0xffff0000, v85
  v_lshlrev_b32 v148, 16, v86
  v_and_b32 v149, 0xffff0000, v86
  v_lshlrev_b32 v150, 16, v87
  v_and_b32 v151, 0xffff0000, v87
  v_pk_add_f32 v[160:161], v[160:161], v[144:145]
  v_pk_add_f32 v[162:163], v[162:163], v[146:147]
  v_pk_add_f32 v[164:165], v[164:165], v[148:149]
  v_pk_add_f32 v[166:167], v[166:167], v[150:151]
  s_waitcnt vmcnt(13)
  v_lshlrev_b32 v144, 16, v88
  v_and_b32 v145, 0xffff0000, v88
  v_lshlrev_b32 v146, 16, v89
  v_and_b32 v147, 0xffff0000, v89
  v_lshlrev_b32 v148, 16, v90
  v_and_b32 v149, 0xffff0000, v90
  v_lshlrev_b32 v150, 16, v91
  v_and_b32 v151, 0xffff0000, v91
  v_pk_add_f32 v[160:161], v[160:161], v[144:145]
  v_pk_add_f32 v[162:163], v[162:163], v[146:147]
  v_pk_add_f32 v[164:165], v[164:165], v[148:149]
  v_pk_add_f32 v[166:167], v[166:167], v[150:151]
  s_waitcnt vmcnt(12)
  v_lshlrev_b32 v144, 16, v92
  v_and_b32 v145, 0xffff0000, v92
  v_lshlrev_b32 v146, 16, v93
  v_and_b32 v147, 0xffff0000, v93
  v_lshlrev_b32 v148, 16, v94
  v_and_b32 v149, 0xffff0000, v94
  v_lshlrev_b32 v150, 16, v95
  v_and_b32 v151, 0xffff0000, v95
  v_pk_add_f32 v[160:161], v[160:161], v[144:145]
  v_pk_add_f32 v[162:163], v[162:163], v[146:147]
  v_pk_add_f32 v[164:165], v[164:165], v[148:149]
  v_pk_add_f32 v[166:167], v[166:167], v[150:151]
  s_waitcnt vmcnt(11)
  v_lshlrev_b32 v144, 16, v96
  v_and_b32 v145, 0xffff0000, v96
  v_lshlrev_b32 v146, 16, v97
  v_and_b32 v147, 0xffff0000, v97
  v_lshlrev_b32 v148, 16, v98
  v_and_b32 v149, 0xffff0000, v98
  v_lshlrev_b32 v150, 16, v99
  v_and_b32 v151, 0xffff0000, v99
  v_pk_add_f32 v[168:169], v[168:169], v[144:145]
  v_pk_add_f32 v[170:171], v[170:171], v[146:147]
  v_pk_add_f32 v[172:173], v[172:173], v[148:149]
  v_pk_add_f32 v[174:175], v[174:175], v[150:151]
  s_waitcnt vmcnt(10)
  v_lshlrev_b32 v144, 16, v100
  v_and_b32 v145, 0xffff0000, v100
  v_lshlrev_b32 v146, 16, v101
  v_and_b32 v147, 0xffff0000, v101
  v_lshlrev_b32 v148, 16, v102
  v_and_b32 v149, 0xffff0000, v102
  v_lshlrev_b32 v150, 16, v103
  v_and_b32 v151, 0xffff0000, v103
  v_pk_add_f32 v[168:169], v[168:169], v[144:145]
  v_pk_add_f32 v[170:171], v[170:171], v[146:147]
  v_pk_add_f32 v[172:173], v[172:173], v[148:149]
  v_pk_add_f32 v[174:175], v[174:175], v[150:151]
  s_waitcnt vmcnt(9)
  v_lshlrev_b32 v144, 16, v104
  v_and_b32 v145, 0xffff0000, v104
  v_lshlrev_b32 v146, 16, v105
  v_and_b32 v147, 0xffff0000, v105
  v_lshlrev_b32 v148, 16, v106
  v_and_b32 v149, 0xffff0000, v106
  v_lshlrev_b32 v150, 16, v107
  v_and_b32 v151, 0xffff0000, v107
  v_pk_add_f32 v[168:169], v[168:169], v[144:145]
  v_pk_add_f32 v[170:171], v[170:171], v[146:147]
  v_pk_add_f32 v[172:173], v[172:173], v[148:149]
  v_pk_add_f32 v[174:175], v[174:175], v[150:151]
  s_waitcnt vmcnt(8)
  v_lshlrev_b32 v144, 16, v108
  v_and_b32 v145, 0xffff0000, v108
  v_lshlrev_b32 v146, 16, v109
  v_and_b32 v147, 0xffff0000, v109
  v_lshlrev_b32 v148, 16, v110
  v_and_b32 v149, 0xffff0000, v110
  v_lshlrev_b32 v150, 16, v111
  v_and_b32 v151, 0xffff0000, v111
  v_pk_add_f32 v[168:169], v[168:169], v[144:145]
  v_pk_add_f32 v[170:171], v[170:171], v[146:147]
  v_pk_add_f32 v[172:173], v[172:173], v[148:149]
  v_pk_add_f32 v[174:175], v[174:175], v[150:151]
  s_waitcnt vmcnt(7)
  v_lshlrev_b32 v144, 16, v112
  v_and_b32 v145, 0xffff0000, v112
  v_lshlrev_b32 v146, 16, v113
  v_and_b32 v147, 0xffff0000, v113
  v_lshlrev_b32 v148, 16, v114
  v_and_b32 v149, 0xffff0000, v114
  v_lshlrev_b32 v150, 16, v115
  v_and_b32 v151, 0xffff0000, v115
  v_pk_add_f32 v[168:169], v[168:169], v[144:145]
  v_pk_add_f32 v[170:171], v[170:171], v[146:147]
  v_pk_add_f32 v[172:173], v[172:173], v[148:149]
  v_pk_add_f32 v[174:175], v[174:175], v[150:151]
  s_waitcnt vmcnt(6)
  v_lshlrev_b32 v144, 16, v116
  v_and_b32 v145, 0xffff0000, v116
  v_lshlrev_b32 v146, 16, v117
  v_and_b32 v147, 0xffff0000, v117
  v_lshlrev_b32 v148, 16, v118
  v_and_b32 v149, 0xffff0000, v118
  v_lshlrev_b32 v150, 16, v119
  v_and_b32 v151, 0xffff0000, v119
  v_pk_add_f32 v[168:169], v[168:169], v[144:145]
  v_pk_add_f32 v[170:171], v[170:171], v[146:147]
  v_pk_add_f32 v[172:173], v[172:173], v[148:149]
  v_pk_add_f32 v[174:175], v[174:175], v[150:151]
  s_waitcnt vmcnt(5)
  v_lshlrev_b32 v144, 16, v128
  v_and_b32 v145, 0xffff0000, v128
  v_lshlrev_b32 v146, 16, v129
  v_and_b32 v147, 0xffff0000, v129
  v_lshlrev_b32 v148, 16, v130
  v_and_b32 v149, 0xffff0000, v130
  v_lshlrev_b32 v150, 16, v131
  v_and_b32 v151, 0xffff0000, v131
  v_pk_add_f32 v[176:177], v[176:177], v[144:145]
  v_pk_add_f32 v[178:179], v[178:179], v[146:147]
  v_pk_add_f32 v[180:181], v[180:181], v[148:149]
  v_pk_add_f32 v[182:183], v[182:183], v[150:151]
  s_waitcnt vmcnt(4)
  v_lshlrev_b32 v144, 16, v132
  v_and_b32 v145, 0xffff0000, v132
  v_lshlrev_b32 v146, 16, v133
  v_and_b32 v147, 0xffff0000, v133
  v_lshlrev_b32 v148, 16, v134
  v_and_b32 v149, 0xffff0000, v134
  v_lshlrev_b32 v150, 16, v135
  v_and_b32 v151, 0xffff0000, v135
  v_pk_add_f32 v[176:177], v[176:177], v[144:145]
  v_pk_add_f32 v[178:179], v[178:179], v[146:147]
  v_pk_add_f32 v[180:181], v[180:181], v[148:149]
  v_pk_add_f32 v[182:183], v[182:183], v[150:151]
  s_waitcnt vmcnt(3)
  v_lshlrev_b32 v144, 16, v136
  v_and_b32 v145, 0xffff0000, v136
  v_lshlrev_b32 v146, 16, v137
  v_and_b32 v147, 0xffff0000, v137
  v_lshlrev_b32 v148, 16, v138
  v_and_b32 v149, 0xffff0000, v138
  v_lshlrev_b32 v150, 16, v139
  v_and_b32 v151, 0xffff0000, v139
  v_pk_add_f32 v[176:177], v[176:177], v[144:145]
  v_pk_add_f32 v[178:179], v[178:179], v[146:147]
  v_pk_add_f32 v[180:181], v[180:181], v[148:149]
  v_pk_add_f32 v[182:183], v[182:183], v[150:151]
  s_waitcnt vmcnt(2)
  v_lshlrev_b32 v144, 16, v140
  v_and_b32 v145, 0xffff0000, v140
  v_lshlrev_b32 v146, 16, v141
  v_and_b32 v147, 0xffff0000, v141
  v_lshlrev_b32 v148, 16, v142
  v_and_b32 v149, 0xffff0000, v142
  v_lshlrev_b32 v150, 16, v143
  v_and_b32 v151, 0xffff0000, v143
  v_pk_add_f32 v[176:177], v[176:177], v[144:145]
  v_pk_add_f32 v[178:179], v[178:179], v[146:147]
  v_pk_add_f32 v[180:181], v[180:181], v[148:149]
  v_pk_add_f32 v[182:183], v[182:183], v[150:151]
  s_waitcnt vmcnt(1)
  v_lshlrev_b32 v144, 16, v120
  v_and_b32 v145, 0xffff0000, v120
  v_lshlrev_b32 v146, 16, v121
  v_and_b32 v147, 0xffff0000, v121
  v_lshlrev_b32 v148, 16, v122
  v_and_b32 v149, 0xffff0000, v122
  v_lshlrev_b32 v150, 16, v123
  v_and_b32 v151, 0xffff0000, v123
  v_pk_add_f32 v[184:185], v[184:185], v[144:145]
  v_pk_add_f32 v[186:187], v[186:187], v[146:147]
  v_pk_add_f32 v[188:189], v[188:189], v[148:149]
  v_pk_add_f32 v[190:191], v[190:191], v[150:151]
  s_waitcnt vmcnt(0)
  v_lshlrev_b32 v144, 16, v124
  v_and_b32 v145, 0xffff0000, v124
  v_lshlrev_b32 v146, 16, v125
  v_and_b32 v147, 0xffff0000, v125
  v_lshlrev_b32 v148, 16, v126
  v_and_b32 v149, 0xffff0000, v126
  v_lshlrev_b32 v150, 16, v127
  v_and_b32 v151, 0xffff0000, v127
  v_pk_add_f32 v[184:185], v[184:185], v[144:145]
  v_pk_add_f32 v[186:187], v[186:187], v[146:147]
  v_pk_add_f32 v[188:189], v[188:189], v[148:149]
  v_pk_add_f32 v[190:191], v[190:191], v[150:151]
  s_branch L_join9
L_join9:
  v_sub_f32 v28, 1.0, v24
  v_mov_b32 v29, v28
  v_mov_b32 v25, v24
  v_sub_f32 v30, 1.0, v26
  v_mov_b32 v31, v30
  v_mov_b32 v27, v26
  v_mov_b32 v144, v168
  v_mov_b32 v145, v169
  v_mov_b32 v146, v170
  v_mov_b32 v147, v171
  v_mov_b32 v148, v172
  v_mov_b32 v149, v173
  v_mov_b32 v150, v174
  v_mov_b32 v151, v175
  s_nop 1
  v_permlane32_swap_b32 v168, v144
  v_permlane32_swap_b32 v169, v145
  v_permlane32_swap_b32 v170, v146
  v_permlane32_swap_b32 v171, v147
  v_permlane32_swap_b32 v172, v148
  v_permlane32_swap_b32 v173, v149
  v_permlane32_swap_b32 v174, v150
  v_permlane32_swap_b32 v175, v151
  v_add_f32 v168, v168, v144
  v_add_f32 v169, v169, v145
  v_add_f32 v170, v170, v146
  v_add_f32 v171, v171, v147
  v_add_f32 v172, v172, v148
  v_add_f32 v173, v173, v149
  v_add_f32 v174, v174, v150
  v_add_f32 v175, v175, v151
  v_mov_b32 v144, v184
  v_mov_b32 v145, v185
  v_mov_b32 v146, v186
  v_mov_b32 v147, v187
  v_mov_b32 v148, v188
  v_mov_b32 v149, v189
  v_mov_b32 v150, v190
  v_mov_b32 v151, v191
  s_nop 1
  v_permlane32_swap_b32 v184, v144
  v_permlane32_swap_b32 v185, v145
  v_permlane32_swap_b32 v186, v146
  v_permlane32_swap_b32 v187, v147
  v_permlane32_swap_b32 v188, v148
  v_permlane32_swap_b32 v189, v149
  v_permlane32_swap_b32 v190, v150
  v_permlane32_swap_b32 v191, v151
  v_add_f32 v184, v184, v144
  v_add_f32 v185, v185, v145
  v_add_f32 v186, v186, v146
  v_add_f32 v187, v187, v147
  v_add_f32 v188, v188, v148
  v_add_f32 v189, v189, v149
  v_add_f32 v190, v190, v150
  v_add_f32 v191, v191, v151
  v_lshlrev_b32 v144, 16, v16
  v_and_b32 v145, 0xffff0000, v16
  v_lshlrev_b32 v146, 16, v17
  v_and_b32 v147, 0xffff0000, v17
  v_lshlrev_b32 v148, 16, v18
  v_and_b32 v149, 0xffff0000, v18
  v_lshlrev_b32 v150, 16, v19
  v_and_b32 v151, 0xffff0000, v19
  v_pk_add_f32 v[160:161], v[160:161], v[144:145]
  v_pk_mul_f32 v[160:161], v[160:161], v[28:29]
  v_pk_fma_f32 v[160:161], v[176:177], v[24:25], v[160:161]
  v_pk_add_f32 v[162:163], v[162:163], v[146:147]
  v_pk_mul_f32 v[162:163], v[162:163], v[28:29]
  v_pk_fma_f32 v[162:163], v[178:179], v[24:25], v[162:163]
  v_pk_add_f32 v[164:165], v[164:165], v[148:149]
  v_pk_mul_f32 v[164:165], v[164:165], v[28:29]
  v_pk_fma_f32 v[164:165], v[180:181], v[24:25], v[164:165]
  v_pk_add_f32 v[166:167], v[166:167], v[150:151]
  v_pk_mul_f32 v[166:167], v[166:167], v[28:29]
  v_pk_fma_f32 v[166:167], v[182:183], v[24:25], v[166:167]
  v_cvt_pk_bf16_f32 v152, v160, v161
  v_cvt_pk_bf16_f32 v153, v162, v163
  v_cvt_pk_bf16_f32 v154, v164, v165
  v_cvt_pk_bf16_f32 v155, v166, v167
  buffer_store_dwordx2 v[152:153], v9, s[12:15], 0 offen
  buffer_store_dwordx2 v[154:155], v9, s[12:15], 0 offen offset:32
  s_nop 1
  v_lshlrev_b32 v144, 16, v20
  v_and_b32 v145, 0xffff0000, v20
  v_lshlrev_b32 v146, 16, v21
  v_and_b32 v147, 0xffff0000, v21
  v_lshlrev_b32 v148, 16, v22
  v_and_b32 v149, 0xffff0000, v22
  v_lshlrev_b32 v150, 16, v23
  v_and_b32 v151, 0xffff0000, v23
  v_pk_add_f32 v[168:169], v[168:169], v[144:145]
  v_pk_mul_f32 v[168:169], v[168:169], v[30:31]
  v_pk_fma_f32 v[168:169], v[184:185], v[26:27], v[168:169]
  v_pk_add_f32 v[170:171], v[170:171], v[146:147]
  v_pk_mul_f32 v[170:171], v[170:171], v[30:31]
  v_pk_fma_f32 v[170:171], v[186:187], v[26:27], v[170:171]
  v_pk_add_f32 v[172:173], v[172:173], v[148:149]
  v_pk_mul_f32 v[172:173], v[172:173], v[30:31]
  v_pk_fma_f32 v[172:173], v[188:189], v[26:27], v[172:173]
  v_pk_add_f32 v[174:175], v[174:175], v[150:151]
  v_pk_mul_f32 v[174:175], v[174:175], v[30:31]
  v_pk_fma_f32 v[174:175], v[190:191], v[26:27], v[174:175]
  v_cvt_pk_bf16_f32 v152, v168, v169
  v_cvt_pk_bf16_f32 v153, v170, v171
  v_cvt_pk_bf16_f32 v154, v172, v173
  v_cvt_pk_bf16_f32 v155, v174, v175
  s_mov_b32 exec_lo, -1
  s_mov_b32 exec_hi, 0
  buffer_store_dwordx2 v[152:153], v14, s[12:15], 0 offen
  buffer_store_dwordx2 v[154:155], v14, s[12:15], 0 offen offset:32
  s_nop 1
  s_mov_b64 exec, -1
  s_endpgm
L_att:
  s_mov_b32 s20, s86
  s_and_b32 s21, s87, 0xffff
  s_mov_b32 s22, 268435456
  s_mov_b32 s23, 0x20000
  s_mov_b32 s48, s84
  s_and_b32 s49, s85, 0xffff
  s_mov_b32 s50, 256
  s_mov_b32 s51, 0x20000
  s_mov_b32 s88, s78
  s_mov_b32 s89, s79
  s_mov_b32 s90, s82
  s_mov_b32 s91, s83
  s_mov_b32 s12, s66
  s_and_b32 s13, s67, 0xffff
  s_mov_b32 s14, 1990656
  s_mov_b32 s15, 0x20000
  s_mov_b32 s16, s68
  s_and_b32 s17, s69, 0xffff
  s_mov_b32 s18, 663552
  s_mov_b32 s19, 0x20000
  s_mov_b32 s24, s80
  s_and_b32 s25, s81, 0xffff
  s_mov_b32 s26, 1152
  s_mov_b32 s27, 0x20000
  s_lshl_b32 s45, s30, 2
  s_add_u32 s46, s45, 64
  v_mov_b32 v8, 0
  v_mov_b32 v9, 0
  v_mov_b32 v10, 0
  v_mov_b32 v11, 0
  s_mul_i32 s33, s30, 36864
  s_mul_i32 s34, s29, 2304
  s_add_u32 s33, s33, s34
  s_mul_i32 s34, s28, 288
  s_add_u32 s33, s33, s34
  s_add_u32 s33, s33, 37756928
  v_lshlrev_b32 v12, 4, v255
  s_mov_b64 exec, 0x3ffff
  buffer_store_dwordx4 v[8:11], v12, s[20:23], s33 offen sc1
  s_cmp_lg_u32 s30, 0
  s_cbranch_scc1 L_zc16
  s_lshl_b32 s33, s29, 8
  s_add_u32 s33, s33, 37904384
  v_lshlrev_b32 v13, 6, v255
  s_mov_b64 exec, 7
  buffer_store_dword v8, v13, s[20:23], s33 offen sc1
L_zc16:
  s_mov_b64 exec, -1
  s_mul_i32 s39, s30, 288
  s_mov_b32 s43, 0x3f803f80
  s_cmp_lg_u32 s31, s30
  s_cbranch_scc1 L_gatel19
  v_lshrrev_b32 v249, 4, v255
  v_lshlrev_b32 v249, 3, v249
  buffer_load_dwordx2 v[144:145], v249, s[24:27], 0 offen offset:0
  buffer_load_dwordx2 v[146:147], v249, s[24:27], 0 offen offset:32
  buffer_load_dwordx2 v[148:149], v249, s[24:27], 0 offen offset:64
  buffer_load_dwordx2 v[150:151], v249, s[24:27], 0 offen offset:96
  buffer_load_dwordx2 v[152:153], v249, s[24:27], 0 offen offset:128
  buffer_load_dwordx2 v[154:155], v249, s[24:27], 0 offen offset:160
  buffer_load_dwordx2 v[156:157], v249, s[24:27], 0 offen offset:192
  buffer_load_dwordx2 v[158:159], v249, s[24:27], 0 offen offset:224
  buffer_load_dwordx2 v[160:161], v249, s[24:27], 0 offen offset:256
  buffer_load_dwordx2 v[162:163], v249, s[24:27], 0 offen offset:288
  buffer_load_dwordx2 v[164:165], v249, s[24:27], 0 offen offset:320
  buffer_load_dwordx2 v[166:167], v249, s[24:27], 0 offen offset:352
  buffer_load_dwordx2 v[168:169], v249, s[24:27], 0 offen offset:384
  buffer_load_dwordx2 v[170:171], v249, s[24:27], 0 offen offset:416
  buffer_load_dwordx2 v[172:173], v249, s[24:27], 0 offen offset:448
  buffer_load_dwordx2 v[174:175], v249, s[24:27], 0 offen offset:480
  buffer_load_dwordx2 v[176:177], v249, s[24:27], 0 offen offset:512
  buffer_load_dwordx2 v[178:179], v249, s[24:27], 0 offen offset:544
  buffer_load_dwordx2 v[180:181], v249, s[24:27], 0 offen offset:576
  buffer_load_dwordx2 v[182:183], v249, s[24:27], 0 offen offset:608
  buffer_load_dwordx2 v[184:185], v249, s[24:27], 0 offen offset:640
  buffer_load_dwordx2 v[186:187], v249, s[24:27], 0 offen offset:672
  buffer_load_dwordx2 v[188:189], v249, s[24:27], 0 offen offset:704
  buffer_load_dwordx2 v[190:191], v249, s[24:27], 0 offen offset:736
  buffer_load_dwordx2 v[192:193], v249, s[24:27], 0 offen offset:768
  buffer_load_dwordx2 v[194:195], v249, s[24:27], 0 offen offset:800
  buffer_load_dwordx2 v[196:197], v249, s[24:27], 0 offen offset:832
  buffer_load_dwordx2 v[198:199], v249, s[24:27], 0 offen offset:864
  buffer_load_dwordx2 v[200:201], v249, s[24:27], 0 offen offset:896
  buffer_load_dwordx2 v[202:203], v249, s[24:27], 0 offen offset:928
  buffer_load_dwordx2 v[204:205], v249, s[24:27], 0 offen offset:960
  buffer_load_dwordx2 v[206:207], v249, s[24:27], 0 offen offset:992
  buffer_load_dwordx2 v[208:209], v249, s[24:27], 0 offen offset:1024
  buffer_load_dwordx2 v[210:211], v249, s[24:27], 0 offen offset:1056
  buffer_load_dwordx2 v[212:213], v249, s[24:27], 0 offen offset:1088
  buffer_load_dwordx2 v[214:215], v249, s[24:27], 0 offen offset:1120
L_gatel19:
  s_cmp_eq_u32 s32, 0
  s_cbranch_scc1 L_w0317
  s_and_b32 s36, s39, 0xffffff80
  s_add_u32 s53, s36, 1152
  s_mul_i32 s33, s28, 72
  s_add_u32 s33, s33, 4294967008
  v_add_u32 v220, s33, v255
  v_min_u32 v220, 287, v220
  s_mul_i32 s34, s47, 72
  v_and_b32 v249, 3, v220
  v_lshrrev_b32 v220, 2, v220
  v_add_u32 v220, s34, v220
  s_mov_b32 s34, 3456
  v_mul_lo_u32 v220, v220, s34
  v_lshl_add_u32 v220, v249, 7, v220
  s_mul_i32 s33, s28, 72
  s_add_u32 s33, s33, 4294967072
  v_add_u32 v221, s33, v255
  v_min_u32 v221, 287, v221
  s_mul_i32 s34, s47, 72
  v_and_b32 v249, 3, v221
  v_lshrrev_b32 v221, 2, v221
  v_add_u32 v221, s34, v221
  s_mov_b32 s34, 3456
  v_mul_lo_u32 v221, v221, s34
  v_lshl_add_u32 v221, v249, 7, v221
  s_mov_b32 m0, 155648
  s_mov_b32 s37, s53
  buffer_load_dword v220, s[12:15], s37 offen lds
  s_mov_b32 m0, 155648
  s_mov_b32 s37, s53
  buffer_load_dword v221, s[12:15], s37 offen lds
  s_and_b32 s36, s39, 0xffffff80
  s_add_u32 s53, s36, 2304
  s_mul_i32 s33, s28, 72
  s_add_u32 s33, s33, 4294967008
  v_add_u32 v220, s33, v255
  v_min_u32 v220, 287, v220
  s_mul_i32 s34, s47, 72
  v_and_b32 v249, 3, v220
  v_lshrrev_b32 v220, 2, v220
  v_add_u32 v220, s34, v220
  s_mov_b32 s34, 3456
  v_mul_lo_u32 v220, v220, s34
  v_lshl_add_u32 v220, v249, 7, v220
  s_mul_i32 s33, s28, 72
  s_add_u32 s33, s33, 4294967072
  v_add_u32 v221, s33, v255
  v_min_u32 v221, 287, v221
  s_mul_i32 s34, s47, 72
  v_and_b32 v249, 3, v221
  v_lshrrev_b32 v221, 2, v221
  v_add_u32 v221, s34, v221
  s_mov_b32 s34, 3456
  v_mul_lo_u32 v221, v221, s34
  v_lshl_add_u32 v221, v249, 7, v221
  s_mov_b32 m0, 155648
  s_mov_b32 s37, s53
  buffer_load_dword v220, s[12:15], s37 offen lds
  s_mov_b32 m0, 155648
  s_mov_b32 s37, s53
  buffer_load_dword v221, s[12:15], s37 offen lds
  s_waitcnt vmcnt(4)
  s_branch L_w03d18
L_w0317:
  s_waitcnt vmcnt(0)
L_w03d18:
  s_barrier
  s_cmp_lg_u32 s28, 0
  s_cbranch_scc1 L_sig20
  v_mov_b32 v249, 1
  v_mov_b32 v250, 0
  s_mov_b64 exec, 1
  buffer_atomic_add v249, v250, s[48:51], s45 offen
  s_mov_b64 exec, -1
L_sig20:
  v_and_b32 v249, 15, v255
  v_lshrrev_b32 v250, 3, v249
  v_lshlrev_b32 v244, 10, v250
  v_and_b32 v250, 7, v249
  v_lshl_add_u32 v244, v250, 7, v244
  v_lshrrev_b32 v249, 1, v249
  v_lshrrev_b32 v250, 5, v255
  v_xor_b32 v249, v249, v250
  v_lshl_add_u32 v244, v249, 4, v244
  v_lshrrev_b32 v250, 4, v255
  v_and_b32 v250, 1, v250
  v_lshl_add_u32 v244, v250, 3, v244
  s_mul_i32 s33, s31, 36864
  v_add_u32 v244, s33, v244
  v_xor_b32 v245, 32, v244
  v_xor_b32 v246, 64, v244
  v_xor_b32 v247, 96, v244
  ds_read_b64 v[0:1], v244 offset:0
  ds_read_b64 v[2:3], v245 offset:0
  ds_read_b64 v[4:5], v246 offset:0
  ds_read_b64 v[6:7], v247 offset:0
  ds_read_b64 v[8:9], v244 offset:2048
  ds_read_b64 v[10:11], v245 offset:2048
  ds_read_b64 v[12:13], v246 offset:2048
  ds_read_b64 v[14:15], v247 offset:2048
  ds_read_b64 v[16:17], v244 offset:4096
  ds_read_b64 v[18:19], v245 offset:4096
  ds_read_b64 v[20:21], v246 offset:4096
  ds_read_b64 v[22:23], v247 offset:4096
  ds_read_b64 v[24:25], v244 offset:6144
  ds_read_b64 v[26:27], v245 offset:6144
  ds_read_b64 v[28:29], v246 offset:6144
  ds_read_b64 v[30:31], v247 offset:6144
  ds_read_b64 v[32:33], v244 offset:8192
  ds_read_b64 v[34:35], v245 offset:8192
  ds_read_b64 v[36:37], v246 offset:8192
  ds_read_b64 v[38:39], v247 offset:8192
  ds_read_b64 v[40:41], v244 offset:10240
  ds_read_b64 v[42:43], v245 offset:10240
  ds_read_b64 v[44:45], v246 offset:10240
  ds_read_b64 v[46:47], v247 offset:10240
  ds_read_b64 v[48:49], v244 offset:12288
  ds_read_b64 v[50:51], v245 offset:12288
  ds_read_b64 v[52:53], v246 offset:12288
  ds_read_b64 v[54:55], v247 offset:12288
  ds_read_b64 v[56:57], v244 offset:14336
  ds_read_b64 v[58:59], v245 offset:14336
  ds_read_b64 v[60:61], v246 offset:14336
  ds_read_b64 v[62:63], v247 offset:14336
  ds_read_b64 v[64:65], v244 offset:16384
  ds_read_b64 v[66:67], v245 offset:16384
  ds_read_b64 v[68:69], v246 offset:16384
  ds_read_b64 v[70:71], v247 offset:16384
  ds_read_b64 v[72:73], v244 offset:18432
  ds_read_b64 v[74:75], v245 offset:18432
  ds_read_b64 v[76:77], v246 offset:18432
  ds_read_b64 v[78:79], v247 offset:18432
  ds_read_b64 v[80:81], v244 offset:20480
  ds_read_b64 v[82:83], v245 offset:20480
  ds_read_b64 v[84:85], v246 offset:20480
  ds_read_b64 v[86:87], v247 offset:20480
  ds_read_b64 v[88:89], v244 offset:22528
  ds_read_b64 v[90:91], v245 offset:22528
  ds_read_b64 v[92:93], v246 offset:22528
  ds_read_b64 v[94:95], v247 offset:22528
  ds_read_b64 v[96:97], v244 offset:24576
  ds_read_b64 v[98:99], v245 offset:24576
  ds_read_b64 v[100:101], v246 offset:24576
  ds_read_b64 v[102:103], v247 offset:24576
  ds_read_b64 v[104:105], v244 offset:26624
  ds_read_b64 v[106:107], v245 offset:26624
  ds_read_b64 v[108:109], v246 offset:26624
  ds_read_b64 v[110:111], v247 offset:26624
  ds_read_b64 v[112:113], v244 offset:28672
  ds_read_b64 v[114:115], v245 offset:28672
  ds_read_b64 v[116:117], v246 offset:28672
  ds_read_b64 v[118:119], v247 offset:28672
  ds_read_b64 v[120:121], v244 offset:30720
  ds_read_b64 v[122:123], v245 offset:30720
  ds_read_b64 v[124:125], v246 offset:30720
  ds_read_b64 v[126:127], v247 offset:30720
  ds_read_b64 v[128:129], v244 offset:32768
  ds_read_b64 v[130:131], v245 offset:32768
  ds_read_b64 v[132:133], v246 offset:32768
  ds_read_b64 v[134:135], v247 offset:32768
  ds_read_b64 v[136:137], v244 offset:34816
  ds_read_b64 v[138:139], v245 offset:34816
  ds_read_b64 v[140:141], v246 offset:34816
  ds_read_b64 v[142:143], v247 offset:34816
  v_cmp_le_u32 vcc, 18, v255
  v_mov_b32 v249, 0
  v_mov_b32 v250, 1
  v_cndmask_b32 v251, v249, v250, vcc
  v_cmp_le_u32 vcc, 36, v255
  s_nop 1
  v_cndmask_b32 v252, v249, v250, vcc
  v_add_u32 v251, v251, v252
  v_cmp_le_u32 vcc, 54, v255
  s_nop 1
  v_cndmask_b32 v252, v249, v250, vcc
  v_add_u32 v251, v251, v252
  v_mul_u32_u24 v252, 18, v251
  v_sub_u32 v252, v255, v252
  v_mul_u32_u24 v248, 3456, v251
  v_lshl_add_u32 v248, v252, 4, v248
  s_mul_i32 s98, s28, 864
  s_mul_i32 s99, s28, 10368
  s_add_u32 s99, s99, s39
  s_lshl_b32 s38, s28, 10
  s_waitcnt lgkmcnt(0)
  s_barrier
  s_add_u32 m0, s98, 73728
  s_add_u32 s37, s99, 1152
  s_mov_b32 exec_lo, 4294967295
  s_mov_b32 exec_hi, 4194303
  buffer_load_dwordx4 v248, s[12:15], s37 offen lds
  s_mov_b64 exec, -1
  s_add_u32 m0, s98, 80640
  s_add_u32 s37, s99, 84096
  s_mov_b32 exec_lo, 4294967295
  s_mov_b32 exec_hi, 4194303
  buffer_load_dwordx4 v248, s[12:15], s37 offen lds
  s_mov_b64 exec, -1
  s_add_u32 m0, s98, 87552
  s_add_u32 s37, s99, 167040
  s_mov_b32 exec_lo, 4294967295
  s_mov_b32 exec_hi, 4194303
  buffer_load_dwordx4 v248, s[12:15], s37 offen lds
  s_mov_b64 exec, -1
  s_add_u32 m0, s98, 94464
  s_add_u32 s37, s99, 249984
  s_mov_b32 exec_lo, 4294967295
  s_mov_b32 exec_hi, 4194303
  buffer_load_dwordx4 v248, s[12:15], s37 offen lds
  s_mov_b64 exec, -1
  s_add_u32 m0, s98, 101376
  s_add_u32 s37, s99, 332928
  s_mov_b32 exec_lo, 4294967295
  s_mov_b32 exec_hi, 4194303
  buffer_load_dwordx4 v248, s[12:15], s37 offen lds
  s_mov_b64 exec, -1
  s_cmp_gt_u32 s28, 2
  s_cbranch_scc1 L_dsk21
  s_add_u32 m0, s98, 108288
  s_add_u32 s37, s99, 415872
  s_mov_b32 exec_lo, 4294967295
  s_mov_b32 exec_hi, 4194303
  s_cmp_lg_u32 s28, 2
  s_cbranch_scc1 L_dpt22
  s_mov_b32 exec_lo, 4294967295
  s_mov_b32 exec_hi, 15
  L_dpt22:
  buffer_load_dwordx4 v248, s[12:15], s37 offen lds
  s_mov_b64 exec, -1
  L_dsk21:
  s_add_u32 m0, s98, 110592
  s_add_u32 s37, s99, 2304
  s_mov_b32 exec_lo, 4294967295
  s_mov_b32 exec_hi, 4194303
  buffer_load_dwordx4 v248, s[12:15], s37 offen lds
  s_mov_b64 exec, -1
  s_add_u32 m0, s98, 117504
  s_add_u32 s37, s99, 85248
  s_mov_b32 exec_lo, 4294967295
  s_mov_b32 exec_hi, 4194303
  buffer_load_dwordx4 v248, s[12:15], s37 offen lds
  s_mov_b64 exec, -1
  s_add_u32 m0, s98, 124416
  s_add_u32 s37, s99, 168192
  s_mov_b32 exec_lo, 4294967295
  s_mov_b32 exec_hi, 4194303
  buffer_load_dwordx4 v248, s[12:15], s37 offen lds
  s_mov_b64 exec, -1
  s_add_u32 m0, s98, 131328
  s_add_u32 s37, s99, 251136
  s_mov_b32 exec_lo, 4294967295
  s_mov_b32 exec_hi, 4194303
  buffer_load_dwordx4 v248, s[12:15], s37 offen lds
  s_mov_b64 exec, -1
  s_add_u32 m0, s98, 138240
  s_add_u32 s37, s99, 334080
  s_mov_b32 exec_lo, 4294967295
  s_mov_b32 exec_hi, 4194303
  buffer_load_dwordx4 v248, s[12:15], s37 offen lds
  s_mov_b64 exec, -1
  s_cmp_gt_u32 s28, 2
  s_cbranch_scc1 L_dsk23
  s_add_u32 m0, s98, 145152
  s_add_u32 s37, s99, 417024
  s_mov_b32 exec_lo, 4294967295
  s_mov_b32 exec_hi, 4194303
  s_cmp_lg_u32 s28, 2
  s_cbranch_scc1 L_dpt24
  s_mov_b32 exec_lo, 4294967295
  s_mov_b32 exec_hi, 15
  L_dpt24:
  buffer_load_dwordx4 v248, s[12:15], s37 offen lds
  s_mov_b64 exec, -1
  L_dsk23:
  s_cmp_lg_u32 s31, s30
  s_cbranch_scc1 L_gate25
  v_mov_b32 v216, 0
  v_mov_b32 v217, 0
  v_mov_b32 v218, 0
  v_mov_b32 v219, 0
  s_cmp_lg_u32 s32, 0
  s_cbranch_scc1 L_gate126
  v_dot2c_f32_bf16 v216, v144, v0
  v_dot2c_f32_bf16 v217, v145, v1
  v_dot2c_f32_bf16 v218, v146, v2
  v_dot2c_f32_bf16 v219, v147, v3
  v_dot2c_f32_bf16 v216, v148, v4
  v_dot2c_f32_bf16 v217, v149, v5
  v_dot2c_f32_bf16 v218, v150, v6
  v_dot2c_f32_bf16 v219, v151, v7
  v_dot2c_f32_bf16 v216, v152, v8
  v_dot2c_f32_bf16 v217, v153, v9
  v_dot2c_f32_bf16 v218, v154, v10
  v_dot2c_f32_bf16 v219, v155, v11
  v_dot2c_f32_bf16 v216, v156, v12
  v_dot2c_f32_bf16 v217, v157, v13
  v_dot2c_f32_bf16 v218, v158, v14
  v_dot2c_f32_bf16 v219, v159, v15
  v_dot2c_f32_bf16 v216, v160, v16
  v_dot2c_f32_bf16 v217, v161, v17
  v_dot2c_f32_bf16 v218, v162, v18
  v_dot2c_f32_bf16 v219, v163, v19
  v_dot2c_f32_bf16 v216, v164, v20
  v_dot2c_f32_bf16 v217, v165, v21
  v_dot2c_f32_bf16 v218, v166, v22
  v_dot2c_f32_bf16 v219, v167, v23
  v_dot2c_f32_bf16 v216, v168, v24
  v_dot2c_f32_bf16 v217, v169, v25
  v_dot2c_f32_bf16 v218, v170, v26
  v_dot2c_f32_bf16 v219, v171, v27
  v_dot2c_f32_bf16 v216, v172, v28
  v_dot2c_f32_bf16 v217, v173, v29
  v_dot2c_f32_bf16 v218, v174, v30
  v_dot2c_f32_bf16 v219, v175, v31
  v_dot2c_f32_bf16 v216, v176, v32
  v_dot2c_f32_bf16 v217, v177, v33
  v_dot2c_f32_bf16 v218, v178, v34
  v_dot2c_f32_bf16 v219, v179, v35
  v_dot2c_f32_bf16 v216, v180, v36
  v_dot2c_f32_bf16 v217, v181, v37
  v_dot2c_f32_bf16 v218, v182, v38
  v_dot2c_f32_bf16 v219, v183, v39
  v_dot2c_f32_bf16 v216, v184, v40
  v_dot2c_f32_bf16 v217, v185, v41
  v_dot2c_f32_bf16 v218, v186, v42
  v_dot2c_f32_bf16 v219, v187, v43
  v_dot2c_f32_bf16 v216, v188, v44
  v_dot2c_f32_bf16 v217, v189, v45
  v_dot2c_f32_bf16 v218, v190, v46
  v_dot2c_f32_bf16 v219, v191, v47
  v_dot2c_f32_bf16 v216, v192, v48
  v_dot2c_f32_bf16 v217, v193, v49
  v_dot2c_f32_bf16 v218, v194, v50
  v_dot2c_f32_bf16 v219, v195, v51
  v_dot2c_f32_bf16 v216, v196, v52
  v_dot2c_f32_bf16 v217, v197, v53
  v_dot2c_f32_bf16 v218, v198, v54
  v_dot2c_f32_bf16 v219, v199, v55
  v_dot2c_f32_bf16 v216, v200, v56
  v_dot2c_f32_bf16 v217, v201, v57
  v_dot2c_f32_bf16 v218, v202, v58
  v_dot2c_f32_bf16 v219, v203, v59
  v_dot2c_f32_bf16 v216, v204, v60
  v_dot2c_f32_bf16 v217, v205, v61
  v_dot2c_f32_bf16 v218, v206, v62
  v_dot2c_f32_bf16 v219, v207, v63
  v_dot2c_f32_bf16 v216, v208, v64
  v_dot2c_f32_bf16 v217, v209, v65
  v_dot2c_f32_bf16 v218, v210, v66
  v_dot2c_f32_bf16 v219, v211, v67
  v_dot2c_f32_bf16 v216, v212, v68
  v_dot2c_f32_bf16 v217, v213, v69
  v_dot2c_f32_bf16 v218, v214, v70
  v_dot2c_f32_bf16 v219, v215, v71
  s_branch L_gate227
L_gate126:
  v_dot2c_f32_bf16 v216, v144, v72
  v_dot2c_f32_bf16 v217, v145, v73
  v_dot2c_f32_bf16 v218, v146, v74
  v_dot2c_f32_bf16 v219, v147, v75
  v_dot2c_f32_bf16 v216, v148, v76
  v_dot2c_f32_bf16 v217, v149, v77
  v_dot2c_f32_bf16 v218, v150, v78
  v_dot2c_f32_bf16 v219, v151, v79
  v_dot2c_f32_bf16 v216, v152, v80
  v_dot2c_f32_bf16 v217, v153, v81
  v_dot2c_f32_bf16 v218, v154, v82
  v_dot2c_f32_bf16 v219, v155, v83
  v_dot2c_f32_bf16 v216, v156, v84
  v_dot2c_f32_bf16 v217, v157, v85
  v_dot2c_f32_bf16 v218, v158, v86
  v_dot2c_f32_bf16 v219, v159, v87
  v_dot2c_f32_bf16 v216, v160, v88
  v_dot2c_f32_bf16 v217, v161, v89
  v_dot2c_f32_bf16 v218, v162, v90
  v_dot2c_f32_bf16 v219, v163, v91
  v_dot2c_f32_bf16 v216, v164, v92
  v_dot2c_f32_bf16 v217, v165, v93
  v_dot2c_f32_bf16 v218, v166, v94
  v_dot2c_f32_bf16 v219, v167, v95
  v_dot2c_f32_bf16 v216, v168, v96
  v_dot2c_f32_bf16 v217, v169, v97
  v_dot2c_f32_bf16 v218, v170, v98
  v_dot2c_f32_bf16 v219, v171, v99
  v_dot2c_f32_bf16 v216, v172, v100
  v_dot2c_f32_bf16 v217, v173, v101
  v_dot2c_f32_bf16 v218, v174, v102
  v_dot2c_f32_bf16 v219, v175, v103
  v_dot2c_f32_bf16 v216, v176, v104
  v_dot2c_f32_bf16 v217, v177, v105
  v_dot2c_f32_bf16 v218, v178, v106
  v_dot2c_f32_bf16 v219, v179, v107
  v_dot2c_f32_bf16 v216, v180, v108
  v_dot2c_f32_bf16 v217, v181, v109
  v_dot2c_f32_bf16 v218, v182, v110
  v_dot2c_f32_bf16 v219, v183, v111
  v_dot2c_f32_bf16 v216, v184, v112
  v_dot2c_f32_bf16 v217, v185, v113
  v_dot2c_f32_bf16 v218, v186, v114
  v_dot2c_f32_bf16 v219, v187, v115
  v_dot2c_f32_bf16 v216, v188, v116
  v_dot2c_f32_bf16 v217, v189, v117
  v_dot2c_f32_bf16 v218, v190, v118
  v_dot2c_f32_bf16 v219, v191, v119
  v_dot2c_f32_bf16 v216, v192, v120
  v_dot2c_f32_bf16 v217, v193, v121
  v_dot2c_f32_bf16 v218, v194, v122
  v_dot2c_f32_bf16 v219, v195, v123
  v_dot2c_f32_bf16 v216, v196, v124
  v_dot2c_f32_bf16 v217, v197, v125
  v_dot2c_f32_bf16 v218, v198, v126
  v_dot2c_f32_bf16 v219, v199, v127
  v_dot2c_f32_bf16 v216, v200, v128
  v_dot2c_f32_bf16 v217, v201, v129
  v_dot2c_f32_bf16 v218, v202, v130
  v_dot2c_f32_bf16 v219, v203, v131
  v_dot2c_f32_bf16 v216, v204, v132
  v_dot2c_f32_bf16 v217, v205, v133
  v_dot2c_f32_bf16 v218, v206, v134
  v_dot2c_f32_bf16 v219, v207, v135
  v_dot2c_f32_bf16 v216, v208, v136
  v_dot2c_f32_bf16 v217, v209, v137
  v_dot2c_f32_bf16 v218, v210, v138
  v_dot2c_f32_bf16 v219, v211, v139
  v_dot2c_f32_bf16 v216, v212, v140
  v_dot2c_f32_bf16 v217, v213, v141
  v_dot2c_f32_bf16 v218, v214, v142
  v_dot2c_f32_bf16 v219, v215, v143
L_gate227:
  s_nop 3
  v_add_f32 v216, v216, v217
  v_add_f32 v218, v218, v219
  v_add_f32 v216, v216, v218
  v_mov_b32 v220, v216
  s_nop 1
  v_permlane16_swap_b32 v216, v220
  v_add_f32 v216, v216, v220
  v_mov_b32 v220, v216
  s_nop 1
  v_permlane32_swap_b32 v216, v220
  v_add_f32 v216, v216, v220
  v_mul_f32 v216, 0xbfb8aa3b, v216
  v_exp_f32 v216, v216
  s_nop 0
  v_add_f32 v216, 1.0, v216
  v_rcp_f32 v216, v216
  v_lshlrev_b32 v221, 2, v255
  s_lshl_b32 s33, s29, 7
  s_lshl_b32 s34, s31, 5
  s_add_u32 s33, s33, s34
  s_lshl_b32 s34, s32, 4
  s_add_u32 s33, s33, s34
  s_lshl_b32 s33, s33, 2
  s_add_u32 s33, s33, 37748736
  s_mov_b64 exec, 0xffff
  buffer_store_dword v216, v221, s[20:23], s33 offen sc1
  s_mov_b64 exec, -1
L_gate25:
  v_lshrrev_b32 v249, 4, v255
  v_lshlrev_b32 v249, 2, v249
  v_and_b32 v250, 15, v255
  v_lshrrev_b32 v251, 2, v250
  v_add_u32 v249, v249, v251
  v_mul_u32_u24 v249, 288, v249
  s_mul_i32 s33, s32, 144
  v_add_u32 v249, s33, v249
  v_and_b32 v250, 3, v250
  v_lshl_add_u32 v244, v250, 3, v249
  v_add_u32 v245, 36880, v244
  v_add_u32 v251, 128, v244
  v_add_u32 v252, 36848, v244
  v_cmp_gt_u32 vcc, 2, v250
  s_nop 1
  v_cndmask_b32 v246, v252, v251, vcc
  v_add_u32 v252, 112, v244
  v_cndmask_b32 v247, v252, v251, vcc
  v_mov_b32 v254, v244
  v_mov_b32 v253, v247
  v_add_u32 v244, 73728, v244
  v_add_u32 v245, 73728, v245
  v_add_u32 v246, 73728, v246
  s_waitcnt vmcnt(0)
  s_barrier
  s_and_b32 s4, s39, 0xffffff80
  s_mul_i32 s33, s28, 36
  s_add_u32 s33, s33, 0
  v_add_u32 v236, s33, v255
  v_min_u32 v236, 287, v236
  s_mul_i32 s34, s47, 72
  v_and_b32 v249, 3, v236
  v_lshrrev_b32 v236, 2, v236
  v_add_u32 v236, s34, v236
  s_mov_b32 s34, 3456
  v_mul_lo_u32 v236, v236, s34
  v_lshl_add_u32 v236, v249, 7, v236
  s_mul_i32 s5, s30, 165888
  s_mul_i32 s33, s28, 21
  s_add_u32 s33, s33, 0
  v_add_u32 v238, s33, v255
  v_min_u32 v238, 161, v238
  s_mul_i32 s34, s47, 162
  v_add_u32 v238, s34, v238
  s_mov_b32 s34, 128
  v_mul_lo_u32 v238, v238, s34
  ds_read_b64_tr_b16 v[216:217], v244 offset:0
  ds_read_b64_tr_b16 v[218:219], v244 offset:4608
  ds_read_b64_tr_b16 v[220:221], v244 offset:32
  ds_read_b64_tr_b16 v[222:223], v244 offset:4640
  ds_read_b64_tr_b16 v[224:225], v244 offset:64
  ds_read_b64_tr_b16 v[226:227], v244 offset:4672
  ds_read_b64_tr_b16 v[228:229], v244 offset:96
  ds_read_b64_tr_b16 v[230:231], v244 offset:4704
  s_waitcnt lgkmcnt(6)
  v_mfma_f32_16x16x32_bf16 v[144:147], v[0:3], v[216:219], 0
  ds_read_b64_tr_b16 v[232:233], v246 offset:0
  v_mfma_f32_16x16x32_bf16 v[148:151], v[72:75], v[216:219], 0
  ds_read_b64_tr_b16 v[234:235], v246 offset:4608
  s_add_u32 m0, s98, 0
  s_add_u32 s37, s99, 443520
  s_mov_b32 exec_lo, 4294967295
  s_mov_b32 exec_hi, 4194303
  buffer_load_dwordx4 v248, s[12:15], s37 offen lds
  s_mov_b64 exec, -1
  s_waitcnt lgkmcnt(6)
  v_mfma_f32_16x16x32_bf16 v[152:155], v[0:3], v[220:223], 0
  ds_read_b64_tr_b16 v[216:217], v245 offset:0
  v_mfma_f32_16x16x32_bf16 v[156:159], v[72:75], v[220:223], 0
  ds_read_b64_tr_b16 v[218:219], v245 offset:4608
  s_waitcnt lgkmcnt(6)
  v_mfma_f32_16x16x32_bf16 v[160:163], v[0:3], v[224:227], 0
  ds_read_b64_tr_b16 v[220:221], v245 offset:32
  v_mfma_f32_16x16x32_bf16 v[164:167], v[72:75], v[224:227], 0
  ds_read_b64_tr_b16 v[222:223], v245 offset:4640
  s_add_u32 m0, s98, 6912
  s_add_u32 s37, s99, 526464
  s_mov_b32 exec_lo, 4294967295
  s_mov_b32 exec_hi, 4194303
  buffer_load_dwordx4 v248, s[12:15], s37 offen lds
  s_mov_b64 exec, -1
  s_waitcnt lgkmcnt(6)
  v_mfma_f32_16x16x32_bf16 v[168:171], v[0:3], v[228:231], 0
  ds_read_b64_tr_b16 v[224:225], v245 offset:64
  v_mfma_f32_16x16x32_bf16 v[172:175], v[72:75], v[228:231], 0
  ds_read_b64_tr_b16 v[226:227], v245 offset:4672
  s_waitcnt lgkmcnt(6)
  v_mfma_f32_16x16x32_bf16 v[176:179], v[0:3], v[232:235], 0
  ds_read_b64_tr_b16 v[228:229], v245 offset:96
  v_mfma_f32_16x16x32_bf16 v[180:183], v[72:75], v[232:235], 0
  ds_read_b64_tr_b16 v[230:231], v245 offset:4704
  s_add_u32 m0, s98, 13824
  s_add_u32 s37, s99, 609408
  s_mov_b32 exec_lo, 4294967295
  s_mov_b32 exec_hi, 4194303
  buffer_load_dwordx4 v248, s[12:15], s37 offen lds
  s_mov_b64 exec, -1
  s_waitcnt lgkmcnt(6)
  v_mfma_f32_16x16x32_bf16 v[184:187], v[0:3], v[216:219], 0
  ds_read_b64_tr_b16 v[232:233], v244 offset:9216
  v_mfma_f32_16x16x32_bf16 v[188:191], v[72:75], v[216:219], 0
  ds_read_b64_tr_b16 v[234:235], v244 offset:13824
  s_waitcnt lgkmcnt(6)
  v_mfma_f32_16x16x32_bf16 v[192:195], v[0:3], v[220:223], 0
  ds_read_b64_tr_b16 v[216:217], v244 offset:9248
  v_mfma_f32_16x16x32_bf16 v[196:199], v[72:75], v[220:223], 0
  ds_read_b64_tr_b16 v[218:219], v244 offset:13856
  s_add_u32 m0, s98, 20736
  s_add_u32 s37, s99, 692352
  s_mov_b32 exec_lo, 4294967295
  s_mov_b32 exec_hi, 4194303
  buffer_load_dwordx4 v248, s[12:15], s37 offen lds
  s_mov_b64 exec, -1
  s_waitcnt lgkmcnt(6)
  v_mfma_f32_16x16x32_bf16 v[200:203], v[0:3], v[224:227], 0
  ds_read_b64_tr_b16 v[220:221], v244 offset:9280
  v_mfma_f32_16x16x32_bf16 v[204:207], v[72:75], v[224:227], 0
  ds_read_b64_tr_b16 v[222:223], v244 offset:13888
  s_waitcnt lgkmcnt(6)
  v_mfma_f32_16x16x32_bf16 v[208:211], v[0:3], v[228:231], 0
  ds_read_b64_tr_b16 v[224:225], v244 offset:9312
  v_mfma_f32_16x16x32_bf16 v[212:215], v[72:75], v[228:231], 0
  ds_read_b64_tr_b16 v[226:227], v244 offset:13920
  s_add_u32 m0, s98, 27648
  s_add_u32 s37, s99, 775296
  s_mov_b32 exec_lo, 4294967295
  s_mov_b32 exec_hi, 4194303
  buffer_load_dwordx4 v248, s[12:15], s37 offen lds
  s_mov_b64 exec, -1
  s_waitcnt lgkmcnt(6)
  v_mfma_f32_16x16x32_bf16 v[144:147], v[4:7], v[232:235], v[144:147]
  ds_read_b64_tr_b16 v[228:229], v246 offset:9216
  v_mfma_f32_16x16x32_bf16 v[148:151], v[76:79], v[232:235], v[148:151]
  ds_read_b64_tr_b16 v[230:231], v246 offset:13824
  s_waitcnt lgkmcnt(6)
  v_mfma_f32_16x16x32_bf16 v[152:155], v[4:7], v[216:219], v[152:155]
  ds_read_b64_tr_b16 v[232:233], v245 offset:9216
  v_mfma_f32_16x16x32_bf16 v[156:159], v[76:79], v[216:219], v[156:159]
  ds_read_b64_tr_b16 v[234:235], v245 offset:13824
  s_cmp_gt_u32 s28, 2
  s_cbranch_scc1 L_dsk28
  s_add_u32 m0, s98, 34560
  s_add_u32 s37, s99, 858240
  s_mov_b32 exec_lo, 4294967295
  s_mov_b32 exec_hi, 4194303
  s_cmp_lg_u32 s28, 2
  s_cbranch_scc1 L_dpt29
  s_mov_b32 exec_lo, 4294967295
  s_mov_b32 exec_hi, 15
  L_dpt29:
  buffer_load_dwordx4 v248, s[12:15], s37 offen lds
  s_mov_b64 exec, -1
  L_dsk28:
  s_waitcnt lgkmcnt(6)
  v_mfma_f32_16x16x32_bf16 v[160:163], v[4:7], v[220:223], v[160:163]
  ds_read_b64_tr_b16 v[216:217], v245 offset:9248
  v_mfma_f32_16x16x32_bf16 v[164:167], v[76:79], v[220:223], v[164:167]
  ds_read_b64_tr_b16 v[218:219], v245 offset:13856
  s_waitcnt lgkmcnt(6)
  v_mfma_f32_16x16x32_bf16 v[168:171], v[4:7], v[224:227], v[168:171]
  ds_read_b64_tr_b16 v[220:221], v245 offset:9280
  v_mfma_f32_16x16x32_bf16 v[172:175], v[76:79], v[224:227], v[172:175]
  ds_read_b64_tr_b16 v[222:223], v245 offset:13888
  s_add_u32 m0, s98, 36864
  s_add_u32 s37, s99, 444672
  s_mov_b32 exec_lo, 4294967295
  s_mov_b32 exec_hi, 4194303
  buffer_load_dwordx4 v248, s[12:15], s37 offen lds
  s_mov_b64 exec, -1
  s_waitcnt lgkmcnt(6)
  v_mfma_f32_16x16x32_bf16 v[176:179], v[4:7], v[228:231], v[176:179]
  ds_read_b64_tr_b16 v[224:225], v245 offset:9312
  v_mfma_f32_16x16x32_bf16 v[180:183], v[76:79], v[228:231], v[180:183]
  ds_read_b64_tr_b16 v[226:227], v245 offset:13920
  s_waitcnt lgkmcnt(6)
  v_mfma_f32_16x16x32_bf16 v[184:187], v[4:7], v[232:235], v[184:187]
  ds_read_b64_tr_b16 v[228:229], v244 offset:18432
  v_mfma_f32_16x16x32_bf16 v[188:191], v[76:79], v[232:235], v[188:191]
  ds_read_b64_tr_b16 v[230:231], v244 offset:23040
  s_add_u32 m0, s98, 43776
  s_add_u32 s37, s99, 527616
  s_mov_b32 exec_lo, 4294967295
  s_mov_b32 exec_hi, 4194303
  buffer_load_dwordx4 v248, s[12:15], s37 offen lds
  s_mov_b64 exec, -1
  s_waitcnt lgkmcnt(6)
  v_mfma_f32_16x16x32_bf16 v[192:195], v[4:7], v[216:219], v[192:195]
  ds_read_b64_tr_b16 v[232:233], v244 offset:18464
  v_mfma_f32_16x16x32_bf16 v[196:199], v[76:79], v[216:219], v[196:199]
  ds_read_b64_tr_b16 v[234:235], v244 offset:23072
  s_waitcnt lgkmcnt(6)
  v_mfma_f32_16x16x32_bf16 v[200:203], v[4:7], v[220:223], v[200:203]
  ds_read_b64_tr_b16 v[216:217], v244 offset:18496
  v_mfma_f32_16x16x32_bf16 v[204:207], v[76:79], v[220:223], v[204:207]
  ds_read_b64_tr_b16 v[218:219], v244 offset:23104
  s_add_u32 m0, s98, 50688
  s_add_u32 s37, s99, 610560
  s_mov_b32 exec_lo, 4294967295
  s_mov_b32 exec_hi, 4194303
  buffer_load_dwordx4 v248, s[12:15], s37 offen lds
  s_mov_b64 exec, -1
  s_waitcnt lgkmcnt(6)
  v_mfma_f32_16x16x32_bf16 v[208:211], v[4:7], v[224:227], v[208:211]
  ds_read_b64_tr_b16 v[220:221], v244 offset:18528
  v_mfma_f32_16x16x32_bf16 v[212:215], v[76:79], v[224:227], v[212:215]
  ds_read_b64_tr_b16 v[222:223], v244 offset:23136
  s_waitcnt lgkmcnt(6)
  v_mfma_f32_16x16x32_bf16 v[144:147], v[8:11], v[228:231], v[144:147]
  ds_read_b64_tr_b16 v[224:225], v246 offset:18432
  v_mfma_f32_16x16x32_bf16 v[148:151], v[80:83], v[228:231], v[148:151]
  ds_read_b64_tr_b16 v[226:227], v246 offset:23040
  s_add_u32 m0, s98, 57600
  s_add_u32 s37, s99, 693504
  s_mov_b32 exec_lo, 4294967295
  s_mov_b32 exec_hi, 4194303
  buffer_load_dwordx4 v248, s[12:15], s37 offen lds
  s_mov_b64 exec, -1
  s_waitcnt lgkmcnt(6)
  v_mfma_f32_16x16x32_bf16 v[152:155], v[8:11], v[232:235], v[152:155]
  ds_read_b64_tr_b16 v[228:229], v245 offset:18432
  v_mfma_f32_16x16x32_bf16 v[156:159], v[80:83], v[232:235], v[156:159]
  ds_read_b64_tr_b16 v[230:231], v245 offset:23040
  s_waitcnt lgkmcnt(6)
  v_mfma_f32_16x16x32_bf16 v[160:163], v[8:11], v[216:219], v[160:163]
  ds_read_b64_tr_b16 v[232:233], v245 offset:18464
  v_mfma_f32_16x16x32_bf16 v[164:167], v[80:83], v[216:219], v[164:167]
  ds_read_b64_tr_b16 v[234:235], v245 offset:23072
  s_add_u32 m0, s98, 64512
  s_add_u32 s37, s99, 776448
  s_mov_b32 exec_lo, 4294967295
  s_mov_b32 exec_hi, 4194303
  buffer_load_dwordx4 v248, s[12:15], s37 offen lds
  s_mov_b64 exec, -1
  s_waitcnt lgkmcnt(6)
  v_mfma_f32_16x16x32_bf16 v[168:171], v[8:11], v[220:223], v[168:171]
  ds_read_b64_tr_b16 v[216:217], v245 offset:18496
  v_mfma_f32_16x16x32_bf16 v[172:175], v[80:83], v[220:223], v[172:175]
  ds_read_b64_tr_b16 v[218:219], v245 offset:23104
  s_waitcnt lgkmcnt(6)
  v_mfma_f32_16x16x32_bf16 v[176:179], v[8:11], v[224:227], v[176:179]
  ds_read_b64_tr_b16 v[220:221], v245 offset:18528
  v_mfma_f32_16x16x32_bf16 v[180:183], v[80:83], v[224:227], v[180:183]
  ds_read_b64_tr_b16 v[222:223], v245 offset:23136
  s_cmp_gt_u32 s28, 2
  s_cbranch_scc1 L_dsk30
  s_add_u32 m0, s98, 71424
  s_add_u32 s37, s99, 859392
  s_mov_b32 exec_lo, 4294967295
  s_mov_b32 exec_hi, 4194303
  s_cmp_lg_u32 s28, 2
  s_cbranch_scc1 L_dpt31
  s_mov_b32 exec_lo, 4294967295
  s_mov_b32 exec_hi, 15
  L_dpt31:
  buffer_load_dwordx4 v248, s[12:15], s37 offen lds
  s_mov_b64 exec, -1
  L_dsk30:
  s_waitcnt lgkmcnt(6)
  v_mfma_f32_16x16x32_bf16 v[184:187], v[8:11], v[228:231], v[184:187]
  ds_read_b64_tr_b16 v[224:225], v244 offset:27648
  v_mfma_f32_16x16x32_bf16 v[188:191], v[80:83], v[228:231], v[188:191]
  ds_read_b64_tr_b16 v[226:227], v244 offset:32256
  s_waitcnt lgkmcnt(6)
  v_mfma_f32_16x16x32_bf16 v[192:195], v[8:11], v[232:235], v[192:195]
  ds_read_b64_tr_b16 v[228:229], v244 offset:27680
  v_mfma_f32_16x16x32_bf16 v[196:199], v[80:83], v[232:235], v[196:199]
  ds_read_b64_tr_b16 v[230:231], v244 offset:32288
  s_waitcnt lgkmcnt(6)
  v_mfma_f32_16x16x32_bf16 v[200:203], v[8:11], v[216:219], v[200:203]
  ds_read_b64_tr_b16 v[232:233], v244 offset:27712
  v_mfma_f32_16x16x32_bf16 v[204:207], v[80:83], v[216:219], v[204:207]
  ds_read_b64_tr_b16 v[234:235], v244 offset:32320
  s_waitcnt lgkmcnt(6)
  v_mfma_f32_16x16x32_bf16 v[208:211], v[8:11], v[220:223], v[208:211]
  ds_read_b64_tr_b16 v[216:217], v244 offset:27744
  v_mfma_f32_16x16x32_bf16 v[212:215], v[80:83], v[220:223], v[212:215]
  ds_read_b64_tr_b16 v[218:219], v244 offset:32352
  s_waitcnt lgkmcnt(6)
  v_mfma_f32_16x16x32_bf16 v[144:147], v[12:15], v[224:227], v[144:147]
  ds_read_b64_tr_b16 v[220:221], v246 offset:27648
  v_mfma_f32_16x16x32_bf16 v[148:151], v[84:87], v[224:227], v[148:151]
  ds_read_b64_tr_b16 v[222:223], v246 offset:32256
  s_mov_b32 m0, 155648
  s_mov_b32 s37, s4
  buffer_load_dword v236, s[12:15], s37 offen lds
  s_waitcnt lgkmcnt(6)
  v_mfma_f32_16x16x32_bf16 v[152:155], v[12:15], v[228:231], v[152:155]
  ds_read_b64_tr_b16 v[224:225], v245 offset:27648
  v_mfma_f32_16x16x32_bf16 v[156:159], v[84:87], v[228:231], v[156:159]
  ds_read_b64_tr_b16 v[226:227], v245 offset:32256
  s_waitcnt lgkmcnt(6)
  v_mfma_f32_16x16x32_bf16 v[160:163], v[12:15], v[232:235], v[160:163]
  ds_read_b64_tr_b16 v[228:229], v245 offset:27680
  v_mfma_f32_16x16x32_bf16 v[164:167], v[84:87], v[232:235], v[164:167]
  ds_read_b64_tr_b16 v[230:231], v245 offset:32288
  s_waitcnt lgkmcnt(6)
  v_mfma_f32_16x16x32_bf16 v[168:171], v[12:15], v[216:219], v[168:171]
  ds_read_b64_tr_b16 v[232:233], v245 offset:27712
  v_mfma_f32_16x16x32_bf16 v[172:175], v[84:87], v[216:219], v[172:175]
  ds_read_b64_tr_b16 v[234:235], v245 offset:32320
  s_waitcnt lgkmcnt(6)
  v_mfma_f32_16x16x32_bf16 v[176:179], v[12:15], v[220:223], v[176:179]
  ds_read_b64_tr_b16 v[216:217], v245 offset:27744
  v_mfma_f32_16x16x32_bf16 v[180:183], v[84:87], v[220:223], v[180:183]
  ds_read_b64_tr_b16 v[218:219], v245 offset:32352
  s_waitcnt lgkmcnt(0)
  s_waitcnt vmcnt(1)
  s_barrier
  v_add_u32 v244, 4294893568, v244
  v_add_u32 v245, 4294893568, v245
  v_add_u32 v246, 4294893568, v246
  v_mfma_f32_16x16x32_bf16 v[184:187], v[12:15], v[224:227], v[184:187]
  ds_read_b64_tr_b16 v[220:221], v244 offset:0
  v_mfma_f32_16x16x32_bf16 v[188:191], v[84:87], v[224:227], v[188:191]
  ds_read_b64_tr_b16 v[222:223], v244 offset:4608
  s_add_u32 m0, s98, 73728
  s_add_u32 s37, s99, 885888
  s_mov_b32 exec_lo, 4294967295
  s_mov_b32 exec_hi, 4194303
  buffer_load_dwordx4 v248, s[12:15], s37 offen lds
  s_mov_b64 exec, -1
  v_mfma_f32_16x16x32_bf16 v[192:195], v[12:15], v[228:231], v[192:195]
  ds_read_b64_tr_b16 v[224:225], v244 offset:32
  v_mfma_f32_16x16x32_bf16 v[196:199], v[84:87], v[228:231], v[196:199]
  ds_read_b64_tr_b16 v[226:227], v244 offset:4640
  v_mfma_f32_16x16x32_bf16 v[200:203], v[12:15], v[232:235], v[200:203]
  ds_read_b64_tr_b16 v[228:229], v244 offset:64
  v_mfma_f32_16x16x32_bf16 v[204:207], v[84:87], v[232:235], v[204:207]
  ds_read_b64_tr_b16 v[230:231], v244 offset:4672
  s_add_u32 m0, s98, 80640
  s_add_u32 s37, s99, 968832
  s_mov_b32 exec_lo, 4294967295
  s_mov_b32 exec_hi, 4194303
  buffer_load_dwordx4 v248, s[12:15], s37 offen lds
  s_mov_b64 exec, -1
  v_mfma_f32_16x16x32_bf16 v[208:211], v[12:15], v[216:219], v[208:211]
  ds_read_b64_tr_b16 v[232:233], v244 offset:96
  v_mfma_f32_16x16x32_bf16 v[212:215], v[84:87], v[216:219], v[212:215]
  ds_read_b64_tr_b16 v[234:235], v244 offset:4704
  s_waitcnt lgkmcnt(6)
  v_mfma_f32_16x16x32_bf16 v[144:147], v[16:19], v[220:223], v[144:147]
  ds_read_b64_tr_b16 v[216:217], v246 offset:0
  v_mfma_f32_16x16x32_bf16 v[148:151], v[88:91], v[220:223], v[148:151]
  ds_read_b64_tr_b16 v[218:219], v246 offset:4608
  s_add_u32 m0, s98, 87552
  s_add_u32 s37, s99, 1051776
  s_mov_b32 exec_lo, 4294967295
  s_mov_b32 exec_hi, 4194303
  buffer_load_dwordx4 v248, s[12:15], s37 offen lds
  s_mov_b64 exec, -1
  s_waitcnt lgkmcnt(6)
  v_mfma_f32_16x16x32_bf16 v[152:155], v[16:19], v[224:227], v[152:155]
  ds_read_b64_tr_b16 v[220:221], v245 offset:0
  v_mfma_f32_16x16x32_bf16 v[156:159], v[88:91], v[224:227], v[156:159]
  ds_read_b64_tr_b16 v[222:223], v245 offset:4608
  s_waitcnt lgkmcnt(6)
  v_mfma_f32_16x16x32_bf16 v[160:163], v[16:19], v[228:231], v[160:163]
  ds_read_b64_tr_b16 v[224:225], v245 offset:32
  v_mfma_f32_16x16x32_bf16 v[164:167], v[88:91], v[228:231], v[164:167]
  ds_read_b64_tr_b16 v[226:227], v245 offset:4640
  s_add_u32 m0, s98, 94464
  s_add_u32 s37, s99, 1134720
  s_mov_b32 exec_lo, 4294967295
  s_mov_b32 exec_hi, 4194303
  buffer_load_dwordx4 v248, s[12:15], s37 offen lds
  s_mov_b64 exec, -1
  s_waitcnt lgkmcnt(6)
  v_mfma_f32_16x16x32_bf16 v[168:171], v[16:19], v[232:235], v[168:171]
  ds_read_b64_tr_b16 v[228:229], v245 offset:64
  v_mfma_f32_16x16x32_bf16 v[172:175], v[88:91], v[232:235], v[172:175]
  ds_read_b64_tr_b16 v[230:231], v245 offset:4672
  s_waitcnt lgkmcnt(6)
  v_mfma_f32_16x16x32_bf16 v[176:179], v[16:19], v[216:219], v[176:179]
  ds_read_b64_tr_b16 v[232:233], v245 offset:96
  v_mfma_f32_16x16x32_bf16 v[180:183], v[88:91], v[216:219], v[180:183]
  ds_read_b64_tr_b16 v[234:235], v245 offset:4704
  s_add_u32 m0, s98, 101376
  s_add_u32 s37, s99, 1217664
  s_mov_b32 exec_lo, 4294967295
  s_mov_b32 exec_hi, 4194303
  buffer_load_dwordx4 v248, s[12:15], s37 offen lds
  s_mov_b64 exec, -1
  s_waitcnt lgkmcnt(6)
  v_mfma_f32_16x16x32_bf16 v[184:187], v[16:19], v[220:223], v[184:187]
  ds_read_b64_tr_b16 v[216:217], v244 offset:9216
  v_mfma_f32_16x16x32_bf16 v[188:191], v[88:91], v[220:223], v[188:191]
  ds_read_b64_tr_b16 v[218:219], v244 offset:13824
  s_waitcnt lgkmcnt(6)
  v_mfma_f32_16x16x32_bf16 v[192:195], v[16:19], v[224:227], v[192:195]
  ds_read_b64_tr_b16 v[220:221], v244 offset:9248
  v_mfma_f32_16x16x32_bf16 v[196:199], v[88:91], v[224:227], v[196:199]
  ds_read_b64_tr_b16 v[222:223], v244 offset:13856
  s_cmp_gt_u32 s28, 2
  s_cbranch_scc1 L_dsk32
  s_add_u32 m0, s98, 108288
  s_add_u32 s37, s99, 1300608
  s_mov_b32 exec_lo, 4294967295
  s_mov_b32 exec_hi, 4194303
  s_cmp_lg_u32 s28, 2
  s_cbranch_scc1 L_dpt33
  s_mov_b32 exec_lo, 4294967295
  s_mov_b32 exec_hi, 15
  L_dpt33:
  buffer_load_dwordx4 v248, s[12:15], s37 offen lds
  s_mov_b64 exec, -1
  L_dsk32:
  s_waitcnt lgkmcnt(6)
  v_mfma_f32_16x16x32_bf16 v[200:203], v[16:19], v[228:231], v[200:203]
  ds_read_b64_tr_b16 v[224:225], v244 offset:9280
  v_mfma_f32_16x16x32_bf16 v[204:207], v[88:91], v[228:231], v[204:207]
  ds_read_b64_tr_b16 v[226:227], v244 offset:13888
  s_waitcnt lgkmcnt(6)
  v_mfma_f32_16x16x32_bf16 v[208:211], v[16:19], v[232:235], v[208:211]
  ds_read_b64_tr_b16 v[228:229], v244 offset:9312
  v_mfma_f32_16x16x32_bf16 v[212:215], v[88:91], v[232:235], v[212:215]
  ds_read_b64_tr_b16 v[230:231], v244 offset:13920
  s_add_u32 m0, s98, 110592
  s_add_u32 s37, s99, 887040
  s_mov_b32 exec_lo, 4294967295
  s_mov_b32 exec_hi, 4194303
  buffer_load_dwordx4 v248, s[12:15], s37 offen lds
  s_mov_b64 exec, -1
  s_waitcnt lgkmcnt(6)
  v_mfma_f32_16x16x32_bf16 v[144:147], v[20:23], v[216:219], v[144:147]
  ds_read_b64_tr_b16 v[232:233], v246 offset:9216
  v_mfma_f32_16x16x32_bf16 v[148:151], v[92:95], v[216:219], v[148:151]
  ds_read_b64_tr_b16 v[234:235], v246 offset:13824
  s_waitcnt lgkmcnt(6)
  v_mfma_f32_16x16x32_bf16 v[152:155], v[20:23], v[220:223], v[152:155]
  ds_read_b64_tr_b16 v[216:217], v245 offset:9216
  v_mfma_f32_16x16x32_bf16 v[156:159], v[92:95], v[220:223], v[156:159]
  ds_read_b64_tr_b16 v[218:219], v245 offset:13824
  s_add_u32 m0, s98, 117504
  s_add_u32 s37, s99, 969984
  s_mov_b32 exec_lo, 4294967295
  s_mov_b32 exec_hi, 4194303
  buffer_load_dwordx4 v248, s[12:15], s37 offen lds
  s_mov_b64 exec, -1
  s_waitcnt lgkmcnt(6)
  v_mfma_f32_16x16x32_bf16 v[160:163], v[20:23], v[224:227], v[160:163]
  ds_read_b64_tr_b16 v[220:221], v245 offset:9248
  v_mfma_f32_16x16x32_bf16 v[164:167], v[92:95], v[224:227], v[164:167]
  ds_read_b64_tr_b16 v[222:223], v245 offset:13856
  s_waitcnt lgkmcnt(6)
  v_mfma_f32_16x16x32_bf16 v[168:171], v[20:23], v[228:231], v[168:171]
  ds_read_b64_tr_b16 v[224:225], v245 offset:9280
  v_mfma_f32_16x16x32_bf16 v[172:175], v[92:95], v[228:231], v[172:175]
  ds_read_b64_tr_b16 v[226:227], v245 offset:13888
  s_add_u32 m0, s98, 124416
  s_add_u32 s37, s99, 1052928
  s_mov_b32 exec_lo, 4294967295
  s_mov_b32 exec_hi, 4194303
  buffer_load_dwordx4 v248, s[12:15], s37 offen lds
  s_mov_b64 exec, -1
  s_waitcnt lgkmcnt(6)
  v_mfma_f32_16x16x32_bf16 v[176:179], v[20:23], v[232:235], v[176:179]
  ds_read_b64_tr_b16 v[228:229], v245 offset:9312
  v_mfma_f32_16x16x32_bf16 v[180:183], v[92:95], v[232:235], v[180:183]
  ds_read_b64_tr_b16 v[230:231], v245 offset:13920
  s_waitcnt lgkmcnt(6)
  v_mfma_f32_16x16x32_bf16 v[184:187], v[20:23], v[216:219], v[184:187]
  ds_read_b64_tr_b16 v[232:233], v244 offset:18432
  v_mfma_f32_16x16x32_bf16 v[188:191], v[92:95], v[216:219], v[188:191]
  ds_read_b64_tr_b16 v[234:235], v244 offset:23040
  s_add_u32 m0, s98, 131328
  s_add_u32 s37, s99, 1135872
  s_mov_b32 exec_lo, 4294967295
  s_mov_b32 exec_hi, 4194303
  buffer_load_dwordx4 v248, s[12:15], s37 offen lds
  s_mov_b64 exec, -1
  s_waitcnt lgkmcnt(6)
  v_mfma_f32_16x16x32_bf16 v[192:195], v[20:23], v[220:223], v[192:195]
  ds_read_b64_tr_b16 v[216:217], v244 offset:18464
  v_mfma_f32_16x16x32_bf16 v[196:199], v[92:95], v[220:223], v[196:199]
  ds_read_b64_tr_b16 v[218:219], v244 offset:23072
  s_waitcnt lgkmcnt(6)
  v_mfma_f32_16x16x32_bf16 v[200:203], v[20:23], v[224:227], v[200:203]
  ds_read_b64_tr_b16 v[220:221], v244 offset:18496
  v_mfma_f32_16x16x32_bf16 v[204:207], v[92:95], v[224:227], v[204:207]
  ds_read_b64_tr_b16 v[222:223], v244 offset:23104
  s_add_u32 m0, s98, 138240
  s_add_u32 s37, s99, 1218816
  s_mov_b32 exec_lo, 4294967295
  s_mov_b32 exec_hi, 4194303
  buffer_load_dwordx4 v248, s[12:15], s37 offen lds
  s_mov_b64 exec, -1
  s_waitcnt lgkmcnt(6)
  v_mfma_f32_16x16x32_bf16 v[208:211], v[20:23], v[228:231], v[208:211]
  ds_read_b64_tr_b16 v[224:225], v244 offset:18528
  v_mfma_f32_16x16x32_bf16 v[212:215], v[92:95], v[228:231], v[212:215]
  ds_read_b64_tr_b16 v[226:227], v244 offset:23136
  s_waitcnt lgkmcnt(6)
  v_mfma_f32_16x16x32_bf16 v[144:147], v[24:27], v[232:235], v[144:147]
  ds_read_b64_tr_b16 v[228:229], v246 offset:18432
  v_mfma_f32_16x16x32_bf16 v[148:151], v[96:99], v[232:235], v[148:151]
  ds_read_b64_tr_b16 v[230:231], v246 offset:23040
  s_cmp_gt_u32 s28, 2
  s_cbranch_scc1 L_dsk34
  s_add_u32 m0, s98, 145152
  s_add_u32 s37, s99, 1301760
  s_mov_b32 exec_lo, 4294967295
  s_mov_b32 exec_hi, 4194303
  s_cmp_lg_u32 s28, 2
  s_cbranch_scc1 L_dpt35
  s_mov_b32 exec_lo, 4294967295
  s_mov_b32 exec_hi, 15
  L_dpt35:
  buffer_load_dwordx4 v248, s[12:15], s37 offen lds
  s_mov_b64 exec, -1
  L_dsk34:
  s_waitcnt lgkmcnt(6)
  v_mfma_f32_16x16x32_bf16 v[152:155], v[24:27], v[216:219], v[152:155]
  ds_read_b64_tr_b16 v[232:233], v245 offset:18432
  v_mfma_f32_16x16x32_bf16 v[156:159], v[96:99], v[216:219], v[156:159]
  ds_read_b64_tr_b16 v[234:235], v245 offset:23040
  s_waitcnt lgkmcnt(6)
  v_mfma_f32_16x16x32_bf16 v[160:163], v[24:27], v[220:223], v[160:163]
  ds_read_b64_tr_b16 v[216:217], v245 offset:18464
  v_mfma_f32_16x16x32_bf16 v[164:167], v[96:99], v[220:223], v[164:167]
  ds_read_b64_tr_b16 v[218:219], v245 offset:23072
  s_waitcnt lgkmcnt(6)
  v_mfma_f32_16x16x32_bf16 v[168:171], v[24:27], v[224:227], v[168:171]
  ds_read_b64_tr_b16 v[220:221], v245 offset:18496
  v_mfma_f32_16x16x32_bf16 v[172:175], v[96:99], v[224:227], v[172:175]
  ds_read_b64_tr_b16 v[222:223], v245 offset:23104
  s_waitcnt lgkmcnt(6)
  v_mfma_f32_16x16x32_bf16 v[176:179], v[24:27], v[228:231], v[176:179]
  ds_read_b64_tr_b16 v[224:225], v245 offset:18528
  v_mfma_f32_16x16x32_bf16 v[180:183], v[96:99], v[228:231], v[180:183]
  ds_read_b64_tr_b16 v[226:227], v245 offset:23136
  s_waitcnt lgkmcnt(6)
  v_mfma_f32_16x16x32_bf16 v[184:187], v[24:27], v[232:235], v[184:187]
  ds_read_b64_tr_b16 v[228:229], v244 offset:27648
  v_mfma_f32_16x16x32_bf16 v[188:191], v[96:99], v[232:235], v[188:191]
  ds_read_b64_tr_b16 v[230:231], v244 offset:32256
  s_waitcnt lgkmcnt(6)
  v_mfma_f32_16x16x32_bf16 v[192:195], v[24:27], v[216:219], v[192:195]
  ds_read_b64_tr_b16 v[232:233], v244 offset:27680
  v_mfma_f32_16x16x32_bf16 v[196:199], v[96:99], v[216:219], v[196:199]
  ds_read_b64_tr_b16 v[234:235], v244 offset:32288
  s_waitcnt lgkmcnt(6)
  v_mfma_f32_16x16x32_bf16 v[200:203], v[24:27], v[220:223], v[200:203]
  ds_read_b64_tr_b16 v[216:217], v244 offset:27712
  v_mfma_f32_16x16x32_bf16 v[204:207], v[96:99], v[220:223], v[204:207]
  ds_read_b64_tr_b16 v[218:219], v244 offset:32320
  s_waitcnt lgkmcnt(6)
  v_mfma_f32_16x16x32_bf16 v[208:211], v[24:27], v[224:227], v[208:211]
  ds_read_b64_tr_b16 v[220:221], v244 offset:27744
  v_mfma_f32_16x16x32_bf16 v[212:215], v[96:99], v[224:227], v[212:215]
  ds_read_b64_tr_b16 v[222:223], v244 offset:32352
  s_waitcnt lgkmcnt(6)
  v_mfma_f32_16x16x32_bf16 v[144:147], v[28:31], v[228:231], v[144:147]
  ds_read_b64_tr_b16 v[224:225], v246 offset:27648
  v_mfma_f32_16x16x32_bf16 v[148:151], v[100:103], v[228:231], v[148:151]
  ds_read_b64_tr_b16 v[226:227], v246 offset:32256
  s_mov_b32 m0, 155648
  s_mov_b32 s37, s5
  buffer_load_dword v238, s[16:19], s37 offen lds
  s_waitcnt lgkmcnt(6)
  v_mfma_f32_16x16x32_bf16 v[152:155], v[28:31], v[232:235], v[152:155]
  ds_read_b64_tr_b16 v[228:229], v245 offset:27648
  v_mfma_f32_16x16x32_bf16 v[156:159], v[100:103], v[232:235], v[156:159]
  ds_read_b64_tr_b16 v[230:231], v245 offset:32256
  s_waitcnt lgkmcnt(6)
  v_mfma_f32_16x16x32_bf16 v[160:163], v[28:31], v[216:219], v[160:163]
  ds_read_b64_tr_b16 v[232:233], v245 offset:27680
  v_mfma_f32_16x16x32_bf16 v[164:167], v[100:103], v[216:219], v[164:167]
  ds_read_b64_tr_b16 v[234:235], v245 offset:32288
  s_waitcnt lgkmcnt(6)
  v_mfma_f32_16x16x32_bf16 v[168:171], v[28:31], v[220:223], v[168:171]
  ds_read_b64_tr_b16 v[216:217], v245 offset:27712
  v_mfma_f32_16x16x32_bf16 v[172:175], v[100:103], v[220:223], v[172:175]
  ds_read_b64_tr_b16 v[218:219], v245 offset:32320
  s_waitcnt lgkmcnt(6)
  v_mfma_f32_16x16x32_bf16 v[176:179], v[28:31], v[224:227], v[176:179]
  ds_read_b64_tr_b16 v[220:221], v245 offset:27744
  v_mfma_f32_16x16x32_bf16 v[180:183], v[100:103], v[224:227], v[180:183]
  ds_read_b64_tr_b16 v[222:223], v245 offset:32352
  s_waitcnt lgkmcnt(0)
  s_waitcnt vmcnt(1)
  s_barrier
  v_add_u32 v244, 73728, v244
  v_add_u32 v245, 73728, v245
  v_add_u32 v246, 73728, v246
  v_mfma_f32_16x16x32_bf16 v[184:187], v[28:31], v[228:231], v[184:187]
  ds_read_b64_tr_b16 v[224:225], v244 offset:0
  v_mfma_f32_16x16x32_bf16 v[188:191], v[100:103], v[228:231], v[188:191]
  ds_read_b64_tr_b16 v[226:227], v244 offset:4608
  s_add_u32 m0, s98, 0
  s_add_u32 s37, s99, 1328256
  s_mov_b32 exec_lo, 4294967295
  s_mov_b32 exec_hi, 4194303
  buffer_load_dwordx4 v248, s[12:15], s37 offen lds
  s_mov_b64 exec, -1
  v_mfma_f32_16x16x32_bf16 v[192:195], v[28:31], v[232:235], v[192:195]
  ds_read_b64_tr_b16 v[228:229], v244 offset:32
  v_mfma_f32_16x16x32_bf16 v[196:199], v[100:103], v[232:235], v[196:199]
  ds_read_b64_tr_b16 v[230:231], v244 offset:4640
  v_mfma_f32_16x16x32_bf16 v[200:203], v[28:31], v[216:219], v[200:203]
  ds_read_b64_tr_b16 v[232:233], v244 offset:64
  v_mfma_f32_16x16x32_bf16 v[204:207], v[100:103], v[216:219], v[204:207]
  ds_read_b64_tr_b16 v[234:235], v244 offset:4672
  s_add_u32 m0, s98, 6912
  s_add_u32 s37, s99, 1411200
  s_mov_b32 exec_lo, 4294967295
  s_mov_b32 exec_hi, 4194303
  buffer_load_dwordx4 v248, s[12:15], s37 offen lds
  s_mov_b64 exec, -1
  v_mfma_f32_16x16x32_bf16 v[208:211], v[28:31], v[220:223], v[208:211]
  ds_read_b64_tr_b16 v[216:217], v244 offset:96
  v_mfma_f32_16x16x32_bf16 v[212:215], v[100:103], v[220:223], v[212:215]
  ds_read_b64_tr_b16 v[218:219], v244 offset:4704
  s_waitcnt lgkmcnt(6)
  v_mfma_f32_16x16x32_bf16 v[144:147], v[32:35], v[224:227], v[144:147]
  ds_read_b64_tr_b16 v[220:221], v246 offset:0
  v_mfma_f32_16x16x32_bf16 v[148:151], v[104:107], v[224:227], v[148:151]
  ds_read_b64_tr_b16 v[222:223], v246 offset:4608
  s_add_u32 m0, s98, 13824
  s_add_u32 s37, s99, 1494144
  s_mov_b32 exec_lo, 4294967295
  s_mov_b32 exec_hi, 4194303
  buffer_load_dwordx4 v248, s[12:15], s37 offen lds
  s_mov_b64 exec, -1
  s_waitcnt lgkmcnt(6)
  v_mfma_f32_16x16x32_bf16 v[152:155], v[32:35], v[228:231], v[152:155]
  ds_read_b64_tr_b16 v[224:225], v245 offset:0
  v_mfma_f32_16x16x32_bf16 v[156:159], v[104:107], v[228:231], v[156:159]
  ds_read_b64_tr_b16 v[226:227], v245 offset:4608
  s_waitcnt lgkmcnt(6)
  v_mfma_f32_16x16x32_bf16 v[160:163], v[32:35], v[232:235], v[160:163]
  ds_read_b64_tr_b16 v[228:229], v245 offset:32
  v_mfma_f32_16x16x32_bf16 v[164:167], v[104:107], v[232:235], v[164:167]
  ds_read_b64_tr_b16 v[230:231], v245 offset:4640
  s_add_u32 m0, s98, 20736
  s_add_u32 s37, s99, 1577088
  s_mov_b32 exec_lo, 4294967295
  s_mov_b32 exec_hi, 4194303
  buffer_load_dwordx4 v248, s[12:15], s37 offen lds
  s_mov_b64 exec, -1
  s_waitcnt lgkmcnt(6)
  v_mfma_f32_16x16x32_bf16 v[168:171], v[32:35], v[216:219], v[168:171]
  ds_read_b64_tr_b16 v[232:233], v245 offset:64
  v_mfma_f32_16x16x32_bf16 v[172:175], v[104:107], v[216:219], v[172:175]
  ds_read_b64_tr_b16 v[234:235], v245 offset:4672
  s_waitcnt lgkmcnt(6)
  v_mfma_f32_16x16x32_bf16 v[176:179], v[32:35], v[220:223], v[176:179]
  ds_read_b64_tr_b16 v[216:217], v245 offset:96
  v_mfma_f32_16x16x32_bf16 v[180:183], v[104:107], v[220:223], v[180:183]
  ds_read_b64_tr_b16 v[218:219], v245 offset:4704
  s_add_u32 m0, s98, 27648
  s_add_u32 s37, s99, 1660032
  s_mov_b32 exec_lo, 4294967295
  s_mov_b32 exec_hi, 4194303
  buffer_load_dwordx4 v248, s[12:15], s37 offen lds
  s_mov_b64 exec, -1
  s_waitcnt lgkmcnt(6)
  v_mfma_f32_16x16x32_bf16 v[184:187], v[32:35], v[224:227], v[184:187]
  ds_read_b64_tr_b16 v[220:221], v244 offset:9216
  v_mfma_f32_16x16x32_bf16 v[188:191], v[104:107], v[224:227], v[188:191]
  ds_read_b64_tr_b16 v[222:223], v244 offset:13824
  s_waitcnt lgkmcnt(6)
  v_mfma_f32_16x16x32_bf16 v[192:195], v[32:35], v[228:231], v[192:195]
  ds_read_b64_tr_b16 v[224:225], v244 offset:9248
  v_mfma_f32_16x16x32_bf16 v[196:199], v[104:107], v[228:231], v[196:199]
  ds_read_b64_tr_b16 v[226:227], v244 offset:13856
  s_cmp_gt_u32 s28, 2
  s_cbranch_scc1 L_dsk36
  s_add_u32 m0, s98, 34560
  s_add_u32 s37, s99, 1742976
  s_mov_b32 exec_lo, 4294967295
  s_mov_b32 exec_hi, 4194303
  s_cmp_lg_u32 s28, 2
  s_cbranch_scc1 L_dpt37
  s_mov_b32 exec_lo, 4294967295
  s_mov_b32 exec_hi, 15
  L_dpt37:
  buffer_load_dwordx4 v248, s[12:15], s37 offen lds
  s_mov_b64 exec, -1
  L_dsk36:
  s_waitcnt lgkmcnt(6)
  v_mfma_f32_16x16x32_bf16 v[200:203], v[32:35], v[232:235], v[200:203]
  ds_read_b64_tr_b16 v[228:229], v244 offset:9280
  v_mfma_f32_16x16x32_bf16 v[204:207], v[104:107], v[232:235], v[204:207]
  ds_read_b64_tr_b16 v[230:231], v244 offset:13888
  s_waitcnt lgkmcnt(6)
  v_mfma_f32_16x16x32_bf16 v[208:211], v[32:35], v[216:219], v[208:211]
  ds_read_b64_tr_b16 v[232:233], v244 offset:9312
  v_mfma_f32_16x16x32_bf16 v[212:215], v[104:107], v[216:219], v[212:215]
  ds_read_b64_tr_b16 v[234:235], v244 offset:13920
  s_add_u32 m0, s98, 36864
  s_add_u32 s37, s99, 1329408
  s_mov_b32 exec_lo, 4294967295
  s_mov_b32 exec_hi, 4194303
  buffer_load_dwordx4 v248, s[12:15], s37 offen lds
  s_mov_b64 exec, -1
  s_waitcnt lgkmcnt(6)
  v_mfma_f32_16x16x32_bf16 v[144:147], v[36:39], v[220:223], v[144:147]
  ds_read_b64_tr_b16 v[216:217], v246 offset:9216
  v_mfma_f32_16x16x32_bf16 v[148:151], v[108:111], v[220:223], v[148:151]
  ds_read_b64_tr_b16 v[218:219], v246 offset:13824
  s_waitcnt lgkmcnt(6)
  v_mfma_f32_16x16x32_bf16 v[152:155], v[36:39], v[224:227], v[152:155]
  ds_read_b64_tr_b16 v[220:221], v245 offset:9216
  v_mfma_f32_16x16x32_bf16 v[156:159], v[108:111], v[224:227], v[156:159]
  ds_read_b64_tr_b16 v[222:223], v245 offset:13824
  s_add_u32 m0, s98, 43776
  s_add_u32 s37, s99, 1412352
  s_mov_b32 exec_lo, 4294967295
  s_mov_b32 exec_hi, 4194303
  buffer_load_dwordx4 v248, s[12:15], s37 offen lds
  s_mov_b64 exec, -1
  s_waitcnt lgkmcnt(6)
  v_mfma_f32_16x16x32_bf16 v[160:163], v[36:39], v[228:231], v[160:163]
  ds_read_b64_tr_b16 v[224:225], v245 offset:9248
  v_mfma_f32_16x16x32_bf16 v[164:167], v[108:111], v[228:231], v[164:167]
  ds_read_b64_tr_b16 v[226:227], v245 offset:13856
  s_waitcnt lgkmcnt(6)
  v_mfma_f32_16x16x32_bf16 v[168:171], v[36:39], v[232:235], v[168:171]
  ds_read_b64_tr_b16 v[228:229], v245 offset:9280
  v_mfma_f32_16x16x32_bf16 v[172:175], v[108:111], v[232:235], v[172:175]
  ds_read_b64_tr_b16 v[230:231], v245 offset:13888
  s_add_u32 m0, s98, 50688
  s_add_u32 s37, s99, 1495296
  s_mov_b32 exec_lo, 4294967295
  s_mov_b32 exec_hi, 4194303
  buffer_load_dwordx4 v248, s[12:15], s37 offen lds
  s_mov_b64 exec, -1
  s_waitcnt lgkmcnt(6)
  v_mfma_f32_16x16x32_bf16 v[176:179], v[36:39], v[216:219], v[176:179]
  ds_read_b64_tr_b16 v[232:233], v245 offset:9312
  v_mfma_f32_16x16x32_bf16 v[180:183], v[108:111], v[216:219], v[180:183]
  ds_read_b64_tr_b16 v[234:235], v245 offset:13920
  s_waitcnt lgkmcnt(6)
  v_mfma_f32_16x16x32_bf16 v[184:187], v[36:39], v[220:223], v[184:187]
  ds_read_b64_tr_b16 v[216:217], v244 offset:18432
  v_mfma_f32_16x16x32_bf16 v[188:191], v[108:111], v[220:223], v[188:191]
  ds_read_b64_tr_b16 v[218:219], v244 offset:23040
  s_add_u32 m0, s98, 57600
  s_add_u32 s37, s99, 1578240
  s_mov_b32 exec_lo, 4294967295
  s_mov_b32 exec_hi, 4194303
  buffer_load_dwordx4 v248, s[12:15], s37 offen lds
  s_mov_b64 exec, -1
  s_waitcnt lgkmcnt(6)
  v_mfma_f32_16x16x32_bf16 v[192:195], v[36:39], v[224:227], v[192:195]
  ds_read_b64_tr_b16 v[220:221], v244 offset:18464
  v_mfma_f32_16x16x32_bf16 v[196:199], v[108:111], v[224:227], v[196:199]
  ds_read_b64_tr_b16 v[222:223], v244 offset:23072
  s_waitcnt lgkmcnt(6)
  v_mfma_f32_16x16x32_bf16 v[200:203], v[36:39], v[228:231], v[200:203]
  ds_read_b64_tr_b16 v[224:225], v244 offset:18496
  v_mfma_f32_16x16x32_bf16 v[204:207], v[108:111], v[228:231], v[204:207]
  ds_read_b64_tr_b16 v[226:227], v244 offset:23104
  s_add_u32 m0, s98, 64512
  s_add_u32 s37, s99, 1661184
  s_mov_b32 exec_lo, 4294967295
  s_mov_b32 exec_hi, 4194303
  buffer_load_dwordx4 v248, s[12:15], s37 offen lds
  s_mov_b64 exec, -1
  s_waitcnt lgkmcnt(6)
  v_mfma_f32_16x16x32_bf16 v[208:211], v[36:39], v[232:235], v[208:211]
  ds_read_b64_tr_b16 v[228:229], v244 offset:18528
  v_mfma_f32_16x16x32_bf16 v[212:215], v[108:111], v[232:235], v[212:215]
  ds_read_b64_tr_b16 v[230:231], v244 offset:23136
  s_waitcnt lgkmcnt(6)
  v_mfma_f32_16x16x32_bf16 v[144:147], v[40:43], v[216:219], v[144:147]
  ds_read_b64_tr_b16 v[232:233], v246 offset:18432
  v_mfma_f32_16x16x32_bf16 v[148:151], v[112:115], v[216:219], v[148:151]
  ds_read_b64_tr_b16 v[234:235], v246 offset:23040
  s_cmp_gt_u32 s28, 2
  s_cbranch_scc1 L_dsk38
  s_add_u32 m0, s98, 71424
  s_add_u32 s37, s99, 1744128
  s_mov_b32 exec_lo, 4294967295
  s_mov_b32 exec_hi, 4194303
  s_cmp_lg_u32 s28, 2
  s_cbranch_scc1 L_dpt39
  s_mov_b32 exec_lo, 4294967295
  s_mov_b32 exec_hi, 15
  L_dpt39:
  buffer_load_dwordx4 v248, s[12:15], s37 offen lds
  s_mov_b64 exec, -1
  L_dsk38:
  s_waitcnt lgkmcnt(6)
  v_mfma_f32_16x16x32_bf16 v[152:155], v[40:43], v[220:223], v[152:155]
  ds_read_b64_tr_b16 v[216:217], v245 offset:18432
  v_mfma_f32_16x16x32_bf16 v[156:159], v[112:115], v[220:223], v[156:159]
  ds_read_b64_tr_b16 v[218:219], v245 offset:23040
  s_waitcnt lgkmcnt(6)
  v_mfma_f32_16x16x32_bf16 v[160:163], v[40:43], v[224:227], v[160:163]
  ds_read_b64_tr_b16 v[220:221], v245 offset:18464
  v_mfma_f32_16x16x32_bf16 v[164:167], v[112:115], v[224:227], v[164:167]
  ds_read_b64_tr_b16 v[222:223], v245 offset:23072
  s_waitcnt lgkmcnt(6)
  v_mfma_f32_16x16x32_bf16 v[168:171], v[40:43], v[228:231], v[168:171]
  ds_read_b64_tr_b16 v[224:225], v245 offset:18496
  v_mfma_f32_16x16x32_bf16 v[172:175], v[112:115], v[228:231], v[172:175]
  ds_read_b64_tr_b16 v[226:227], v245 offset:23104
  s_waitcnt lgkmcnt(6)
  v_mfma_f32_16x16x32_bf16 v[176:179], v[40:43], v[232:235], v[176:179]
  ds_read_b64_tr_b16 v[228:229], v245 offset:18528
  v_mfma_f32_16x16x32_bf16 v[180:183], v[112:115], v[232:235], v[180:183]
  ds_read_b64_tr_b16 v[230:231], v245 offset:23136
  s_waitcnt lgkmcnt(6)
  v_mfma_f32_16x16x32_bf16 v[184:187], v[40:43], v[216:219], v[184:187]
  ds_read_b64_tr_b16 v[232:233], v244 offset:27648
  v_mfma_f32_16x16x32_bf16 v[188:191], v[112:115], v[216:219], v[188:191]
  ds_read_b64_tr_b16 v[234:235], v244 offset:32256
  s_waitcnt lgkmcnt(6)
  v_mfma_f32_16x16x32_bf16 v[192:195], v[40:43], v[220:223], v[192:195]
  ds_read_b64_tr_b16 v[216:217], v244 offset:27680
  v_mfma_f32_16x16x32_bf16 v[196:199], v[112:115], v[220:223], v[196:199]
  ds_read_b64_tr_b16 v[218:219], v244 offset:32288
  s_waitcnt lgkmcnt(6)
  v_mfma_f32_16x16x32_bf16 v[200:203], v[40:43], v[224:227], v[200:203]
  ds_read_b64_tr_b16 v[220:221], v244 offset:27712
  v_mfma_f32_16x16x32_bf16 v[204:207], v[112:115], v[224:227], v[204:207]
  ds_read_b64_tr_b16 v[222:223], v244 offset:32320
  s_waitcnt lgkmcnt(6)
  v_mfma_f32_16x16x32_bf16 v[208:211], v[40:43], v[228:231], v[208:211]
  ds_read_b64_tr_b16 v[224:225], v244 offset:27744
  v_mfma_f32_16x16x32_bf16 v[212:215], v[112:115], v[228:231], v[212:215]
  ds_read_b64_tr_b16 v[226:227], v244 offset:32352
  s_waitcnt lgkmcnt(6)
  v_mfma_f32_16x16x32_bf16 v[144:147], v[44:47], v[232:235], v[144:147]
  ds_read_b64_tr_b16 v[228:229], v246 offset:27648
  v_mfma_f32_16x16x32_bf16 v[148:151], v[116:119], v[232:235], v[148:151]
  ds_read_b64_tr_b16 v[230:231], v246 offset:32256
  s_waitcnt lgkmcnt(6)
  v_mfma_f32_16x16x32_bf16 v[152:155], v[44:47], v[216:219], v[152:155]
  ds_read_b64_tr_b16 v[232:233], v245 offset:27648
  v_mfma_f32_16x16x32_bf16 v[156:159], v[116:119], v[216:219], v[156:159]
  ds_read_b64_tr_b16 v[234:235], v245 offset:32256
  s_waitcnt lgkmcnt(6)
  v_mfma_f32_16x16x32_bf16 v[160:163], v[44:47], v[220:223], v[160:163]
  ds_read_b64_tr_b16 v[216:217], v245 offset:27680
  v_mfma_f32_16x16x32_bf16 v[164:167], v[116:119], v[220:223], v[164:167]
  ds_read_b64_tr_b16 v[218:219], v245 offset:32288
  s_waitcnt lgkmcnt(6)
  v_mfma_f32_16x16x32_bf16 v[168:171], v[44:47], v[224:227], v[168:171]
  ds_read_b64_tr_b16 v[220:221], v245 offset:27712
  v_mfma_f32_16x16x32_bf16 v[172:175], v[116:119], v[224:227], v[172:175]
  ds_read_b64_tr_b16 v[222:223], v245 offset:32320
  s_waitcnt lgkmcnt(6)
  v_mfma_f32_16x16x32_bf16 v[176:179], v[44:47], v[228:231], v[176:179]
  ds_read_b64_tr_b16 v[224:225], v245 offset:27744
  v_mfma_f32_16x16x32_bf16 v[180:183], v[116:119], v[228:231], v[180:183]
  ds_read_b64_tr_b16 v[226:227], v245 offset:32352
  s_waitcnt lgkmcnt(0)
  s_waitcnt vmcnt(0)
  s_barrier
  v_add_u32 v244, 4294893568, v244
  v_add_u32 v245, 4294893568, v245
  v_add_u32 v246, 4294893568, v246
  v_mfma_f32_16x16x32_bf16 v[184:187], v[44:47], v[232:235], v[184:187]
  ds_read_b64_tr_b16 v[228:229], v244 offset:0
  v_mfma_f32_16x16x32_bf16 v[188:191], v[116:119], v[232:235], v[188:191]
  ds_read_b64_tr_b16 v[230:231], v244 offset:4608
  s_add_u32 m0, s98, 73728
  s_add_u32 s37, s99, 1770624
  s_mov_b32 exec_lo, 4294967295
  s_mov_b32 exec_hi, 4194303
  buffer_load_dwordx4 v248, s[12:15], s37 offen lds
  s_mov_b64 exec, -1
  v_mfma_f32_16x16x32_bf16 v[192:195], v[44:47], v[216:219], v[192:195]
  ds_read_b64_tr_b16 v[232:233], v244 offset:32
  v_mfma_f32_16x16x32_bf16 v[196:199], v[116:119], v[216:219], v[196:199]
  ds_read_b64_tr_b16 v[234:235], v244 offset:4640
  v_mfma_f32_16x16x32_bf16 v[200:203], v[44:47], v[220:223], v[200:203]
  ds_read_b64_tr_b16 v[216:217], v244 offset:64
  v_mfma_f32_16x16x32_bf16 v[204:207], v[116:119], v[220:223], v[204:207]
  ds_read_b64_tr_b16 v[218:219], v244 offset:4672
  s_add_u32 m0, s98, 80640
  s_add_u32 s37, s99, 1853568
  s_mov_b32 exec_lo, 4294967295
  s_mov_b32 exec_hi, 4194303
  buffer_load_dwordx4 v248, s[12:15], s37 offen lds
  s_mov_b64 exec, -1
  v_mfma_f32_16x16x32_bf16 v[208:211], v[44:47], v[224:227], v[208:211]
  ds_read_b64_tr_b16 v[220:221], v244 offset:96
  v_mfma_f32_16x16x32_bf16 v[212:215], v[116:119], v[224:227], v[212:215]
  ds_read_b64_tr_b16 v[222:223], v244 offset:4704
  s_waitcnt lgkmcnt(6)
  v_mfma_f32_16x16x32_bf16 v[144:147], v[48:51], v[228:231], v[144:147]
  ds_read_b64_tr_b16 v[224:225], v246 offset:0
  v_mfma_f32_16x16x32_bf16 v[148:151], v[120:123], v[228:231], v[148:151]
  ds_read_b64_tr_b16 v[226:227], v246 offset:4608
  s_cmp_gt_u32 s28, 5
  s_cbranch_scc1 L_dsk40
  s_add_u32 m0, s98, 87552
  s_add_u32 s37, s99, 1936512
  s_mov_b32 exec_lo, 4294967295
  s_mov_b32 exec_hi, 4194303
  s_cmp_lg_u32 s28, 5
  s_cbranch_scc1 L_dpt41
  s_mov_b32 exec_lo, 262143
  s_mov_b32 exec_hi, 0
  L_dpt41:
  buffer_load_dwordx4 v248, s[12:15], s37 offen lds
  s_mov_b64 exec, -1
  L_dsk40:
  s_waitcnt lgkmcnt(6)
  v_mfma_f32_16x16x32_bf16 v[152:155], v[48:51], v[232:235], v[152:155]
  ds_read_b64_tr_b16 v[228:229], v245 offset:0
  v_mfma_f32_16x16x32_bf16 v[156:159], v[120:123], v[232:235], v[156:159]
  ds_read_b64_tr_b16 v[230:231], v245 offset:4608
  s_waitcnt lgkmcnt(6)
  v_mfma_f32_16x16x32_bf16 v[160:163], v[48:51], v[216:219], v[160:163]
  ds_read_b64_tr_b16 v[232:233], v245 offset:32
  v_mfma_f32_16x16x32_bf16 v[164:167], v[120:123], v[216:219], v[164:167]
  ds_read_b64_tr_b16 v[234:235], v245 offset:4640
  s_add_u32 m0, s98, 110592
  s_add_u32 s37, s99, 1771776
  s_mov_b32 exec_lo, 4294967295
  s_mov_b32 exec_hi, 4194303
  buffer_load_dwordx4 v248, s[12:15], s37 offen lds
  s_mov_b64 exec, -1
  s_waitcnt lgkmcnt(6)
  v_mfma_f32_16x16x32_bf16 v[168:171], v[48:51], v[220:223], v[168:171]
  ds_read_b64_tr_b16 v[216:217], v245 offset:64
  v_mfma_f32_16x16x32_bf16 v[172:175], v[120:123], v[220:223], v[172:175]
  ds_read_b64_tr_b16 v[218:219], v245 offset:4672
  s_waitcnt lgkmcnt(6)
  v_mfma_f32_16x16x32_bf16 v[176:179], v[48:51], v[224:227], v[176:179]
  ds_read_b64_tr_b16 v[220:221], v245 offset:96
  v_mfma_f32_16x16x32_bf16 v[180:183], v[120:123], v[224:227], v[180:183]
  ds_read_b64_tr_b16 v[222:223], v245 offset:4704
  s_add_u32 m0, s98, 117504
  s_add_u32 s37, s99, 1854720
  s_mov_b32 exec_lo, 4294967295
  s_mov_b32 exec_hi, 4194303
  buffer_load_dwordx4 v248, s[12:15], s37 offen lds
  s_mov_b64 exec, -1
  s_waitcnt lgkmcnt(6)
  v_mfma_f32_16x16x32_bf16 v[184:187], v[48:51], v[228:231], v[184:187]
  ds_read_b64_tr_b16 v[224:225], v244 offset:9216
  s_cmp_lg_u32 s28, 0
  s_cbranch_scc1 L_pw44
  v_mov_b32 v243, 0
  buffer_load_dword v243, v243, s[48:51], s45 offen sc1
  L_pw44:
  v_mfma_f32_16x16x32_bf16 v[188:191], v[120:123], v[228:231], v[188:191]
  ds_read_b64_tr_b16 v[226:227], v244 offset:13824
  s_waitcnt lgkmcnt(6)
  v_mfma_f32_16x16x32_bf16 v[192:195], v[48:51], v[232:235], v[192:195]
  ds_read_b64_tr_b16 v[228:229], v244 offset:9248
  v_mfma_f32_16x16x32_bf16 v[196:199], v[120:123], v[232:235], v[196:199]
  ds_read_b64_tr_b16 v[230:231], v244 offset:13856
  s_cmp_gt_u32 s28, 5
  s_cbranch_scc1 L_dsk42
  s_add_u32 m0, s98, 124416
  s_add_u32 s37, s99, 1937664
  s_mov_b32 exec_lo, 4294967295
  s_mov_b32 exec_hi, 4194303
  s_cmp_lg_u32 s28, 5
  s_cbranch_scc1 L_dpt43
  s_mov_b32 exec_lo, 262143
  s_mov_b32 exec_hi, 0
  L_dpt43:
  buffer_load_dwordx4 v248, s[12:15], s37 offen lds
  s_mov_b64 exec, -1
  L_dsk42:
  s_waitcnt lgkmcnt(6)
  v_mfma_f32_16x16x32_bf16 v[200:203], v[48:51], v[216:219], v[200:203]
  ds_read_b64_tr_b16 v[232:233], v244 offset:9280
  v_mfma_f32_16x16x32_bf16 v[204:207], v[120:123], v[216:219], v[204:207]
  ds_read_b64_tr_b16 v[234:235], v244 offset:13888
  s_waitcnt lgkmcnt(6)
  v_mfma_f32_16x16x32_bf16 v[208:211], v[48:51], v[220:223], v[208:211]
  ds_read_b64_tr_b16 v[216:217], v244 offset:9312
  v_mfma_f32_16x16x32_bf16 v[212:215], v[120:123], v[220:223], v[212:215]
  ds_read_b64_tr_b16 v[218:219], v244 offset:13920
  s_waitcnt lgkmcnt(6)
  v_mfma_f32_16x16x32_bf16 v[144:147], v[52:55], v[224:227], v[144:147]
  ds_read_b64_tr_b16 v[220:221], v246 offset:9216
  v_mfma_f32_16x16x32_bf16 v[148:151], v[124:127], v[224:227], v[148:151]
  ds_read_b64_tr_b16 v[222:223], v246 offset:13824
  s_waitcnt lgkmcnt(6)
  v_mfma_f32_16x16x32_bf16 v[152:155], v[52:55], v[228:231], v[152:155]
  ds_read_b64_tr_b16 v[224:225], v245 offset:9216
  v_mfma_f32_16x16x32_bf16 v[156:159], v[124:127], v[228:231], v[156:159]
  ds_read_b64_tr_b16 v[226:227], v245 offset:13824
  s_waitcnt lgkmcnt(6)
  v_mfma_f32_16x16x32_bf16 v[160:163], v[52:55], v[232:235], v[160:163]
  ds_read_b64_tr_b16 v[228:229], v245 offset:9248
  v_mfma_f32_16x16x32_bf16 v[164:167], v[124:127], v[232:235], v[164:167]
  ds_read_b64_tr_b16 v[230:231], v245 offset:13856
  s_waitcnt lgkmcnt(6)
  v_mfma_f32_16x16x32_bf16 v[168:171], v[52:55], v[216:219], v[168:171]
  ds_read_b64_tr_b16 v[232:233], v245 offset:9280
  v_mfma_f32_16x16x32_bf16 v[172:175], v[124:127], v[216:219], v[172:175]
  ds_read_b64_tr_b16 v[234:235], v245 offset:13888
  s_waitcnt lgkmcnt(6)
  v_mfma_f32_16x16x32_bf16 v[176:179], v[52:55], v[220:223], v[176:179]
  ds_read_b64_tr_b16 v[216:217], v245 offset:9312
  v_mfma_f32_16x16x32_bf16 v[180:183], v[124:127], v[220:223], v[180:183]
  ds_read_b64_tr_b16 v[218:219], v245 offset:13920
  s_waitcnt lgkmcnt(6)
  v_mfma_f32_16x16x32_bf16 v[184:187], v[52:55], v[224:227], v[184:187]
  ds_read_b64_tr_b16 v[220:221], v244 offset:18432
  v_mfma_f32_16x16x32_bf16 v[188:191], v[124:127], v[224:227], v[188:191]
  ds_read_b64_tr_b16 v[222:223], v244 offset:23040
  s_waitcnt lgkmcnt(6)
  v_mfma_f32_16x16x32_bf16 v[192:195], v[52:55], v[228:231], v[192:195]
  ds_read_b64_tr_b16 v[224:225], v244 offset:18464
  v_mfma_f32_16x16x32_bf16 v[196:199], v[124:127], v[228:231], v[196:199]
  ds_read_b64_tr_b16 v[226:227], v244 offset:23072
  s_waitcnt lgkmcnt(6)
  v_mfma_f32_16x16x32_bf16 v[200:203], v[52:55], v[232:235], v[200:203]
  ds_read_b64_tr_b16 v[228:229], v244 offset:18496
  v_mfma_f32_16x16x32_bf16 v[204:207], v[124:127], v[232:235], v[204:207]
  ds_read_b64_tr_b16 v[230:231], v244 offset:23104
  s_waitcnt lgkmcnt(6)
  v_mfma_f32_16x16x32_bf16 v[208:211], v[52:55], v[216:219], v[208:211]
  ds_read_b64_tr_b16 v[232:233], v244 offset:18528
  v_mfma_f32_16x16x32_bf16 v[212:215], v[124:127], v[216:219], v[212:215]
  ds_read_b64_tr_b16 v[234:235], v244 offset:23136
  s_waitcnt lgkmcnt(6)
  v_mfma_f32_16x16x32_bf16 v[144:147], v[56:59], v[220:223], v[144:147]
  ds_read_b64_tr_b16 v[216:217], v246 offset:18432
  v_mfma_f32_16x16x32_bf16 v[148:151], v[128:131], v[220:223], v[148:151]
  ds_read_b64_tr_b16 v[218:219], v246 offset:23040
  s_waitcnt lgkmcnt(6)
  v_mfma_f32_16x16x32_bf16 v[152:155], v[56:59], v[224:227], v[152:155]
  ds_read_b64_tr_b16 v[220:221], v245 offset:18432
  v_mfma_f32_16x16x32_bf16 v[156:159], v[128:131], v[224:227], v[156:159]
  ds_read_b64_tr_b16 v[222:223], v245 offset:23040
  s_waitcnt lgkmcnt(6)
  v_mfma_f32_16x16x32_bf16 v[160:163], v[56:59], v[228:231], v[160:163]
  ds_read_b64_tr_b16 v[224:225], v245 offset:18464
  v_mfma_f32_16x16x32_bf16 v[164:167], v[128:131], v[228:231], v[164:167]
  ds_read_b64_tr_b16 v[226:227], v245 offset:23072
  s_waitcnt lgkmcnt(6)
  v_mfma_f32_16x16x32_bf16 v[168:171], v[56:59], v[232:235], v[168:171]
  ds_read_b64_tr_b16 v[228:229], v245 offset:18496
  v_mfma_f32_16x16x32_bf16 v[172:175], v[128:131], v[232:235], v[172:175]
  ds_read_b64_tr_b16 v[230:231], v245 offset:23104
  s_waitcnt lgkmcnt(6)
  v_mfma_f32_16x16x32_bf16 v[176:179], v[56:59], v[216:219], v[176:179]
  ds_read_b64_tr_b16 v[232:233], v245 offset:18528
  v_mfma_f32_16x16x32_bf16 v[180:183], v[128:131], v[216:219], v[180:183]
  ds_read_b64_tr_b16 v[234:235], v245 offset:23136
  s_waitcnt lgkmcnt(6)
  v_mfma_f32_16x16x32_bf16 v[184:187], v[56:59], v[220:223], v[184:187]
  ds_read_b64_tr_b16 v[216:217], v244 offset:27648
  v_mfma_f32_16x16x32_bf16 v[188:191], v[128:131], v[220:223], v[188:191]
  ds_read_b64_tr_b16 v[218:219], v244 offset:32256
  s_waitcnt lgkmcnt(6)
  v_mfma_f32_16x16x32_bf16 v[192:195], v[56:59], v[224:227], v[192:195]
  ds_read_b64_tr_b16 v[220:221], v244 offset:27680
  v_mfma_f32_16x16x32_bf16 v[196:199], v[128:131], v[224:227], v[196:199]
  ds_read_b64_tr_b16 v[222:223], v244 offset:32288
  s_waitcnt lgkmcnt(6)
  v_mfma_f32_16x16x32_bf16 v[200:203], v[56:59], v[228:231], v[200:203]
  ds_read_b64_tr_b16 v[224:225], v244 offset:27712
  v_mfma_f32_16x16x32_bf16 v[204:207], v[128:131], v[228:231], v[204:207]
  ds_read_b64_tr_b16 v[226:227], v244 offset:32320
  s_waitcnt lgkmcnt(6)
  v_mfma_f32_16x16x32_bf16 v[208:211], v[56:59], v[232:235], v[208:211]
  ds_read_b64_tr_b16 v[228:229], v244 offset:27744
  v_mfma_f32_16x16x32_bf16 v[212:215], v[128:131], v[232:235], v[212:215]
  ds_read_b64_tr_b16 v[230:231], v244 offset:32352
  s_waitcnt lgkmcnt(6)
  v_mfma_f32_16x16x32_bf16 v[144:147], v[60:63], v[216:219], v[144:147]
  ds_read_b64_tr_b16 v[232:233], v246 offset:27648
  v_mfma_f32_16x16x32_bf16 v[148:151], v[132:135], v[216:219], v[148:151]
  ds_read_b64_tr_b16 v[234:235], v246 offset:32256
  s_waitcnt lgkmcnt(6)
  v_mfma_f32_16x16x32_bf16 v[152:155], v[60:63], v[220:223], v[152:155]
  ds_read_b64_tr_b16 v[216:217], v245 offset:27648
  v_mfma_f32_16x16x32_bf16 v[156:159], v[132:135], v[220:223], v[156:159]
  ds_read_b64_tr_b16 v[218:219], v245 offset:32256
  s_waitcnt lgkmcnt(6)
  v_mfma_f32_16x16x32_bf16 v[160:163], v[60:63], v[224:227], v[160:163]
  ds_read_b64_tr_b16 v[220:221], v245 offset:27680
  v_mfma_f32_16x16x32_bf16 v[164:167], v[132:135], v[224:227], v[164:167]
  ds_read_b64_tr_b16 v[222:223], v245 offset:32288
  s_waitcnt lgkmcnt(6)
  v_mfma_f32_16x16x32_bf16 v[168:171], v[60:63], v[228:231], v[168:171]
  ds_read_b64_tr_b16 v[224:225], v245 offset:27712
  v_mfma_f32_16x16x32_bf16 v[172:175], v[132:135], v[228:231], v[172:175]
  ds_read_b64_tr_b16 v[226:227], v245 offset:32320
  s_waitcnt lgkmcnt(6)
  v_mfma_f32_16x16x32_bf16 v[176:179], v[60:63], v[232:235], v[176:179]
  ds_read_b64_tr_b16 v[228:229], v245 offset:27744
  v_mfma_f32_16x16x32_bf16 v[180:183], v[132:135], v[232:235], v[180:183]
  ds_read_b64_tr_b16 v[230:231], v245 offset:32352
  s_waitcnt lgkmcnt(0)
  s_waitcnt vmcnt(0)
  s_barrier
  v_add_u32 v244, 73728, v244
  v_add_u32 v245, 73728, v245
  v_add_u32 v246, 73728, v246
  v_mfma_f32_16x16x32_bf16 v[184:187], v[60:63], v[216:219], v[184:187]
  ds_read_b64_tr_b16 v[232:233], v244 offset:0
  v_mfma_f32_16x16x32_bf16 v[188:191], v[132:135], v[216:219], v[188:191]
  ds_read_b64_tr_b16 v[234:235], v244 offset:4608
  s_add_u32 m0, s98, 0
  s_add_u32 s37, s99, 0
  s_mov_b32 exec_lo, 4294967295
  s_mov_b32 exec_hi, 4194303
  buffer_load_dwordx4 v248, s[12:15], s37 offen lds
  s_mov_b64 exec, -1
  v_mfma_f32_16x16x32_bf16 v[192:195], v[60:63], v[220:223], v[192:195]
  ds_read_b64_tr_b16 v[216:217], v244 offset:32
  v_mfma_f32_16x16x32_bf16 v[196:199], v[132:135], v[220:223], v[196:199]
  ds_read_b64_tr_b16 v[218:219], v244 offset:4640
  v_mfma_f32_16x16x32_bf16 v[200:203], v[60:63], v[224:227], v[200:203]
  ds_read_b64_tr_b16 v[220:221], v244 offset:64
  s_add_u32 m0, s98, 6912
  s_add_u32 s37, s99, 82944
  s_mov_b32 exec_lo, 4294967295
  s_mov_b32 exec_hi, 4194303
  buffer_load_dwordx4 v248, s[12:15], s37 offen lds
  s_mov_b64 exec, -1
  v_mfma_f32_16x16x32_bf16 v[204:207], v[132:135], v[224:227], v[204:207]
  ds_read_b64_tr_b16 v[222:223], v244 offset:4672
  v_mfma_f32_16x16x32_bf16 v[208:211], v[60:63], v[228:231], v[208:211]
  ds_read_b64_tr_b16 v[224:225], v244 offset:96
  v_mfma_f32_16x16x32_bf16 v[212:215], v[132:135], v[228:231], v[212:215]
  ds_read_b64_tr_b16 v[226:227], v244 offset:4704
  s_add_u32 m0, s98, 13824
  s_add_u32 s37, s99, 165888
  s_mov_b32 exec_lo, 4294967295
  s_mov_b32 exec_hi, 4194303
  buffer_load_dwordx4 v248, s[12:15], s37 offen lds
  s_mov_b64 exec, -1
  s_waitcnt lgkmcnt(6)
  v_mfma_f32_16x16x32_bf16 v[144:147], v[64:67], v[232:235], v[144:147]
  ds_read_b64_tr_b16 v[228:229], v246 offset:0
  v_mfma_f32_16x16x32_bf16 v[148:151], v[136:139], v[232:235], v[148:151]
  ds_read_b64_tr_b16 v[230:231], v246 offset:4608
  s_waitcnt lgkmcnt(6)
  v_mfma_f32_16x16x32_bf16 v[152:155], v[64:67], v[216:219], v[152:155]
  ds_read_b64_tr_b16 v[232:233], v245 offset:0
  s_add_u32 m0, s98, 20736
  s_add_u32 s37, s99, 248832
  s_mov_b32 exec_lo, 4294967295
  s_mov_b32 exec_hi, 4194303
  buffer_load_dwordx4 v248, s[12:15], s37 offen lds
  s_mov_b64 exec, -1
  v_mfma_f32_16x16x32_bf16 v[156:159], v[136:139], v[216:219], v[156:159]
  ds_read_b64_tr_b16 v[234:235], v245 offset:4608
  s_waitcnt lgkmcnt(6)
  v_mfma_f32_16x16x32_bf16 v[160:163], v[64:67], v[220:223], v[160:163]
  ds_read_b64_tr_b16 v[216:217], v245 offset:32
  v_mfma_f32_16x16x32_bf16 v[164:167], v[136:139], v[220:223], v[164:167]
  ds_read_b64_tr_b16 v[218:219], v245 offset:4640
  s_add_u32 m0, s98, 27648
  s_add_u32 s37, s99, 331776
  s_mov_b32 exec_lo, 4294967295
  s_mov_b32 exec_hi, 4194303
  buffer_load_dwordx4 v248, s[12:15], s37 offen lds
  s_mov_b64 exec, -1
  s_waitcnt lgkmcnt(6)
  v_mfma_f32_16x16x32_bf16 v[168:171], v[64:67], v[224:227], v[168:171]
  ds_read_b64_tr_b16 v[220:221], v245 offset:64
  v_mfma_f32_16x16x32_bf16 v[172:175], v[136:139], v[224:227], v[172:175]
  ds_read_b64_tr_b16 v[222:223], v245 offset:4672
  s_waitcnt lgkmcnt(6)
  v_mfma_f32_16x16x32_bf16 v[176:179], v[64:67], v[228:231], v[176:179]
  ds_read_b64_tr_b16 v[224:225], v245 offset:96
  s_add_u32 m0, s98, 34560
  s_add_u32 s37, s99, 414720
  s_mov_b32 exec_lo, 4294967295
  s_mov_b32 exec_hi, 4194303
  buffer_load_dwordx4 v248, s[12:15], s37 offen lds
  s_mov_b64 exec, -1
  v_mfma_f32_16x16x32_bf16 v[180:183], v[136:139], v[228:231], v[180:183]
  ds_read_b64_tr_b16 v[226:227], v245 offset:4704
  s_waitcnt lgkmcnt(6)
  v_mfma_f32_16x16x32_bf16 v[184:187], v[64:67], v[232:235], v[184:187]
  ds_read_b64_tr_b16 v[228:229], v244 offset:9216
  v_mfma_f32_16x16x32_bf16 v[188:191], v[136:139], v[232:235], v[188:191]
  ds_read_b64_tr_b16 v[230:231], v244 offset:13824
  s_add_u32 m0, s98, 41472
  s_add_u32 s37, s99, 497664
  s_mov_b32 exec_lo, 4294967295
  s_mov_b32 exec_hi, 4194303
  buffer_load_dwordx4 v248, s[12:15], s37 offen lds
  s_mov_b64 exec, -1
  s_waitcnt lgkmcnt(6)
  v_mfma_f32_16x16x32_bf16 v[192:195], v[64:67], v[216:219], v[192:195]
  ds_read_b64_tr_b16 v[232:233], v244 offset:9248
  v_mfma_f32_16x16x32_bf16 v[196:199], v[136:139], v[216:219], v[196:199]
  ds_read_b64_tr_b16 v[234:235], v244 offset:13856
  s_waitcnt lgkmcnt(6)
  v_mfma_f32_16x16x32_bf16 v[200:203], v[64:67], v[220:223], v[200:203]
  ds_read_b64_tr_b16 v[216:217], v244 offset:9280
  s_add_u32 m0, s98, 48384
  s_add_u32 s37, s99, 580608
  s_mov_b32 exec_lo, 4294967295
  s_mov_b32 exec_hi, 4194303
  buffer_load_dwordx4 v248, s[12:15], s37 offen lds
  s_mov_b64 exec, -1
  v_mfma_f32_16x16x32_bf16 v[204:207], v[136:139], v[220:223], v[204:207]
  ds_read_b64_tr_b16 v[218:219], v244 offset:13888
  s_waitcnt lgkmcnt(6)
  v_mfma_f32_16x16x32_bf16 v[208:211], v[64:67], v[224:227], v[208:211]
  ds_read_b64_tr_b16 v[220:221], v244 offset:9312
  v_mfma_f32_16x16x32_bf16 v[212:215], v[136:139], v[224:227], v[212:215]
  ds_read_b64_tr_b16 v[222:223], v244 offset:13920
  s_add_u32 m0, s98, 55296
  s_add_u32 s37, s99, 663552
  s_mov_b32 exec_lo, 4294967295
  s_mov_b32 exec_hi, 4194303
  buffer_load_dwordx4 v248, s[12:15], s37 offen lds
  s_mov_b64 exec, -1
  s_waitcnt lgkmcnt(6)
  v_mfma_f32_16x16x32_bf16 v[144:147], v[68:71], v[228:231], v[144:147]
  ds_read_b64_tr_b16 v[224:225], v246 offset:9216
  v_mfma_f32_16x16x32_bf16 v[148:151], v[140:143], v[228:231], v[148:151]
  ds_read_b64_tr_b16 v[226:227], v246 offset:13824
  s_waitcnt lgkmcnt(6)
  v_mfma_f32_16x16x32_bf16 v[152:155], v[68:71], v[232:235], v[152:155]
  ds_read_b64_tr_b16 v[228:229], v245 offset:9216
  s_add_u32 m0, s98, 62208
  s_add_u32 s37, s99, 746496
  s_mov_b32 exec_lo, 4294967295
  s_mov_b32 exec_hi, 4194303
  buffer_load_dwordx4 v248, s[12:15], s37 offen lds
  s_mov_b64 exec, -1
  v_mfma_f32_16x16x32_bf16 v[156:159], v[140:143], v[232:235], v[156:159]
  ds_read_b64_tr_b16 v[230:231], v245 offset:13824
  s_waitcnt lgkmcnt(6)
  v_mfma_f32_16x16x32_bf16 v[160:163], v[68:71], v[216:219], v[160:163]
  ds_read_b64_tr_b16 v[232:233], v245 offset:9248
  v_mfma_f32_16x16x32_bf16 v[164:167], v[140:143], v[216:219], v[164:167]
  ds_read_b64_tr_b16 v[234:235], v245 offset:13856
  s_cmp_gt_u32 s28, 5
  s_cbranch_scc1 L_dsk45
  s_add_u32 m0, s98, 69120
  s_add_u32 s37, s99, 829440
  s_mov_b32 exec_lo, 4294967295
  s_mov_b32 exec_hi, 4194303
  s_cmp_lg_u32 s28, 5
  s_cbranch_scc1 L_dpt46
  s_mov_b32 exec_lo, 262143
  s_mov_b32 exec_hi, 0
  L_dpt46:
  buffer_load_dwordx4 v248, s[12:15], s37 offen lds
  s_mov_b64 exec, -1
  L_dsk45:
  s_waitcnt lgkmcnt(6)
  v_mfma_f32_16x16x32_bf16 v[168:171], v[68:71], v[220:223], v[168:171]
  ds_read_b64_tr_b16 v[216:217], v245 offset:9280
  v_mfma_f32_16x16x32_bf16 v[172:175], v[140:143], v[220:223], v[172:175]
  ds_read_b64_tr_b16 v[218:219], v245 offset:13888
  s_waitcnt lgkmcnt(6)
  v_mfma_f32_16x16x32_bf16 v[176:179], v[68:71], v[224:227], v[176:179]
  ds_read_b64_tr_b16 v[220:221], v245 offset:9312
  v_mfma_f32_16x16x32_bf16 v[180:183], v[140:143], v[224:227], v[180:183]
  ds_read_b64_tr_b16 v[222:223], v245 offset:13920
  s_waitcnt lgkmcnt(6)
  v_mfma_f32_16x16x32_bf16 v[184:187], v[68:71], v[228:231], v[184:187]
  v_mfma_f32_16x16x32_bf16 v[188:191], v[140:143], v[228:231], v[188:191]
  s_waitcnt lgkmcnt(4)
  v_mfma_f32_16x16x32_bf16 v[192:195], v[68:71], v[232:235], v[192:195]
  v_mfma_f32_16x16x32_bf16 v[196:199], v[140:143], v[232:235], v[196:199]
  s_waitcnt lgkmcnt(2)
  v_mfma_f32_16x16x32_bf16 v[200:203], v[68:71], v[216:219], v[200:203]
  v_mfma_f32_16x16x32_bf16 v[204:207], v[140:143], v[216:219], v[204:207]
  s_waitcnt lgkmcnt(0)
  v_mfma_f32_16x16x32_bf16 v[208:211], v[68:71], v[220:223], v[208:211]
  v_mfma_f32_16x16x32_bf16 v[212:215], v[140:143], v[220:223], v[212:215]
  s_waitcnt vmcnt(0)
  s_cmp_lg_u32 s28, 0
  s_cbranch_scc1 L_cz47
  s_mov_b32 s52, 0
L_pc48:
  v_readfirstlane_b32 s36, v243
  s_add_u32 s52, s52, 1
  s_nop 3
  s_cmp_ge_u32 s36, 16
  s_cbranch_scc1 L_pcd49
  s_cmp_ge_u32 s52, 0x40000
  s_cbranch_scc1 L_pcd49
  s_sleep 2
  v_mov_b32 v243, 0
  buffer_load_dword v243, v243, s[48:51], s45 offen sc1
  s_waitcnt vmcnt(0)
  s_branch L_pc48
L_pcd49:
L_cz47:
  s_barrier
  s_mov_b32 s54, 0x3fb8aa3b
  s_mov_b32 s55, 0x3fb8aa3b
  s_mov_b32 s56, 0x358637bd
  s_mov_b32 s57, 0x358637bd
  s_nop 3
  s_mov_b32 s62, 0x00ff00ff
  s_mov_b32 s63, 0x00ff00ff
  v_lshlrev_b32 v250, 4, v255
  s_mul_i32 s33, s28, 9216
  s_add_u32 s33, s33, 73728
  v_add_u32 v249, s33, v250
  s_mul_i32 s33, s32, 36864
  s_add_u32 s33, s33, 73728
  v_add_u32 v250, s33, v250
  v_lshlrev_b32 v251, 2, v255
  v_cvt_pk_bf16_f32 v184, v184, v185
  v_cvt_pk_bf16_f32 v185, v186, v187
  v_cvt_pk_bf16_f32 v186, v188, v189
  v_cvt_pk_bf16_f32 v187, v190, v191
  ds_write_b128 v249, v[184:187] offset:5120
  v_cvt_pk_bf16_f32 v192, v192, v193
  v_cvt_pk_bf16_f32 v193, v194, v195
  v_cvt_pk_bf16_f32 v194, v196, v197
  v_cvt_pk_bf16_f32 v195, v198, v199
  ds_write_b128 v249, v[192:195] offset:6144
  v_cvt_pk_bf16_f32 v200, v200, v201
  v_cvt_pk_bf16_f32 v201, v202, v203
  v_cvt_pk_bf16_f32 v202, v204, v205
  v_cvt_pk_bf16_f32 v203, v206, v207
  ds_write_b128 v249, v[200:203] offset:7168
  v_cvt_pk_bf16_f32 v208, v208, v209
  v_cvt_pk_bf16_f32 v209, v210, v211
  v_cvt_pk_bf16_f32 v210, v212, v213
  v_cvt_pk_bf16_f32 v211, v214, v215
  ds_write_b128 v249, v[208:211] offset:8192
  v_mov_b32 v240, v176
  v_mov_b32 v241, v177
  v_mov_b32 v242, v178
  v_mov_b32 v243, v179
  v_pk_mul_f32 v[236:237], v[176:177], s[54:55]
  v_pk_mul_f32 v[238:239], v[178:179], s[54:55]
  v_exp_f32_e64 v236, v236 clamp
  v_exp_f32_e64 v237, v237 clamp
  v_exp_f32_e64 v238, v238 clamp
  v_exp_f32_e64 v239, v239 clamp
  v_max_f32 v176, 0, v176
  v_max_f32 v177, 0, v177
  v_max_f32 v178, 0, v178
  v_max_f32 v179, 0, v179
  v_pk_add_f32 v[176:177], v[176:177], s[56:57]
  v_pk_add_f32 v[178:179], v[178:179], s[56:57]
  v_pk_add_f32 v[176:177], v[176:177], v[236:237]
  v_pk_add_f32 v[178:179], v[178:179], v[238:239]
  v_cndmask_b32 v176, v240, v176, s[62:63]
  v_cndmask_b32 v177, v241, v177, s[62:63]
  v_cndmask_b32 v178, v242, v178, s[62:63]
  v_cndmask_b32 v179, v243, v179, s[62:63]
  v_mov_b32 v240, v180
  v_mov_b32 v241, v181
  v_mov_b32 v242, v182
  v_mov_b32 v243, v183
  v_pk_mul_f32 v[236:237], v[180:181], s[54:55]
  v_pk_mul_f32 v[238:239], v[182:183], s[54:55]
  v_exp_f32_e64 v236, v236 clamp
  v_exp_f32_e64 v237, v237 clamp
  v_exp_f32_e64 v238, v238 clamp
  v_exp_f32_e64 v239, v239 clamp
  v_max_f32 v180, 0, v180
  v_max_f32 v181, 0, v181
  v_max_f32 v182, 0, v182
  v_max_f32 v183, 0, v183
  v_pk_add_f32 v[180:181], v[180:181], s[56:57]
  v_pk_add_f32 v[182:183], v[182:183], s[56:57]
  v_pk_add_f32 v[180:181], v[180:181], v[236:237]
  v_pk_add_f32 v[182:183], v[182:183], v[238:239]
  v_cndmask_b32 v180, v240, v180, s[62:63]
  v_cndmask_b32 v181, v241, v181, s[62:63]
  v_cndmask_b32 v182, v242, v182, s[62:63]
  v_cndmask_b32 v183, v243, v183, s[62:63]
  v_cvt_pk_bf16_f32 v176, v176, v177
  v_cvt_pk_bf16_f32 v177, v178, v179
  v_cvt_pk_bf16_f32 v178, v180, v181
  v_cvt_pk_bf16_f32 v179, v182, v183
  ds_write_b128 v249, v[176:179] offset:4096
  v_pk_mul_f32 v[236:237], v[144:145], s[54:55]
  v_pk_mul_f32 v[240:241], v[148:149], s[54:55]
  v_pk_mul_f32 v[238:239], v[146:147], s[54:55]
  v_pk_mul_f32 v[242:243], v[150:151], s[54:55]
  v_exp_f32_e64 v236, v236 clamp
  v_exp_f32_e64 v240, v240 clamp
  v_exp_f32_e64 v237, v237 clamp
  v_exp_f32_e64 v241, v241 clamp
  v_exp_f32_e64 v238, v238 clamp
  v_exp_f32_e64 v242, v242 clamp
  v_exp_f32_e64 v239, v239 clamp
  v_exp_f32_e64 v243, v243 clamp
  v_max_f32 v144, 0, v144
  v_max_f32 v148, 0, v148
  v_max_f32 v145, 0, v145
  v_max_f32 v149, 0, v149
  v_max_f32 v146, 0, v146
  v_max_f32 v150, 0, v150
  v_max_f32 v147, 0, v147
  v_max_f32 v151, 0, v151
  v_pk_add_f32 v[144:145], v[144:145], s[56:57]
  v_pk_add_f32 v[148:149], v[148:149], s[56:57]
  v_pk_add_f32 v[146:147], v[146:147], s[56:57]
  v_pk_add_f32 v[150:151], v[150:151], s[56:57]
  v_pk_add_f32 v[144:145], v[144:145], v[236:237]
  v_pk_add_f32 v[148:149], v[148:149], v[240:241]
  v_pk_add_f32 v[146:147], v[146:147], v[238:239]
  v_pk_add_f32 v[150:151], v[150:151], v[242:243]
  v_cvt_pk_bf16_f32 v144, v144, v145
  v_cvt_pk_bf16_f32 v145, v146, v147
  v_cvt_pk_bf16_f32 v146, v148, v149
  v_cvt_pk_bf16_f32 v147, v150, v151
  ds_write_b128 v249, v[144:147] offset:0
  v_pk_mul_f32 v[236:237], v[152:153], s[54:55]
  v_pk_mul_f32 v[240:241], v[156:157], s[54:55]
  v_pk_mul_f32 v[238:239], v[154:155], s[54:55]
  v_pk_mul_f32 v[242:243], v[158:159], s[54:55]
  v_exp_f32_e64 v236, v236 clamp
  v_exp_f32_e64 v240, v240 clamp
  v_exp_f32_e64 v237, v237 clamp
  v_exp_f32_e64 v241, v241 clamp
  v_exp_f32_e64 v238, v238 clamp
  v_exp_f32_e64 v242, v242 clamp
  v_exp_f32_e64 v239, v239 clamp
  v_exp_f32_e64 v243, v243 clamp
  v_max_f32 v152, 0, v152
  v_max_f32 v156, 0, v156
  v_max_f32 v153, 0, v153
  v_max_f32 v157, 0, v157
  v_max_f32 v154, 0, v154
  v_max_f32 v158, 0, v158
  v_max_f32 v155, 0, v155
  v_max_f32 v159, 0, v159
  v_pk_add_f32 v[152:153], v[152:153], s[56:57]
  v_pk_add_f32 v[156:157], v[156:157], s[56:57]
  v_pk_add_f32 v[154:155], v[154:155], s[56:57]
  v_pk_add_f32 v[158:159], v[158:159], s[56:57]
  v_pk_add_f32 v[152:153], v[152:153], v[236:237]
  v_pk_add_f32 v[156:157], v[156:157], v[240:241]
  v_pk_add_f32 v[154:155], v[154:155], v[238:239]
  v_pk_add_f32 v[158:159], v[158:159], v[242:243]
  v_cvt_pk_bf16_f32 v152, v152, v153
  v_cvt_pk_bf16_f32 v153, v154, v155
  v_cvt_pk_bf16_f32 v154, v156, v157
  v_cvt_pk_bf16_f32 v155, v158, v159
  ds_write_b128 v249, v[152:155] offset:1024
  v_pk_mul_f32 v[236:237], v[160:161], s[54:55]
  v_pk_mul_f32 v[240:241], v[164:165], s[54:55]
  v_pk_mul_f32 v[238:239], v[162:163], s[54:55]
  v_pk_mul_f32 v[242:243], v[166:167], s[54:55]
  v_exp_f32_e64 v236, v236 clamp
  v_exp_f32_e64 v240, v240 clamp
  v_exp_f32_e64 v237, v237 clamp
  v_exp_f32_e64 v241, v241 clamp
  v_exp_f32_e64 v238, v238 clamp
  v_exp_f32_e64 v242, v242 clamp
  v_exp_f32_e64 v239, v239 clamp
  v_exp_f32_e64 v243, v243 clamp
  v_max_f32 v160, 0, v160
  v_max_f32 v164, 0, v164
  v_max_f32 v161, 0, v161
  v_max_f32 v165, 0, v165
  v_max_f32 v162, 0, v162
  v_max_f32 v166, 0, v166
  v_max_f32 v163, 0, v163
  v_max_f32 v167, 0, v167
  v_pk_add_f32 v[160:161], v[160:161], s[56:57]
  v_pk_add_f32 v[164:165], v[164:165], s[56:57]
  v_pk_add_f32 v[162:163], v[162:163], s[56:57]
  v_pk_add_f32 v[166:167], v[166:167], s[56:57]
  v_pk_add_f32 v[160:161], v[160:161], v[236:237]
  v_pk_add_f32 v[164:165], v[164:165], v[240:241]
  v_pk_add_f32 v[162:163], v[162:163], v[238:239]
  v_pk_add_f32 v[166:167], v[166:167], v[242:243]
  v_cvt_pk_bf16_f32 v160, v160, v161
  v_cvt_pk_bf16_f32 v161, v162, v163
  v_cvt_pk_bf16_f32 v162, v164, v165
  v_cvt_pk_bf16_f32 v163, v166, v167
  ds_write_b128 v249, v[160:163] offset:2048
  v_pk_mul_f32 v[236:237], v[168:169], s[54:55]
  v_pk_mul_f32 v[240:241], v[172:173], s[54:55]
  v_pk_mul_f32 v[238:239], v[170:171], s[54:55]
  v_pk_mul_f32 v[242:243], v[174:175], s[54:55]
  v_exp_f32_e64 v236, v236 clamp
  v_exp_f32_e64 v240, v240 clamp
  v_exp_f32_e64 v237, v237 clamp
  v_exp_f32_e64 v241, v241 clamp
  v_exp_f32_e64 v238, v238 clamp
  v_exp_f32_e64 v242, v242 clamp
  v_exp_f32_e64 v239, v239 clamp
  v_exp_f32_e64 v243, v243 clamp
  v_max_f32 v168, 0, v168
  v_max_f32 v172, 0, v172
  v_max_f32 v169, 0, v169
  v_max_f32 v173, 0, v173
  v_max_f32 v170, 0, v170
  v_max_f32 v174, 0, v174
  v_max_f32 v171, 0, v171
  v_max_f32 v175, 0, v175
  v_pk_add_f32 v[168:169], v[168:169], s[56:57]
  v_pk_add_f32 v[172:173], v[172:173], s[56:57]
  v_pk_add_f32 v[170:171], v[170:171], s[56:57]
  v_pk_add_f32 v[174:175], v[174:175], s[56:57]
  v_pk_add_f32 v[168:169], v[168:169], v[236:237]
  v_pk_add_f32 v[172:173], v[172:173], v[240:241]
  v_pk_add_f32 v[170:171], v[170:171], v[238:239]
  v_pk_add_f32 v[174:175], v[174:175], v[242:243]
  v_cvt_pk_bf16_f32 v168, v168, v169
  v_cvt_pk_bf16_f32 v169, v170, v171
  v_cvt_pk_bf16_f32 v170, v172, v173
  v_cvt_pk_bf16_f32 v171, v174, v175
  ds_write_b128 v249, v[168:171] offset:3072
  v_mov_b32 v216, 0x3f803f80
  v_mov_b32 v217, 0x3f803f80
  v_mov_b32 v218, 0x3f803f80
  v_mov_b32 v219, 0x3f803f80
  s_lshl_b32 s40, s30, 1
  s_add_u32 s40, s40, s32
  s_mul_i32 s40, s40, 18432
  s_add_u32 s40, s40, 37756928
  s_waitcnt lgkmcnt(0)
  s_barrier
  s_cmp_lg_u32 s31, 0
  s_cbranch_scc1 L_kvv51
  ds_read_b128 v[144:147], v250 offset:0
  ds_read_b128 v[148:151], v250 offset:1024
  ds_read_b128 v[152:155], v250 offset:4096
  ds_read_b128 v[156:159], v250 offset:5120
  ds_read_b128 v[164:167], v250 offset:9216
  ds_read_b128 v[168:171], v250 offset:10240
  ds_read_b128 v[172:175], v250 offset:13312
  ds_read_b128 v[176:179], v250 offset:14336
  s_waitcnt lgkmcnt(4)
  v_mfma_f32_16x16x32_bf16 v[184:187], v[144:147], v[152:155], 0
  v_mfma_f32_16x16x32_bf16 v[188:191], v[144:147], v[156:159], 0
  v_mfma_f32_16x16x32_bf16 v[192:195], v[148:151], v[152:155], 0
  v_mfma_f32_16x16x32_bf16 v[196:199], v[148:151], v[156:159], 0
  v_mfma_f32_16x16x32_bf16 v[200:203], v[216:219], v[144:147], 0
  ds_read_b128 v[144:147], v250 offset:18432
  ds_read_b128 v[148:151], v250 offset:19456
  ds_read_b128 v[152:155], v250 offset:22528
  ds_read_b128 v[156:159], v250 offset:23552
  s_waitcnt lgkmcnt(4)
  v_mfma_f32_16x16x32_bf16 v[184:187], v[164:167], v[172:175], v[184:187]
  v_mfma_f32_16x16x32_bf16 v[188:191], v[164:167], v[176:179], v[188:191]
  v_mfma_f32_16x16x32_bf16 v[192:195], v[168:171], v[172:175], v[192:195]
  v_mfma_f32_16x16x32_bf16 v[196:199], v[168:171], v[176:179], v[196:199]
  v_mfma_f32_16x16x32_bf16 v[200:203], v[216:219], v[164:167], v[200:203]
  ds_read_b128 v[164:167], v250 offset:27648
  ds_read_b128 v[168:171], v250 offset:28672
  ds_read_b128 v[172:175], v250 offset:31744
  ds_read_b128 v[176:179], v250 offset:32768
  s_waitcnt lgkmcnt(4)
  v_mfma_f32_16x16x32_bf16 v[184:187], v[144:147], v[152:155], v[184:187]
  v_mfma_f32_16x16x32_bf16 v[188:191], v[144:147], v[156:159], v[188:191]
  v_mfma_f32_16x16x32_bf16 v[192:195], v[148:151], v[152:155], v[192:195]
  v_mfma_f32_16x16x32_bf16 v[196:199], v[148:151], v[156:159], v[196:199]
  v_mfma_f32_16x16x32_bf16 v[200:203], v[216:219], v[144:147], v[200:203]
  s_waitcnt lgkmcnt(0)
  v_mfma_f32_16x16x32_bf16 v[184:187], v[164:167], v[172:175], v[184:187]
  v_mfma_f32_16x16x32_bf16 v[188:191], v[164:167], v[176:179], v[188:191]
  v_mfma_f32_16x16x32_bf16 v[192:195], v[168:171], v[172:175], v[192:195]
  v_mfma_f32_16x16x32_bf16 v[196:199], v[168:171], v[176:179], v[196:199]
  v_mfma_f32_16x16x32_bf16 v[200:203], v[216:219], v[164:167], v[200:203]
  s_nop 7
  s_lshl_b32 s33, s28, 11
  s_add_u32 s33, s33, 147456
  v_lshlrev_b32 v236, 4, v255
  v_add_u32 v236, s33, v236
  v_add_u32 v237, s33, v251
  ds_write_b128 v236, v[184:187] offset:0
  ds_read_b32 v144, v237 offset:0
  ds_read_b32 v145, v237 offset:256
  ds_read_b32 v146, v237 offset:512
  ds_read_b32 v147, v237 offset:768
  ds_write_b128 v236, v[188:191] offset:1024
  ds_read_b32 v148, v237 offset:1024
  ds_read_b32 v149, v237 offset:1280
  ds_read_b32 v150, v237 offset:1536
  ds_read_b32 v151, v237 offset:1792
  s_waitcnt lgkmcnt(0)
  ds_write_b128 v236, v[192:195] offset:0
  ds_read_b32 v152, v237 offset:0
  ds_read_b32 v153, v237 offset:256
  ds_read_b32 v154, v237 offset:512
  ds_read_b32 v155, v237 offset:768
  ds_write_b128 v236, v[196:199] offset:1024
  ds_read_b32 v156, v237 offset:1024
  ds_read_b32 v157, v237 offset:1280
  ds_read_b32 v158, v237 offset:1536
  ds_read_b32 v159, v237 offset:1792
  s_waitcnt lgkmcnt(0)
  s_waitcnt lgkmcnt(0)
  s_add_u32 s35, s40, 0
  buffer_atomic_add_f32 v144, v251, s[20:23], s35 offen offset:0
  buffer_atomic_add_f32 v145, v251, s[20:23], s35 offen offset:256
  buffer_atomic_add_f32 v146, v251, s[20:23], s35 offen offset:512
  buffer_atomic_add_f32 v147, v251, s[20:23], s35 offen offset:768
  s_add_u32 s35, s40, 1024
  buffer_atomic_add_f32 v148, v251, s[20:23], s35 offen offset:0
  buffer_atomic_add_f32 v149, v251, s[20:23], s35 offen offset:256
  buffer_atomic_add_f32 v150, v251, s[20:23], s35 offen offset:512
  buffer_atomic_add_f32 v151, v251, s[20:23], s35 offen offset:768
  s_add_u32 s35, s40, 2048
  buffer_atomic_add_f32 v152, v251, s[20:23], s35 offen offset:0
  buffer_atomic_add_f32 v153, v251, s[20:23], s35 offen offset:256
  buffer_atomic_add_f32 v154, v251, s[20:23], s35 offen offset:512
  buffer_atomic_add_f32 v155, v251, s[20:23], s35 offen offset:768
  s_add_u32 s35, s40, 3072
  buffer_atomic_add_f32 v156, v251, s[20:23], s35 offen offset:0
  buffer_atomic_add_f32 v157, v251, s[20:23], s35 offen offset:256
  buffer_atomic_add_f32 v158, v251, s[20:23], s35 offen offset:512
  buffer_atomic_add_f32 v159, v251, s[20:23], s35 offen offset:768
  s_add_u32 s35, s40, 13312
  buffer_atomic_add_f32 v200, v251, s[20:23], s35 offen
  s_branch L_kvred50
L_kvv51:
  s_cmp_lg_u32 s31, 1
  s_cbranch_scc1 L_kvv52
  ds_read_b128 v[144:147], v250 offset:1024
  ds_read_b128 v[148:151], v250 offset:2048
  ds_read_b128 v[152:155], v250 offset:5120
  ds_read_b128 v[156:159], v250 offset:6144
  ds_read_b128 v[160:163], v250 offset:7168
  ds_read_b128 v[164:167], v250 offset:10240
  ds_read_b128 v[168:171], v250 offset:11264
  ds_read_b128 v[172:175], v250 offset:14336
  ds_read_b128 v[176:179], v250 offset:15360
  ds_read_b128 v[180:183], v250 offset:16384
  s_waitcnt lgkmcnt(5)
  v_mfma_f32_16x16x32_bf16 v[184:187], v[144:147], v[156:159], 0
  v_mfma_f32_16x16x32_bf16 v[188:191], v[148:151], v[152:155], 0
  v_mfma_f32_16x16x32_bf16 v[192:195], v[148:151], v[156:159], 0
  v_mfma_f32_16x16x32_bf16 v[196:199], v[148:151], v[160:163], 0
  v_mfma_f32_16x16x32_bf16 v[200:203], v[216:219], v[144:147], 0
  v_mfma_f32_16x16x32_bf16 v[204:207], v[216:219], v[148:151], 0
  ds_read_b128 v[144:147], v250 offset:19456
  ds_read_b128 v[148:151], v250 offset:20480
  ds_read_b128 v[152:155], v250 offset:23552
  ds_read_b128 v[156:159], v250 offset:24576
  ds_read_b128 v[160:163], v250 offset:25600
  s_waitcnt lgkmcnt(5)
  v_mfma_f32_16x16x32_bf16 v[184:187], v[164:167], v[176:179], v[184:187]
  v_mfma_f32_16x16x32_bf16 v[188:191], v[168:171], v[172:175], v[188:191]
  v_mfma_f32_16x16x32_bf16 v[192:195], v[168:171], v[176:179], v[192:195]
  v_mfma_f32_16x16x32_bf16 v[196:199], v[168:171], v[180:183], v[196:199]
  v_mfma_f32_16x16x32_bf16 v[200:203], v[216:219], v[164:167], v[200:203]
  v_mfma_f32_16x16x32_bf16 v[204:207], v[216:219], v[168:171], v[204:207]
  ds_read_b128 v[164:167], v250 offset:28672
  ds_read_b128 v[168:171], v250 offset:29696
  ds_read_b128 v[172:175], v250 offset:32768
  ds_read_b128 v[176:179], v250 offset:33792
  ds_read_b128 v[180:183], v250 offset:34816
  s_waitcnt lgkmcnt(5)
  v_mfma_f32_16x16x32_bf16 v[184:187], v[144:147], v[156:159], v[184:187]
  v_mfma_f32_16x16x32_bf16 v[188:191], v[148:151], v[152:155], v[188:191]
  v_mfma_f32_16x16x32_bf16 v[192:195], v[148:151], v[156:159], v[192:195]
  v_mfma_f32_16x16x32_bf16 v[196:199], v[148:151], v[160:163], v[196:199]
  v_mfma_f32_16x16x32_bf16 v[200:203], v[216:219], v[144:147], v[200:203]
  v_mfma_f32_16x16x32_bf16 v[204:207], v[216:219], v[148:151], v[204:207]
  s_waitcnt lgkmcnt(0)
  v_mfma_f32_16x16x32_bf16 v[184:187], v[164:167], v[176:179], v[184:187]
  v_mfma_f32_16x16x32_bf16 v[188:191], v[168:171], v[172:175], v[188:191]
  v_mfma_f32_16x16x32_bf16 v[192:195], v[168:171], v[176:179], v[192:195]
  v_mfma_f32_16x16x32_bf16 v[196:199], v[168:171], v[180:183], v[196:199]
  v_mfma_f32_16x16x32_bf16 v[200:203], v[216:219], v[164:167], v[200:203]
  v_mfma_f32_16x16x32_bf16 v[204:207], v[216:219], v[168:171], v[204:207]
  s_nop 7
  s_lshl_b32 s33, s28, 11
  s_add_u32 s33, s33, 147456
  v_lshlrev_b32 v236, 4, v255
  v_add_u32 v236, s33, v236
  v_add_u32 v237, s33, v251
  ds_write_b128 v236, v[184:187] offset:0
  ds_read_b32 v144, v237 offset:0
  ds_read_b32 v145, v237 offset:256
  ds_read_b32 v146, v237 offset:512
  ds_read_b32 v147, v237 offset:768
  ds_write_b128 v236, v[188:191] offset:1024
  ds_read_b32 v148, v237 offset:1024
  ds_read_b32 v149, v237 offset:1280
  ds_read_b32 v150, v237 offset:1536
  ds_read_b32 v151, v237 offset:1792
  s_waitcnt lgkmcnt(0)
  ds_write_b128 v236, v[192:195] offset:0
  ds_read_b32 v152, v237 offset:0
  ds_read_b32 v153, v237 offset:256
  ds_read_b32 v154, v237 offset:512
  ds_read_b32 v155, v237 offset:768
  ds_write_b128 v236, v[196:199] offset:1024
  ds_read_b32 v156, v237 offset:1024
  ds_read_b32 v157, v237 offset:1280
  ds_read_b32 v158, v237 offset:1536
  ds_read_b32 v159, v237 offset:1792
  s_waitcnt lgkmcnt(0)
  s_waitcnt lgkmcnt(0)
  s_add_u32 s35, s40, 4096
  buffer_atomic_add_f32 v144, v251, s[20:23], s35 offen offset:0
  buffer_atomic_add_f32 v145, v251, s[20:23], s35 offen offset:256
  buffer_atomic_add_f32 v146, v251, s[20:23], s35 offen offset:512
  buffer_atomic_add_f32 v147, v251, s[20:23], s35 offen offset:768
  s_add_u32 s35, s40, 5120
  buffer_atomic_add_f32 v148, v251, s[20:23], s35 offen offset:0
  buffer_atomic_add_f32 v149, v251, s[20:23], s35 offen offset:256
  buffer_atomic_add_f32 v150, v251, s[20:23], s35 offen offset:512
  buffer_atomic_add_f32 v151, v251, s[20:23], s35 offen offset:768
  s_add_u32 s35, s40, 6144
  buffer_atomic_add_f32 v152, v251, s[20:23], s35 offen offset:0
  buffer_atomic_add_f32 v153, v251, s[20:23], s35 offen offset:256
  buffer_atomic_add_f32 v154, v251, s[20:23], s35 offen offset:512
  buffer_atomic_add_f32 v155, v251, s[20:23], s35 offen offset:768
  s_add_u32 s35, s40, 7168
  buffer_atomic_add_f32 v156, v251, s[20:23], s35 offen offset:0
  buffer_atomic_add_f32 v157, v251, s[20:23], s35 offen offset:256
  buffer_atomic_add_f32 v158, v251, s[20:23], s35 offen offset:512
  buffer_atomic_add_f32 v159, v251, s[20:23], s35 offen offset:768
  s_add_u32 s35, s40, 14336
  buffer_atomic_add_f32 v200, v251, s[20:23], s35 offen
  s_add_u32 s35, s40, 15360
  buffer_atomic_add_f32 v204, v251, s[20:23], s35 offen
  s_branch L_kvred50
L_kvv52:
  s_cmp_lg_u32 s31, 2
  s_cbranch_scc1 L_kvv53
  ds_read_b128 v[144:147], v250 offset:3072
  ds_read_b128 v[148:151], v250 offset:6144
  ds_read_b128 v[152:155], v250 offset:7168
  ds_read_b128 v[156:159], v250 offset:8192
  ds_read_b128 v[164:167], v250 offset:12288
  ds_read_b128 v[168:171], v250 offset:15360
  ds_read_b128 v[172:175], v250 offset:16384
  ds_read_b128 v[176:179], v250 offset:17408
  s_waitcnt lgkmcnt(4)
  v_mfma_f32_16x16x32_bf16 v[184:187], v[144:147], v[148:151], 0
  v_mfma_f32_16x16x32_bf16 v[188:191], v[144:147], v[152:155], 0
  v_mfma_f32_16x16x32_bf16 v[192:195], v[144:147], v[156:159], 0
  v_mfma_f32_16x16x32_bf16 v[196:199], v[216:219], v[144:147], 0
  ds_read_b128 v[144:147], v250 offset:21504
  ds_read_b128 v[148:151], v250 offset:24576
  ds_read_b128 v[152:155], v250 offset:25600
  ds_read_b128 v[156:159], v250 offset:26624
  s_waitcnt lgkmcnt(4)
  v_mfma_f32_16x16x32_bf16 v[184:187], v[164:167], v[168:171], v[184:187]
  v_mfma_f32_16x16x32_bf16 v[188:191], v[164:167], v[172:175], v[188:191]
  v_mfma_f32_16x16x32_bf16 v[192:195], v[164:167], v[176:179], v[192:195]
  v_mfma_f32_16x16x32_bf16 v[196:199], v[216:219], v[164:167], v[196:199]
  ds_read_b128 v[164:167], v250 offset:30720
  ds_read_b128 v[168:171], v250 offset:33792
  ds_read_b128 v[172:175], v250 offset:34816
  ds_read_b128 v[176:179], v250 offset:35840
  s_waitcnt lgkmcnt(4)
  v_mfma_f32_16x16x32_bf16 v[184:187], v[144:147], v[148:151], v[184:187]
  v_mfma_f32_16x16x32_bf16 v[188:191], v[144:147], v[152:155], v[188:191]
  v_mfma_f32_16x16x32_bf16 v[192:195], v[144:147], v[156:159], v[192:195]
  v_mfma_f32_16x16x32_bf16 v[196:199], v[216:219], v[144:147], v[196:199]
  s_waitcnt lgkmcnt(0)
  v_mfma_f32_16x16x32_bf16 v[184:187], v[164:167], v[168:171], v[184:187]
  v_mfma_f32_16x16x32_bf16 v[188:191], v[164:167], v[172:175], v[188:191]
  v_mfma_f32_16x16x32_bf16 v[192:195], v[164:167], v[176:179], v[192:195]
  v_mfma_f32_16x16x32_bf16 v[196:199], v[216:219], v[164:167], v[196:199]
  s_nop 7
  s_lshl_b32 s33, s28, 11
  s_add_u32 s33, s33, 147456
  v_lshlrev_b32 v236, 4, v255
  v_add_u32 v236, s33, v236
  v_add_u32 v237, s33, v251
  ds_write_b128 v236, v[184:187] offset:0
  ds_read_b32 v144, v237 offset:0
  ds_read_b32 v145, v237 offset:256
  ds_read_b32 v146, v237 offset:512
  ds_read_b32 v147, v237 offset:768
  ds_write_b128 v236, v[188:191] offset:1024
  ds_read_b32 v148, v237 offset:1024
  ds_read_b32 v149, v237 offset:1280
  ds_read_b32 v150, v237 offset:1536
  ds_read_b32 v151, v237 offset:1792
  s_waitcnt lgkmcnt(0)
  ds_write_b128 v236, v[192:195] offset:0
  ds_read_b32 v152, v237 offset:0
  ds_read_b32 v153, v237 offset:256
  ds_read_b32 v154, v237 offset:512
  ds_read_b32 v155, v237 offset:768
  s_waitcnt lgkmcnt(0)
  s_add_u32 s35, s40, 8192
  buffer_atomic_add_f32 v144, v251, s[20:23], s35 offen offset:0
  buffer_atomic_add_f32 v145, v251, s[20:23], s35 offen offset:256
  buffer_atomic_add_f32 v146, v251, s[20:23], s35 offen offset:512
  buffer_atomic_add_f32 v147, v251, s[20:23], s35 offen offset:768
  s_add_u32 s35, s40, 9216
  buffer_atomic_add_f32 v148, v251, s[20:23], s35 offen offset:0
  buffer_atomic_add_f32 v149, v251, s[20:23], s35 offen offset:256
  buffer_atomic_add_f32 v150, v251, s[20:23], s35 offen offset:512
  buffer_atomic_add_f32 v151, v251, s[20:23], s35 offen offset:768
  s_add_u32 s35, s40, 10240
  buffer_atomic_add_f32 v152, v251, s[20:23], s35 offen offset:0
  buffer_atomic_add_f32 v153, v251, s[20:23], s35 offen offset:256
  buffer_atomic_add_f32 v154, v251, s[20:23], s35 offen offset:512
  buffer_atomic_add_f32 v155, v251, s[20:23], s35 offen offset:768
  s_add_u32 s35, s40, 16384
  buffer_atomic_add_f32 v196, v251, s[20:23], s35 offen
  s_branch L_kvred50
L_kvv53:
  ds_read_b128 v[144:147], v250 offset:4096
  ds_read_b128 v[148:151], v250 offset:7168
  ds_read_b128 v[152:155], v250 offset:8192
  ds_read_b128 v[164:167], v250 offset:13312
  ds_read_b128 v[168:171], v250 offset:16384
  ds_read_b128 v[172:175], v250 offset:17408
  s_waitcnt lgkmcnt(3)
  v_mfma_f32_16x16x32_bf16 v[184:187], v[144:147], v[148:151], 0
  v_mfma_f32_16x16x32_bf16 v[188:191], v[144:147], v[152:155], 0
  v_mfma_f32_16x16x32_bf16 v[192:195], v[216:219], v[144:147], 0
  ds_read_b128 v[144:147], v250 offset:22528
  ds_read_b128 v[148:151], v250 offset:25600
  ds_read_b128 v[152:155], v250 offset:26624
  s_waitcnt lgkmcnt(3)
  v_mfma_f32_16x16x32_bf16 v[184:187], v[164:167], v[168:171], v[184:187]
  v_mfma_f32_16x16x32_bf16 v[188:191], v[164:167], v[172:175], v[188:191]
  v_mfma_f32_16x16x32_bf16 v[192:195], v[216:219], v[164:167], v[192:195]
  ds_read_b128 v[164:167], v250 offset:31744
  ds_read_b128 v[168:171], v250 offset:34816
  ds_read_b128 v[172:175], v250 offset:35840
  s_waitcnt lgkmcnt(3)
  v_mfma_f32_16x16x32_bf16 v[184:187], v[144:147], v[148:151], v[184:187]
  v_mfma_f32_16x16x32_bf16 v[188:191], v[144:147], v[152:155], v[188:191]
  v_mfma_f32_16x16x32_bf16 v[192:195], v[216:219], v[144:147], v[192:195]
  s_waitcnt lgkmcnt(0)
  v_mfma_f32_16x16x32_bf16 v[184:187], v[164:167], v[168:171], v[184:187]
  v_mfma_f32_16x16x32_bf16 v[188:191], v[164:167], v[172:175], v[188:191]
  v_mfma_f32_16x16x32_bf16 v[192:195], v[216:219], v[164:167], v[192:195]
  s_nop 7
  s_lshl_b32 s33, s28, 11
  s_add_u32 s33, s33, 147456
  v_lshlrev_b32 v236, 4, v255
  v_add_u32 v236, s33, v236
  v_add_u32 v237, s33, v251
  ds_write_b128 v236, v[184:187] offset:0
  ds_read_b32 v144, v237 offset:0
  ds_read_b32 v145, v237 offset:256
  ds_read_b32 v146, v237 offset:512
  ds_read_b32 v147, v237 offset:768
  ds_write_b128 v236, v[188:191] offset:1024
  ds_read_b32 v148, v237 offset:1024
  ds_read_b32 v149, v237 offset:1280
  ds_read_b32 v150, v237 offset:1536
  ds_read_b32 v151, v237 offset:1792
  s_waitcnt lgkmcnt(0)
  s_waitcnt lgkmcnt(0)
  s_add_u32 s35, s40, 11264
  buffer_atomic_add_f32 v144, v251, s[20:23], s35 offen offset:0
  buffer_atomic_add_f32 v145, v251, s[20:23], s35 offen offset:256
  buffer_atomic_add_f32 v146, v251, s[20:23], s35 offen offset:512
  buffer_atomic_add_f32 v147, v251, s[20:23], s35 offen offset:768
  s_add_u32 s35, s40, 12288
  buffer_atomic_add_f32 v148, v251, s[20:23], s35 offen offset:0
  buffer_atomic_add_f32 v149, v251, s[20:23], s35 offen offset:256
  buffer_atomic_add_f32 v150, v251, s[20:23], s35 offen offset:512
  buffer_atomic_add_f32 v151, v251, s[20:23], s35 offen offset:768
  s_add_u32 s35, s40, 17408
  buffer_atomic_add_f32 v192, v251, s[20:23], s35 offen
L_kvred50:
  s_cmp_lg_u32 s28, 0
  s_cbranch_scc1 L_lc55
  v_mov_b32 v236, 147488
  v_mov_b32 v237, 0
  ds_write_b32 v236, v237
  s_waitcnt lgkmcnt(0)
L_lc55:
  s_barrier
  v_mov_b32 v244, v254
  v_mov_b32 v245, v253
  v_add_u32 v246, 36864, v244
  v_add_u32 v247, 36864, v245
  v_lshrrev_b32 v249, 3, v255
  v_lshrrev_b32 v250, 1, v249
  v_lshlrev_b32 v250, 1, v250
  v_and_b32 v251, 7, v255
  v_xor_b32 v250, v251, v250
  v_lshlrev_b32 v250, 4, v250
  s_lshl_b32 s33, s28, 3
  v_add_u32 v249, s33, v249
  s_mul_i32 s34, s30, 144
  s_sub_u32 s34, s34, 8
  s_movk_i32 s35, 1152
  v_add_u32 v251, 0, v249
  v_cmp_le_u32 vcc, 80, v251
  v_add_u32 v251, s34, v251
  v_mov_b32 v241, 8
  v_cndmask_b32 v241, 0, v241, vcc
  v_sub_u32 v251, v251, v241
  v_max_i32 v251, 0, v251
  v_mul_lo_u32 v241, v251, s35
  v_add_u32 v241, v241, v250
  v_add_u32 v251, 64, v249
  v_cmp_le_u32 vcc, 80, v251
  v_add_u32 v251, s34, v251
  v_mov_b32 v242, 8
  v_cndmask_b32 v242, 0, v242, vcc
  v_sub_u32 v251, v251, v242
  v_max_i32 v251, 0, v251
  v_mul_lo_u32 v242, v251, s35
  v_add_u32 v242, v242, v250
  v_add_u32 v251, 128, v249
  v_cmp_le_u32 vcc, 80, v251
  v_add_u32 v251, s34, v251
  v_mov_b32 v243, 8
  v_cndmask_b32 v243, 0, v243, vcc
  v_sub_u32 v251, v251, v243
  v_max_i32 v251, 0, v251
  v_mul_lo_u32 v243, v251, s35
  v_add_u32 v243, v243, v250
  ds_read_b64_tr_b16 v[216:217], v244 offset:0
  ds_read_b64_tr_b16 v[218:219], v244 offset:4608
  ds_read_b64_tr_b16 v[220:221], v244 offset:32
  ds_read_b64_tr_b16 v[222:223], v244 offset:4640
  ds_read_b64_tr_b16 v[224:225], v244 offset:64
  ds_read_b64_tr_b16 v[226:227], v244 offset:4672
  ds_read_b64_tr_b16 v[228:229], v244 offset:96
  ds_read_b64_tr_b16 v[230:231], v244 offset:4704
  s_waitcnt lgkmcnt(6)
  v_mfma_f32_16x16x32_bf16 v[144:147], v[216:219], v[0:3], 0
  ds_read_b64_tr_b16 v[232:233], v245 offset:0
  v_mfma_f32_16x16x32_bf16 v[148:151], v[216:219], v[72:75], 0
  ds_read_b64_tr_b16 v[234:235], v245 offset:4608
  s_add_u32 m0, s98, 73728
  s_add_u32 s37, s99, 884736
  s_mov_b32 exec_lo, 4294967295
  s_mov_b32 exec_hi, 4194303
  buffer_load_dwordx4 v248, s[12:15], s37 offen lds
  s_mov_b64 exec, -1
  s_waitcnt lgkmcnt(6)
  v_mfma_f32_16x16x32_bf16 v[152:155], v[220:223], v[0:3], 0
  ds_read_b64_tr_b16 v[216:217], v244 offset:9216
  v_mfma_f32_16x16x32_bf16 v[156:159], v[220:223], v[72:75], 0
  ds_read_b64_tr_b16 v[218:219], v244 offset:13824
  s_waitcnt lgkmcnt(6)
  v_mfma_f32_16x16x32_bf16 v[160:163], v[224:227], v[0:3], 0
  ds_read_b64_tr_b16 v[220:221], v244 offset:9248
  v_mfma_f32_16x16x32_bf16 v[164:167], v[224:227], v[72:75], 0
  ds_read_b64_tr_b16 v[222:223], v244 offset:13856
  s_waitcnt lgkmcnt(6)
  v_mfma_f32_16x16x32_bf16 v[168:171], v[228:231], v[0:3], 0
  ds_read_b64_tr_b16 v[224:225], v244 offset:9280
  s_add_u32 m0, s98, 80640
  s_add_u32 s37, s99, 967680
  s_mov_b32 exec_lo, 4294967295
  s_mov_b32 exec_hi, 4194303
  buffer_load_dwordx4 v248, s[12:15], s37 offen lds
  s_mov_b64 exec, -1
  v_mfma_f32_16x16x32_bf16 v[172:175], v[228:231], v[72:75], 0
  ds_read_b64_tr_b16 v[226:227], v244 offset:13888
  s_waitcnt lgkmcnt(6)
  v_mfma_f32_16x16x32_bf16 v[176:179], v[232:235], v[0:3], 0
  ds_read_b64_tr_b16 v[228:229], v244 offset:9312
  v_mfma_f32_16x16x32_bf16 v[180:183], v[232:235], v[72:75], 0
  ds_read_b64_tr_b16 v[230:231], v244 offset:13920
  s_waitcnt lgkmcnt(6)
  v_mfma_f32_16x16x32_bf16 v[144:147], v[216:219], v[4:7], v[144:147]
  ds_read_b64_tr_b16 v[232:233], v245 offset:9216
  v_mfma_f32_16x16x32_bf16 v[148:151], v[216:219], v[76:79], v[148:151]
  ds_read_b64_tr_b16 v[234:235], v245 offset:13824
  s_add_u32 m0, s98, 87552
  s_add_u32 s37, s99, 1050624
  s_mov_b32 exec_lo, 4294967295
  s_mov_b32 exec_hi, 4194303
  buffer_load_dwordx4 v248, s[12:15], s37 offen lds
  s_mov_b64 exec, -1
  s_waitcnt lgkmcnt(6)
  v_mfma_f32_16x16x32_bf16 v[152:155], v[220:223], v[4:7], v[152:155]
  ds_read_b64_tr_b16 v[216:217], v244 offset:18432
  v_mfma_f32_16x16x32_bf16 v[156:159], v[220:223], v[76:79], v[156:159]
  ds_read_b64_tr_b16 v[218:219], v244 offset:23040
  s_waitcnt lgkmcnt(6)
  v_mfma_f32_16x16x32_bf16 v[160:163], v[224:227], v[4:7], v[160:163]
  ds_read_b64_tr_b16 v[220:221], v244 offset:18464
  v_mfma_f32_16x16x32_bf16 v[164:167], v[224:227], v[76:79], v[164:167]
  ds_read_b64_tr_b16 v[222:223], v244 offset:23072
  s_waitcnt lgkmcnt(6)
  v_mfma_f32_16x16x32_bf16 v[168:171], v[228:231], v[4:7], v[168:171]
  ds_read_b64_tr_b16 v[224:225], v244 offset:18496
  s_add_u32 m0, s98, 94464
  s_add_u32 s37, s99, 1133568
  s_mov_b32 exec_lo, 4294967295
  s_mov_b32 exec_hi, 4194303
  buffer_load_dwordx4 v248, s[12:15], s37 offen lds
  s_mov_b64 exec, -1
  v_mfma_f32_16x16x32_bf16 v[172:175], v[228:231], v[76:79], v[172:175]
  ds_read_b64_tr_b16 v[226:227], v244 offset:23104
  s_waitcnt lgkmcnt(6)
  v_mfma_f32_16x16x32_bf16 v[176:179], v[232:235], v[4:7], v[176:179]
  ds_read_b64_tr_b16 v[228:229], v244 offset:18528
  v_mfma_f32_16x16x32_bf16 v[180:183], v[232:235], v[76:79], v[180:183]
  ds_read_b64_tr_b16 v[230:231], v244 offset:23136
  s_waitcnt lgkmcnt(6)
  v_mfma_f32_16x16x32_bf16 v[144:147], v[216:219], v[8:11], v[144:147]
  ds_read_b64_tr_b16 v[232:233], v245 offset:18432
  v_mfma_f32_16x16x32_bf16 v[148:151], v[216:219], v[80:83], v[148:151]
  ds_read_b64_tr_b16 v[234:235], v245 offset:23040
  s_add_u32 m0, s98, 101376
  s_add_u32 s37, s99, 1216512
  s_mov_b32 exec_lo, 4294967295
  s_mov_b32 exec_hi, 4194303
  buffer_load_dwordx4 v248, s[12:15], s37 offen lds
  s_mov_b64 exec, -1
  s_waitcnt lgkmcnt(6)
  v_mfma_f32_16x16x32_bf16 v[152:155], v[220:223], v[8:11], v[152:155]
  ds_read_b64_tr_b16 v[216:217], v244 offset:27648
  v_mfma_f32_16x16x32_bf16 v[156:159], v[220:223], v[80:83], v[156:159]
  ds_read_b64_tr_b16 v[218:219], v244 offset:32256
  s_waitcnt lgkmcnt(6)
  v_mfma_f32_16x16x32_bf16 v[160:163], v[224:227], v[8:11], v[160:163]
  ds_read_b64_tr_b16 v[220:221], v244 offset:27680
  v_mfma_f32_16x16x32_bf16 v[164:167], v[224:227], v[80:83], v[164:167]
  ds_read_b64_tr_b16 v[222:223], v244 offset:32288
  s_waitcnt lgkmcnt(6)
  v_mfma_f32_16x16x32_bf16 v[168:171], v[228:231], v[8:11], v[168:171]
  ds_read_b64_tr_b16 v[224:225], v244 offset:27712
  s_add_u32 m0, s98, 108288
  s_add_u32 s37, s99, 1299456
  s_mov_b32 exec_lo, 4294967295
  s_mov_b32 exec_hi, 4194303
  buffer_load_dwordx4 v248, s[12:15], s37 offen lds
  s_mov_b64 exec, -1
  v_mfma_f32_16x16x32_bf16 v[172:175], v[228:231], v[80:83], v[172:175]
  ds_read_b64_tr_b16 v[226:227], v244 offset:32320
  s_waitcnt lgkmcnt(6)
  v_mfma_f32_16x16x32_bf16 v[176:179], v[232:235], v[8:11], v[176:179]
  ds_read_b64_tr_b16 v[228:229], v244 offset:27744
  v_mfma_f32_16x16x32_bf16 v[180:183], v[232:235], v[80:83], v[180:183]
  ds_read_b64_tr_b16 v[230:231], v244 offset:32352
  s_waitcnt lgkmcnt(6)
  v_mfma_f32_16x16x32_bf16 v[144:147], v[216:219], v[12:15], v[144:147]
  ds_read_b64_tr_b16 v[232:233], v245 offset:27648
  v_mfma_f32_16x16x32_bf16 v[148:151], v[216:219], v[84:87], v[148:151]
  ds_read_b64_tr_b16 v[234:235], v245 offset:32256
  s_add_u32 m0, s98, 115200
  s_add_u32 s37, s99, 1382400
  s_mov_b32 exec_lo, 4294967295
  s_mov_b32 exec_hi, 4194303
  buffer_load_dwordx4 v248, s[12:15], s37 offen lds
  s_mov_b64 exec, -1
  s_waitcnt lgkmcnt(6)
  v_mfma_f32_16x16x32_bf16 v[152:155], v[220:223], v[12:15], v[152:155]
  ds_read_b64_tr_b16 v[216:217], v246 offset:0
  v_mfma_f32_16x16x32_bf16 v[156:159], v[220:223], v[84:87], v[156:159]
  ds_read_b64_tr_b16 v[218:219], v246 offset:4608
  s_waitcnt lgkmcnt(6)
  v_mfma_f32_16x16x32_bf16 v[160:163], v[224:227], v[12:15], v[160:163]
  ds_read_b64_tr_b16 v[220:221], v246 offset:32
  v_mfma_f32_16x16x32_bf16 v[164:167], v[224:227], v[84:87], v[164:167]
  ds_read_b64_tr_b16 v[222:223], v246 offset:4640
  s_waitcnt lgkmcnt(6)
  v_mfma_f32_16x16x32_bf16 v[168:171], v[228:231], v[12:15], v[168:171]
  ds_read_b64_tr_b16 v[224:225], v246 offset:64
  s_add_u32 m0, s98, 122112
  s_add_u32 s37, s99, 1465344
  s_mov_b32 exec_lo, 4294967295
  s_mov_b32 exec_hi, 4194303
  buffer_load_dwordx4 v248, s[12:15], s37 offen lds
  s_mov_b64 exec, -1
  v_mfma_f32_16x16x32_bf16 v[172:175], v[228:231], v[84:87], v[172:175]
  ds_read_b64_tr_b16 v[226:227], v246 offset:4672
  s_waitcnt lgkmcnt(6)
  v_mfma_f32_16x16x32_bf16 v[176:179], v[232:235], v[12:15], v[176:179]
  ds_read_b64_tr_b16 v[228:229], v246 offset:96
  v_mfma_f32_16x16x32_bf16 v[180:183], v[232:235], v[84:87], v[180:183]
  ds_read_b64_tr_b16 v[230:231], v246 offset:4704
  s_waitcnt lgkmcnt(6)
  v_mfma_f32_16x16x32_bf16 v[144:147], v[216:219], v[16:19], v[144:147]
  ds_read_b64_tr_b16 v[232:233], v247 offset:0
  v_mfma_f32_16x16x32_bf16 v[148:151], v[216:219], v[88:91], v[148:151]
  ds_read_b64_tr_b16 v[234:235], v247 offset:4608
  s_add_u32 m0, s98, 129024
  s_add_u32 s37, s99, 1548288
  s_mov_b32 exec_lo, 4294967295
  s_mov_b32 exec_hi, 4194303
  buffer_load_dwordx4 v248, s[12:15], s37 offen lds
  s_mov_b64 exec, -1
  s_waitcnt lgkmcnt(6)
  v_mfma_f32_16x16x32_bf16 v[152:155], v[220:223], v[16:19], v[152:155]
  ds_read_b64_tr_b16 v[216:217], v246 offset:9216
  v_mfma_f32_16x16x32_bf16 v[156:159], v[220:223], v[88:91], v[156:159]
  ds_read_b64_tr_b16 v[218:219], v246 offset:13824
  s_waitcnt lgkmcnt(6)
  v_mfma_f32_16x16x32_bf16 v[160:163], v[224:227], v[16:19], v[160:163]
  ds_read_b64_tr_b16 v[220:221], v246 offset:9248
  v_mfma_f32_16x16x32_bf16 v[164:167], v[224:227], v[88:91], v[164:167]
  ds_read_b64_tr_b16 v[222:223], v246 offset:13856
  s_waitcnt lgkmcnt(6)
  v_mfma_f32_16x16x32_bf16 v[168:171], v[228:231], v[16:19], v[168:171]
  ds_read_b64_tr_b16 v[224:225], v246 offset:9280
  s_add_u32 m0, s98, 135936
  s_add_u32 s37, s99, 1631232
  s_mov_b32 exec_lo, 4294967295
  s_mov_b32 exec_hi, 4194303
  buffer_load_dwordx4 v248, s[12:15], s37 offen lds
  s_mov_b64 exec, -1
  v_mfma_f32_16x16x32_bf16 v[172:175], v[228:231], v[88:91], v[172:175]
  ds_read_b64_tr_b16 v[226:227], v246 offset:13888
  s_waitcnt vmcnt(9)
  v_mov_b32 v238, 147488
  v_mov_b32 v239, 1
  s_mov_b64 exec, 1
  ds_add_rtn_u32 v240, v238, v239
  s_waitcnt lgkmcnt(0)
  v_readfirstlane_b32 s36, v240
  s_nop 3
  s_cmp_lg_u32 s36, 7
  s_cbranch_scc1 L_ks58
  v_mov_b32 v238, 0
  buffer_atomic_add v239, v238, s[48:51], s46 offen
  L_ks58:
  s_mov_b64 exec, -1
  v_mfma_f32_16x16x32_bf16 v[176:179], v[232:235], v[16:19], v[176:179]
  ds_read_b64_tr_b16 v[228:229], v246 offset:9312
  v_mfma_f32_16x16x32_bf16 v[180:183], v[232:235], v[88:91], v[180:183]
  ds_read_b64_tr_b16 v[230:231], v246 offset:13920
  v_mfma_f32_16x16x32_bf16 v[144:147], v[216:219], v[20:23], v[144:147]
  ds_read_b64_tr_b16 v[232:233], v247 offset:9216
  v_mfma_f32_16x16x32_bf16 v[148:151], v[216:219], v[92:95], v[148:151]
  ds_read_b64_tr_b16 v[234:235], v247 offset:13824
  s_cmp_gt_u32 s28, 5
  s_cbranch_scc1 L_dsk56
  s_add_u32 m0, s98, 142848
  s_add_u32 s37, s99, 1714176
  s_mov_b32 exec_lo, 4294967295
  s_mov_b32 exec_hi, 4194303
  s_cmp_lg_u32 s28, 5
  s_cbranch_scc1 L_dpt57
  s_mov_b32 exec_lo, 262143
  s_mov_b32 exec_hi, 0
  L_dpt57:
  buffer_load_dwordx4 v248, s[12:15], s37 offen lds
  s_mov_b64 exec, -1
  L_dsk56:
  v_mfma_f32_16x16x32_bf16 v[152:155], v[220:223], v[20:23], v[152:155]
  ds_read_b64_tr_b16 v[216:217], v246 offset:18432
  v_mfma_f32_16x16x32_bf16 v[156:159], v[220:223], v[92:95], v[156:159]
  ds_read_b64_tr_b16 v[218:219], v246 offset:23040
  v_mfma_f32_16x16x32_bf16 v[160:163], v[224:227], v[20:23], v[160:163]
  ds_read_b64_tr_b16 v[220:221], v246 offset:18464
  v_mfma_f32_16x16x32_bf16 v[164:167], v[224:227], v[92:95], v[164:167]
  ds_read_b64_tr_b16 v[222:223], v246 offset:23072
  s_waitcnt lgkmcnt(6)
  v_mfma_f32_16x16x32_bf16 v[168:171], v[228:231], v[20:23], v[168:171]
  ds_read_b64_tr_b16 v[224:225], v246 offset:18496
  v_mfma_f32_16x16x32_bf16 v[172:175], v[228:231], v[92:95], v[172:175]
  ds_read_b64_tr_b16 v[226:227], v246 offset:23104
  s_waitcnt lgkmcnt(6)
  v_mfma_f32_16x16x32_bf16 v[176:179], v[232:235], v[20:23], v[176:179]
  ds_read_b64_tr_b16 v[228:229], v246 offset:18528
  v_mfma_f32_16x16x32_bf16 v[180:183], v[232:235], v[92:95], v[180:183]
  ds_read_b64_tr_b16 v[230:231], v246 offset:23136
  s_waitcnt lgkmcnt(6)
  v_mfma_f32_16x16x32_bf16 v[144:147], v[216:219], v[24:27], v[144:147]
  ds_read_b64_tr_b16 v[232:233], v247 offset:18432
  v_mfma_f32_16x16x32_bf16 v[148:151], v[216:219], v[96:99], v[148:151]
  ds_read_b64_tr_b16 v[234:235], v247 offset:23040
  s_waitcnt lgkmcnt(6)
  v_mfma_f32_16x16x32_bf16 v[152:155], v[220:223], v[24:27], v[152:155]
  ds_read_b64_tr_b16 v[216:217], v246 offset:27648
  v_mfma_f32_16x16x32_bf16 v[156:159], v[220:223], v[96:99], v[156:159]
  ds_read_b64_tr_b16 v[218:219], v246 offset:32256
  s_waitcnt lgkmcnt(6)
  v_mfma_f32_16x16x32_bf16 v[160:163], v[224:227], v[24:27], v[160:163]
  ds_read_b64_tr_b16 v[220:221], v246 offset:27680
  v_mfma_f32_16x16x32_bf16 v[164:167], v[224:227], v[96:99], v[164:167]
  ds_read_b64_tr_b16 v[222:223], v246 offset:32288
  s_waitcnt lgkmcnt(6)
  v_mfma_f32_16x16x32_bf16 v[168:171], v[228:231], v[24:27], v[168:171]
  ds_read_b64_tr_b16 v[224:225], v246 offset:27712
  v_mfma_f32_16x16x32_bf16 v[172:175], v[228:231], v[96:99], v[172:175]
  ds_read_b64_tr_b16 v[226:227], v246 offset:32320
  s_waitcnt lgkmcnt(6)
  v_mfma_f32_16x16x32_bf16 v[176:179], v[232:235], v[24:27], v[176:179]
  ds_read_b64_tr_b16 v[228:229], v246 offset:27744
  v_mfma_f32_16x16x32_bf16 v[180:183], v[232:235], v[96:99], v[180:183]
  ds_read_b64_tr_b16 v[230:231], v246 offset:32352
  s_waitcnt lgkmcnt(6)
  v_mfma_f32_16x16x32_bf16 v[144:147], v[216:219], v[28:31], v[144:147]
  ds_read_b64_tr_b16 v[232:233], v247 offset:27648
  v_mfma_f32_16x16x32_bf16 v[148:151], v[216:219], v[100:103], v[148:151]
  ds_read_b64_tr_b16 v[234:235], v247 offset:32256
  s_waitcnt lgkmcnt(0)
  s_waitcnt vmcnt(0)
  s_barrier
  v_add_u32 v244, 73728, v244
  v_add_u32 v245, 73728, v245
  v_add_u32 v246, 73728, v246
  v_add_u32 v247, 73728, v247
  v_mfma_f32_16x16x32_bf16 v[152:155], v[220:223], v[28:31], v[152:155]
  ds_read_b64_tr_b16 v[216:217], v244 offset:0
  v_mfma_f32_16x16x32_bf16 v[156:159], v[220:223], v[100:103], v[156:159]
  ds_read_b64_tr_b16 v[218:219], v244 offset:4608
  s_add_u32 m0, s98, 0
  s_add_u32 s37, s99, 1769472
  s_mov_b32 exec_lo, 4294967295
  s_mov_b32 exec_hi, 4194303
  buffer_load_dwordx4 v248, s[12:15], s37 offen lds
  s_mov_b64 exec, -1
  v_mfma_f32_16x16x32_bf16 v[160:163], v[224:227], v[28:31], v[160:163]
  ds_read_b64_tr_b16 v[220:221], v244 offset:32
  v_mfma_f32_16x16x32_bf16 v[164:167], v[224:227], v[100:103], v[164:167]
  ds_read_b64_tr_b16 v[222:223], v244 offset:4640
  v_mfma_f32_16x16x32_bf16 v[168:171], v[228:231], v[28:31], v[168:171]
  ds_read_b64_tr_b16 v[224:225], v244 offset:64
  s_add_u32 m0, s98, 6912
  s_add_u32 s37, s99, 1852416
  s_mov_b32 exec_lo, 4294967295
  s_mov_b32 exec_hi, 4194303
  buffer_load_dwordx4 v248, s[12:15], s37 offen lds
  s_mov_b64 exec, -1
  v_mfma_f32_16x16x32_bf16 v[172:175], v[228:231], v[100:103], v[172:175]
  ds_read_b64_tr_b16 v[226:227], v244 offset:4672
  v_mfma_f32_16x16x32_bf16 v[176:179], v[232:235], v[28:31], v[176:179]
  ds_read_b64_tr_b16 v[228:229], v244 offset:96
  v_mfma_f32_16x16x32_bf16 v[180:183], v[232:235], v[100:103], v[180:183]
  ds_read_b64_tr_b16 v[230:231], v244 offset:4704
  s_cmp_gt_u32 s28, 5
  s_cbranch_scc1 L_dsk59
  s_add_u32 m0, s98, 13824
  s_add_u32 s37, s99, 1935360
  s_mov_b32 exec_lo, 4294967295
  s_mov_b32 exec_hi, 4194303
  s_cmp_lg_u32 s28, 5
  s_cbranch_scc1 L_dpt60
  s_mov_b32 exec_lo, 262143
  s_mov_b32 exec_hi, 0
  L_dpt60:
  buffer_load_dwordx4 v248, s[12:15], s37 offen lds
  s_mov_b64 exec, -1
  L_dsk59:
  s_waitcnt lgkmcnt(6)
  v_mfma_f32_16x16x32_bf16 v[144:147], v[216:219], v[32:35], v[144:147]
  ds_read_b64_tr_b16 v[232:233], v245 offset:0
  v_mfma_f32_16x16x32_bf16 v[148:151], v[216:219], v[104:107], v[148:151]
  ds_read_b64_tr_b16 v[234:235], v245 offset:4608
  s_waitcnt lgkmcnt(6)
  v_mfma_f32_16x16x32_bf16 v[152:155], v[220:223], v[32:35], v[152:155]
  ds_read_b64_tr_b16 v[216:217], v244 offset:9216
  v_mfma_f32_16x16x32_bf16 v[156:159], v[220:223], v[104:107], v[156:159]
  ds_read_b64_tr_b16 v[218:219], v244 offset:13824
  s_waitcnt lgkmcnt(6)
  v_mfma_f32_16x16x32_bf16 v[160:163], v[224:227], v[32:35], v[160:163]
  ds_read_b64_tr_b16 v[220:221], v244 offset:9248
  v_mfma_f32_16x16x32_bf16 v[164:167], v[224:227], v[104:107], v[164:167]
  ds_read_b64_tr_b16 v[222:223], v244 offset:13856
  s_waitcnt lgkmcnt(6)
  v_mfma_f32_16x16x32_bf16 v[168:171], v[228:231], v[32:35], v[168:171]
  ds_read_b64_tr_b16 v[224:225], v244 offset:9280
  v_mfma_f32_16x16x32_bf16 v[172:175], v[228:231], v[104:107], v[172:175]
  ds_read_b64_tr_b16 v[226:227], v244 offset:13888
  s_waitcnt lgkmcnt(6)
  v_mfma_f32_16x16x32_bf16 v[176:179], v[232:235], v[32:35], v[176:179]
  ds_read_b64_tr_b16 v[228:229], v244 offset:9312
  v_mfma_f32_16x16x32_bf16 v[180:183], v[232:235], v[104:107], v[180:183]
  ds_read_b64_tr_b16 v[230:231], v244 offset:13920
  s_waitcnt lgkmcnt(6)
  v_mfma_f32_16x16x32_bf16 v[144:147], v[216:219], v[36:39], v[144:147]
  ds_read_b64_tr_b16 v[232:233], v245 offset:9216
  v_mfma_f32_16x16x32_bf16 v[148:151], v[216:219], v[108:111], v[148:151]
  ds_read_b64_tr_b16 v[234:235], v245 offset:13824
  s_waitcnt lgkmcnt(6)
  v_mfma_f32_16x16x32_bf16 v[152:155], v[220:223], v[36:39], v[152:155]
  ds_read_b64_tr_b16 v[216:217], v244 offset:18432
  v_mfma_f32_16x16x32_bf16 v[156:159], v[220:223], v[108:111], v[156:159]
  ds_read_b64_tr_b16 v[218:219], v244 offset:23040
  s_waitcnt lgkmcnt(6)
  v_mfma_f32_16x16x32_bf16 v[160:163], v[224:227], v[36:39], v[160:163]
  ds_read_b64_tr_b16 v[220:221], v244 offset:18464
  v_mfma_f32_16x16x32_bf16 v[164:167], v[224:227], v[108:111], v[164:167]
  ds_read_b64_tr_b16 v[222:223], v244 offset:23072
  s_waitcnt lgkmcnt(6)
  v_mfma_f32_16x16x32_bf16 v[168:171], v[228:231], v[36:39], v[168:171]
  ds_read_b64_tr_b16 v[224:225], v244 offset:18496
  v_mfma_f32_16x16x32_bf16 v[172:175], v[228:231], v[108:111], v[172:175]
  ds_read_b64_tr_b16 v[226:227], v244 offset:23104
  s_waitcnt lgkmcnt(6)
  v_mfma_f32_16x16x32_bf16 v[176:179], v[232:235], v[36:39], v[176:179]
  ds_read_b64_tr_b16 v[228:229], v244 offset:18528
  v_mfma_f32_16x16x32_bf16 v[180:183], v[232:235], v[108:111], v[180:183]
  ds_read_b64_tr_b16 v[230:231], v244 offset:23136
  s_waitcnt lgkmcnt(6)
  v_mfma_f32_16x16x32_bf16 v[144:147], v[216:219], v[40:43], v[144:147]
  ds_read_b64_tr_b16 v[232:233], v245 offset:18432
  v_mfma_f32_16x16x32_bf16 v[148:151], v[216:219], v[112:115], v[148:151]
  ds_read_b64_tr_b16 v[234:235], v245 offset:23040
  s_waitcnt lgkmcnt(6)
  v_mfma_f32_16x16x32_bf16 v[152:155], v[220:223], v[40:43], v[152:155]
  ds_read_b64_tr_b16 v[216:217], v244 offset:27648
  v_mfma_f32_16x16x32_bf16 v[156:159], v[220:223], v[112:115], v[156:159]
  ds_read_b64_tr_b16 v[218:219], v244 offset:32256
  s_waitcnt lgkmcnt(6)
  v_mfma_f32_16x16x32_bf16 v[160:163], v[224:227], v[40:43], v[160:163]
  ds_read_b64_tr_b16 v[220:221], v244 offset:27680
  v_mfma_f32_16x16x32_bf16 v[164:167], v[224:227], v[112:115], v[164:167]
  ds_read_b64_tr_b16 v[222:223], v244 offset:32288
  s_waitcnt lgkmcnt(6)
  v_mfma_f32_16x16x32_bf16 v[168:171], v[228:231], v[40:43], v[168:171]
  ds_read_b64_tr_b16 v[224:225], v244 offset:27712
  v_mfma_f32_16x16x32_bf16 v[172:175], v[228:231], v[112:115], v[172:175]
  ds_read_b64_tr_b16 v[226:227], v244 offset:32320
  s_waitcnt lgkmcnt(6)
  v_mfma_f32_16x16x32_bf16 v[176:179], v[232:235], v[40:43], v[176:179]
  ds_read_b64_tr_b16 v[228:229], v244 offset:27744
  v_mfma_f32_16x16x32_bf16 v[180:183], v[232:235], v[112:115], v[180:183]
  ds_read_b64_tr_b16 v[230:231], v244 offset:32352
  s_waitcnt lgkmcnt(6)
  v_mfma_f32_16x16x32_bf16 v[144:147], v[216:219], v[44:47], v[144:147]
  ds_read_b64_tr_b16 v[232:233], v245 offset:27648
  v_mfma_f32_16x16x32_bf16 v[148:151], v[216:219], v[116:119], v[148:151]
  ds_read_b64_tr_b16 v[234:235], v245 offset:32256
  s_waitcnt lgkmcnt(6)
  v_mfma_f32_16x16x32_bf16 v[152:155], v[220:223], v[44:47], v[152:155]
  ds_read_b64_tr_b16 v[216:217], v246 offset:0
  v_mfma_f32_16x16x32_bf16 v[156:159], v[220:223], v[116:119], v[156:159]
  ds_read_b64_tr_b16 v[218:219], v246 offset:4608
  s_waitcnt lgkmcnt(6)
  v_mfma_f32_16x16x32_bf16 v[160:163], v[224:227], v[44:47], v[160:163]
  ds_read_b64_tr_b16 v[220:221], v246 offset:32
  v_mfma_f32_16x16x32_bf16 v[164:167], v[224:227], v[116:119], v[164:167]
  ds_read_b64_tr_b16 v[222:223], v246 offset:4640
  s_waitcnt lgkmcnt(6)
  v_mfma_f32_16x16x32_bf16 v[168:171], v[228:231], v[44:47], v[168:171]
  ds_read_b64_tr_b16 v[224:225], v246 offset:64
  v_mfma_f32_16x16x32_bf16 v[172:175], v[228:231], v[116:119], v[172:175]
  ds_read_b64_tr_b16 v[226:227], v246 offset:4672
  s_waitcnt lgkmcnt(6)
  v_mfma_f32_16x16x32_bf16 v[176:179], v[232:235], v[44:47], v[176:179]
  ds_read_b64_tr_b16 v[228:229], v246 offset:96
  v_mfma_f32_16x16x32_bf16 v[180:183], v[232:235], v[116:119], v[180:183]
  ds_read_b64_tr_b16 v[230:231], v246 offset:4704
  s_waitcnt lgkmcnt(6)
  v_mfma_f32_16x16x32_bf16 v[144:147], v[216:219], v[48:51], v[144:147]
  ds_read_b64_tr_b16 v[232:233], v247 offset:0
  v_mfma_f32_16x16x32_bf16 v[148:151], v[216:219], v[120:123], v[148:151]
  ds_read_b64_tr_b16 v[234:235], v247 offset:4608
  s_waitcnt lgkmcnt(6)
  v_mfma_f32_16x16x32_bf16 v[152:155], v[220:223], v[48:51], v[152:155]
  ds_read_b64_tr_b16 v[216:217], v246 offset:9216
  v_mfma_f32_16x16x32_bf16 v[156:159], v[220:223], v[120:123], v[156:159]
  ds_read_b64_tr_b16 v[218:219], v246 offset:13824
  s_waitcnt lgkmcnt(6)
  v_mfma_f32_16x16x32_bf16 v[160:163], v[224:227], v[48:51], v[160:163]
  ds_read_b64_tr_b16 v[220:221], v246 offset:9248
  v_mfma_f32_16x16x32_bf16 v[164:167], v[224:227], v[120:123], v[164:167]
  ds_read_b64_tr_b16 v[222:223], v246 offset:13856
  s_cmp_lg_u32 s28, 0
  s_cbranch_scc1 L_pw61
  v_mov_b32 v240, 0
  buffer_load_dword v240, v240, s[48:51], s46 offen sc1
  L_pw61:
  s_waitcnt lgkmcnt(6)
  v_mfma_f32_16x16x32_bf16 v[168:171], v[228:231], v[48:51], v[168:171]
  ds_read_b64_tr_b16 v[224:225], v246 offset:9280
  v_mfma_f32_16x16x32_bf16 v[172:175], v[228:231], v[120:123], v[172:175]
  ds_read_b64_tr_b16 v[226:227], v246 offset:13888
  s_waitcnt lgkmcnt(6)
  v_mfma_f32_16x16x32_bf16 v[176:179], v[232:235], v[48:51], v[176:179]
  ds_read_b64_tr_b16 v[228:229], v246 offset:9312
  v_mfma_f32_16x16x32_bf16 v[180:183], v[232:235], v[120:123], v[180:183]
  ds_read_b64_tr_b16 v[230:231], v246 offset:13920
  s_waitcnt lgkmcnt(6)
  v_mfma_f32_16x16x32_bf16 v[144:147], v[216:219], v[52:55], v[144:147]
  ds_read_b64_tr_b16 v[232:233], v247 offset:9216
  v_mfma_f32_16x16x32_bf16 v[148:151], v[216:219], v[124:127], v[148:151]
  ds_read_b64_tr_b16 v[234:235], v247 offset:13824
  s_waitcnt lgkmcnt(6)
  v_mfma_f32_16x16x32_bf16 v[152:155], v[220:223], v[52:55], v[152:155]
  ds_read_b64_tr_b16 v[216:217], v246 offset:18432
  v_mfma_f32_16x16x32_bf16 v[156:159], v[220:223], v[124:127], v[156:159]
  ds_read_b64_tr_b16 v[218:219], v246 offset:23040
  s_waitcnt lgkmcnt(6)
  v_mfma_f32_16x16x32_bf16 v[160:163], v[224:227], v[52:55], v[160:163]
  ds_read_b64_tr_b16 v[220:221], v246 offset:18464
  v_mfma_f32_16x16x32_bf16 v[164:167], v[224:227], v[124:127], v[164:167]
  ds_read_b64_tr_b16 v[222:223], v246 offset:23072
  s_waitcnt lgkmcnt(6)
  v_mfma_f32_16x16x32_bf16 v[168:171], v[228:231], v[52:55], v[168:171]
  ds_read_b64_tr_b16 v[224:225], v246 offset:18496
  v_mfma_f32_16x16x32_bf16 v[172:175], v[228:231], v[124:127], v[172:175]
  ds_read_b64_tr_b16 v[226:227], v246 offset:23104
  s_waitcnt lgkmcnt(6)
  v_mfma_f32_16x16x32_bf16 v[176:179], v[232:235], v[52:55], v[176:179]
  ds_read_b64_tr_b16 v[228:229], v246 offset:18528
  v_mfma_f32_16x16x32_bf16 v[180:183], v[232:235], v[124:127], v[180:183]
  ds_read_b64_tr_b16 v[230:231], v246 offset:23136
  s_waitcnt lgkmcnt(6)
  v_mfma_f32_16x16x32_bf16 v[144:147], v[216:219], v[56:59], v[144:147]
  ds_read_b64_tr_b16 v[232:233], v247 offset:18432
  v_mfma_f32_16x16x32_bf16 v[148:151], v[216:219], v[128:131], v[148:151]
  ds_read_b64_tr_b16 v[234:235], v247 offset:23040
  s_waitcnt lgkmcnt(6)
  v_mfma_f32_16x16x32_bf16 v[152:155], v[220:223], v[56:59], v[152:155]
  ds_read_b64_tr_b16 v[216:217], v246 offset:27648
  v_mfma_f32_16x16x32_bf16 v[156:159], v[220:223], v[128:131], v[156:159]
  ds_read_b64_tr_b16 v[218:219], v246 offset:32256
  s_waitcnt lgkmcnt(6)
  v_mfma_f32_16x16x32_bf16 v[160:163], v[224:227], v[56:59], v[160:163]
  ds_read_b64_tr_b16 v[220:221], v246 offset:27680
  v_mfma_f32_16x16x32_bf16 v[164:167], v[224:227], v[128:131], v[164:167]
  ds_read_b64_tr_b16 v[222:223], v246 offset:32288
  s_waitcnt lgkmcnt(6)
  v_mfma_f32_16x16x32_bf16 v[168:171], v[228:231], v[56:59], v[168:171]
  ds_read_b64_tr_b16 v[224:225], v246 offset:27712
  v_mfma_f32_16x16x32_bf16 v[172:175], v[228:231], v[128:131], v[172:175]
  ds_read_b64_tr_b16 v[226:227], v246 offset:32320
  s_waitcnt lgkmcnt(6)
  v_mfma_f32_16x16x32_bf16 v[176:179], v[232:235], v[56:59], v[176:179]
  ds_read_b64_tr_b16 v[228:229], v246 offset:27744
  v_mfma_f32_16x16x32_bf16 v[180:183], v[232:235], v[128:131], v[180:183]
  ds_read_b64_tr_b16 v[230:231], v246 offset:32352
  s_waitcnt lgkmcnt(6)
  v_mfma_f32_16x16x32_bf16 v[144:147], v[216:219], v[60:63], v[144:147]
  ds_read_b64_tr_b16 v[232:233], v247 offset:27648
  v_mfma_f32_16x16x32_bf16 v[148:151], v[216:219], v[132:135], v[148:151]
  ds_read_b64_tr_b16 v[234:235], v247 offset:32256
  s_waitcnt lgkmcnt(0)
  s_waitcnt vmcnt(0)
  s_cmp_lg_u32 s28, 0
  s_cbranch_scc1 L_pb62
  v_mov_b32 v239, 147456
  ds_write_b32 v239, v240
  L_pb62:
  s_waitcnt lgkmcnt(0)
  s_barrier
  v_add_u32 v244, 4294893568, v244
  v_add_u32 v245, 4294893568, v245
  v_add_u32 v246, 4294893568, v246
  v_add_u32 v247, 4294893568, v247
  v_mov_b32 v239, 147456
  ds_read_b32 v240, v239
  s_waitcnt lgkmcnt(0)
  v_readfirstlane_b32 s60, v240
  s_nop 3
  s_cmp_ge_u32 s60, 16
  s_cselect_b32 s60, 1, 0
  s_cbranch_scc0 L_kt63
  v_lshlrev_b32 v249, 4, v255
  v_lshrrev_b32 v250, 4, v255
  v_lshlrev_b32 v250, 4, v250
  s_cmp_lg_u32 s31, 0
  s_cbranch_scc1 L_tgn65
  s_add_u32 s35, s40, 0
  buffer_load_dwordx4 v[0:3], v249, s[20:23], s35 offen sc1
  s_add_u32 s35, s40, 2048
  buffer_load_dwordx4 v[4:7], v249, s[20:23], s35 offen sc1
  s_add_u32 s35, s40, 1024
  buffer_load_dwordx4 v[8:11], v249, s[20:23], s35 offen sc1
  s_add_u32 s35, s40, 3072
  buffer_load_dwordx4 v[12:15], v249, s[20:23], s35 offen sc1
  s_add_u32 s35, s40, 13312
  buffer_load_dwordx4 v[16:19], v250, s[20:23], s35 offen sc1
  s_add_u32 s35, s40, 14336
  buffer_load_dwordx4 v[20:23], v250, s[20:23], s35 offen sc1
  s_branch L_tgv64
  L_tgn65:
  s_cmp_lg_u32 s31, 1
  s_cbranch_scc1 L_tgn66
  s_add_u32 s35, s40, 5120
  buffer_load_dwordx4 v[0:3], v249, s[20:23], s35 offen sc1
  s_add_u32 s35, s40, 4096
  buffer_load_dwordx4 v[4:7], v249, s[20:23], s35 offen sc1
  s_add_u32 s35, s40, 15360
  buffer_load_dwordx4 v[16:19], v250, s[20:23], s35 offen sc1
  s_add_u32 s35, s40, 14336
  buffer_load_dwordx4 v[20:23], v250, s[20:23], s35 offen sc1
  s_branch L_tgv64
  L_tgn66:
  s_cmp_lg_u32 s31, 2
  s_cbranch_scc1 L_tgn67
  s_add_u32 s35, s40, 6144
  buffer_load_dwordx4 v[0:3], v249, s[20:23], s35 offen sc1
  s_add_u32 s35, s40, 8192
  buffer_load_dwordx4 v[4:7], v249, s[20:23], s35 offen sc1
  s_add_u32 s35, s40, 7168
  buffer_load_dwordx4 v[8:11], v249, s[20:23], s35 offen sc1
  s_add_u32 s35, s40, 9216
  buffer_load_dwordx4 v[12:15], v249, s[20:23], s35 offen sc1
  s_add_u32 s35, s40, 15360
  buffer_load_dwordx4 v[16:19], v250, s[20:23], s35 offen sc1
  s_add_u32 s35, s40, 16384
  buffer_load_dwordx4 v[20:23], v250, s[20:23], s35 offen sc1
  s_branch L_tgv64
  L_tgn67:
  s_add_u32 s35, s40, 11264
  buffer_load_dwordx4 v[0:3], v249, s[20:23], s35 offen sc1
  s_add_u32 s35, s40, 10240
  buffer_load_dwordx4 v[4:7], v249, s[20:23], s35 offen sc1
  s_add_u32 s35, s40, 12288
  buffer_load_dwordx4 v[8:11], v249, s[20:23], s35 offen sc1
  s_add_u32 s35, s40, 17408
  buffer_load_dwordx4 v[16:19], v250, s[20:23], s35 offen sc1
  s_add_u32 s35, s40, 16384
  buffer_load_dwordx4 v[20:23], v250, s[20:23], s35 offen sc1
  L_tgv64:
  L_kt63:
  v_mfma_f32_16x16x32_bf16 v[152:155], v[220:223], v[60:63], v[152:155]
  ds_read_b64_tr_b16 v[216:217], v244 offset:0
  v_mfma_f32_16x16x32_bf16 v[156:159], v[220:223], v[132:135], v[156:159]
  ds_read_b64_tr_b16 v[218:219], v244 offset:4608
  s_add_u32 m0, s38, 73728
  s_movk_i32 s37, 0
  buffer_load_dwordx4 v241, s[16:19], s37 offen lds
  v_mfma_f32_16x16x32_bf16 v[160:163], v[224:227], v[60:63], v[160:163]
  ds_read_b64_tr_b16 v[220:221], v244 offset:32
  v_mfma_f32_16x16x32_bf16 v[164:167], v[224:227], v[132:135], v[164:167]
  ds_read_b64_tr_b16 v[222:223], v244 offset:4640
  v_mfma_f32_16x16x32_bf16 v[168:171], v[228:231], v[60:63], v[168:171]
  ds_read_b64_tr_b16 v[224:225], v244 offset:64
  s_add_u32 m0, s38, 81920
  s_movk_i32 s37, 0
  buffer_load_dwordx4 v242, s[16:19], s37 offen lds
  v_mfma_f32_16x16x32_bf16 v[172:175], v[228:231], v[132:135], v[172:175]
  ds_read_b64_tr_b16 v[226:227], v244 offset:4672
  v_mfma_f32_16x16x32_bf16 v[176:179], v[232:235], v[60:63], v[176:179]
  ds_read_b64_tr_b16 v[228:229], v244 offset:96
  v_mfma_f32_16x16x32_bf16 v[180:183], v[232:235], v[132:135], v[180:183]
  ds_read_b64_tr_b16 v[230:231], v244 offset:4704
  s_add_u32 m0, s38, 90112
  s_movk_i32 s37, 0
  buffer_load_dwordx4 v243, s[16:19], s37 offen lds
  s_waitcnt lgkmcnt(6)
  v_mfma_f32_16x16x32_bf16 v[144:147], v[216:219], v[64:67], v[144:147]
  ds_read_b64_tr_b16 v[232:233], v245 offset:0
  v_mfma_f32_16x16x32_bf16 v[148:151], v[216:219], v[136:139], v[148:151]
  ds_read_b64_tr_b16 v[234:235], v245 offset:4608
  s_waitcnt lgkmcnt(6)
  v_mfma_f32_16x16x32_bf16 v[152:155], v[220:223], v[64:67], v[152:155]
  ds_read_b64_tr_b16 v[216:217], v244 offset:9216
  v_mfma_f32_16x16x32_bf16 v[156:159], v[220:223], v[136:139], v[156:159]
  ds_read_b64_tr_b16 v[218:219], v244 offset:13824
  s_waitcnt lgkmcnt(6)
  v_mfma_f32_16x16x32_bf16 v[160:163], v[224:227], v[64:67], v[160:163]
  ds_read_b64_tr_b16 v[220:221], v244 offset:9248
  v_mfma_f32_16x16x32_bf16 v[164:167], v[224:227], v[136:139], v[164:167]
  ds_read_b64_tr_b16 v[222:223], v244 offset:13856
  s_waitcnt lgkmcnt(6)
  v_mfma_f32_16x16x32_bf16 v[168:171], v[228:231], v[64:67], v[168:171]
  ds_read_b64_tr_b16 v[224:225], v244 offset:9280
  v_mfma_f32_16x16x32_bf16 v[172:175], v[228:231], v[136:139], v[172:175]
  ds_read_b64_tr_b16 v[226:227], v244 offset:13888
  s_waitcnt lgkmcnt(6)
  v_mfma_f32_16x16x32_bf16 v[176:179], v[232:235], v[64:67], v[176:179]
  ds_read_b64_tr_b16 v[228:229], v244 offset:9312
  v_mfma_f32_16x16x32_bf16 v[180:183], v[232:235], v[136:139], v[180:183]
  ds_read_b64_tr_b16 v[230:231], v244 offset:13920
  s_waitcnt lgkmcnt(6)
  v_mfma_f32_16x16x32_bf16 v[144:147], v[216:219], v[68:71], v[144:147]
  ds_read_b64_tr_b16 v[232:233], v245 offset:9216
  v_mfma_f32_16x16x32_bf16 v[148:151], v[216:219], v[140:143], v[148:151]
  ds_read_b64_tr_b16 v[234:235], v245 offset:13824
  s_waitcnt lgkmcnt(6)
  v_mfma_f32_16x16x32_bf16 v[152:155], v[220:223], v[68:71], v[152:155]
  v_mfma_f32_16x16x32_bf16 v[156:159], v[220:223], v[140:143], v[156:159]
  s_waitcnt lgkmcnt(4)
  v_mfma_f32_16x16x32_bf16 v[160:163], v[224:227], v[68:71], v[160:163]
  v_mfma_f32_16x16x32_bf16 v[164:167], v[224:227], v[140:143], v[164:167]
  s_waitcnt lgkmcnt(2)
  v_mfma_f32_16x16x32_bf16 v[168:171], v[228:231], v[68:71], v[168:171]
  v_mfma_f32_16x16x32_bf16 v[172:175], v[228:231], v[140:143], v[172:175]
  s_waitcnt lgkmcnt(0)
  v_mfma_f32_16x16x32_bf16 v[176:179], v[232:235], v[68:71], v[176:179]
  v_mfma_f32_16x16x32_bf16 v[180:183], v[232:235], v[140:143], v[180:183]
  s_barrier
  s_cmp_eq_u32 s60, 1
  s_cbranch_scc1 L_kt269
  s_cmp_lg_u32 s28, 0
  s_cbranch_scc1 L_kw70
  v_mov_b32 v240, 0
  buffer_load_dword v240, v240, s[48:51], s46 offen sc1
  s_waitcnt vmcnt(0)
  s_mov_b32 s52, 0
L_pc71:
  v_readfirstlane_b32 s36, v240
  s_add_u32 s52, s52, 1
  s_nop 3
  s_cmp_ge_u32 s36, 16
  s_cbranch_scc1 L_pcd72
  s_cmp_ge_u32 s52, 0x40000
  s_cbranch_scc1 L_pcd72
  s_sleep 4
  v_mov_b32 v240, 0
  buffer_load_dword v240, v240, s[48:51], s46 offen sc1
  s_waitcnt vmcnt(0)
  s_branch L_pc71
L_pcd72:
L_kw70:
  s_barrier
  v_lshlrev_b32 v249, 4, v255
  v_lshrrev_b32 v250, 4, v255
  v_lshlrev_b32 v250, 4, v250
  s_cmp_lg_u32 s31, 0
  s_cbranch_scc1 L_tgn74
  s_add_u32 s35, s40, 0
  buffer_load_dwordx4 v[0:3], v249, s[20:23], s35 offen sc1
  s_add_u32 s35, s40, 2048
  buffer_load_dwordx4 v[4:7], v249, s[20:23], s35 offen sc1
  s_add_u32 s35, s40, 1024
  buffer_load_dwordx4 v[8:11], v249, s[20:23], s35 offen sc1
  s_add_u32 s35, s40, 3072
  buffer_load_dwordx4 v[12:15], v249, s[20:23], s35 offen sc1
  s_add_u32 s35, s40, 13312
  buffer_load_dwordx4 v[16:19], v250, s[20:23], s35 offen sc1
  s_add_u32 s35, s40, 14336
  buffer_load_dwordx4 v[20:23], v250, s[20:23], s35 offen sc1
  s_branch L_tgv73
L_tgn74:
  s_cmp_lg_u32 s31, 1
  s_cbranch_scc1 L_tgn75
  s_add_u32 s35, s40, 5120
  buffer_load_dwordx4 v[0:3], v249, s[20:23], s35 offen sc1
  s_add_u32 s35, s40, 4096
  buffer_load_dwordx4 v[4:7], v249, s[20:23], s35 offen sc1
  s_add_u32 s35, s40, 15360
  buffer_load_dwordx4 v[16:19], v250, s[20:23], s35 offen sc1
  s_add_u32 s35, s40, 14336
  buffer_load_dwordx4 v[20:23], v250, s[20:23], s35 offen sc1
  s_branch L_tgv73
L_tgn75:
  s_cmp_lg_u32 s31, 2
  s_cbranch_scc1 L_tgn76
  s_add_u32 s35, s40, 6144
  buffer_load_dwordx4 v[0:3], v249, s[20:23], s35 offen sc1
  s_add_u32 s35, s40, 8192
  buffer_load_dwordx4 v[4:7], v249, s[20:23], s35 offen sc1
  s_add_u32 s35, s40, 7168
  buffer_load_dwordx4 v[8:11], v249, s[20:23], s35 offen sc1
  s_add_u32 s35, s40, 9216
  buffer_load_dwordx4 v[12:15], v249, s[20:23], s35 offen sc1
  s_add_u32 s35, s40, 15360
  buffer_load_dwordx4 v[16:19], v250, s[20:23], s35 offen sc1
  s_add_u32 s35, s40, 16384
  buffer_load_dwordx4 v[20:23], v250, s[20:23], s35 offen sc1
  s_branch L_tgv73
L_tgn76:
  s_add_u32 s35, s40, 11264
  buffer_load_dwordx4 v[0:3], v249, s[20:23], s35 offen sc1
  s_add_u32 s35, s40, 10240
  buffer_load_dwordx4 v[4:7], v249, s[20:23], s35 offen sc1
  s_add_u32 s35, s40, 12288
  buffer_load_dwordx4 v[8:11], v249, s[20:23], s35 offen sc1
  s_add_u32 s35, s40, 17408
  buffer_load_dwordx4 v[16:19], v250, s[20:23], s35 offen sc1
  s_add_u32 s35, s40, 16384
  buffer_load_dwordx4 v[20:23], v250, s[20:23], s35 offen sc1
L_tgv73:
L_kt269:
  v_pk_mul_f32 v[232:233], v[144:145], s[54:55]
  v_pk_mul_f32 v[236:237], v[148:149], s[54:55]
  v_pk_mul_f32 v[234:235], v[146:147], s[54:55]
  v_pk_mul_f32 v[238:239], v[150:151], s[54:55]
  v_exp_f32_e64 v232, v232 clamp
  v_exp_f32_e64 v236, v236 clamp
  v_exp_f32_e64 v233, v233 clamp
  v_exp_f32_e64 v237, v237 clamp
  v_exp_f32_e64 v234, v234 clamp
  v_exp_f32_e64 v238, v238 clamp
  v_exp_f32_e64 v235, v235 clamp
  v_exp_f32_e64 v239, v239 clamp
  v_max_f32 v144, 0, v144
  v_max_f32 v148, 0, v148
  v_max_f32 v145, 0, v145
  v_max_f32 v149, 0, v149
  v_max_f32 v146, 0, v146
  v_max_f32 v150, 0, v150
  v_max_f32 v147, 0, v147
  v_max_f32 v151, 0, v151
  v_pk_add_f32 v[144:145], v[144:145], s[56:57]
  v_pk_add_f32 v[148:149], v[148:149], s[56:57]
  v_pk_add_f32 v[146:147], v[146:147], s[56:57]
  v_pk_add_f32 v[150:151], v[150:151], s[56:57]
  v_pk_add_f32 v[144:145], v[144:145], v[232:233]
  v_pk_add_f32 v[148:149], v[148:149], v[236:237]
  v_pk_add_f32 v[146:147], v[146:147], v[234:235]
  v_pk_add_f32 v[150:151], v[150:151], v[238:239]
  v_cvt_pk_bf16_f32 v184, v144, v145
  v_cvt_pk_bf16_f32 v185, v146, v147
  v_cvt_pk_bf16_f32 v188, v148, v149
  v_cvt_pk_bf16_f32 v189, v150, v151
  v_pk_mul_f32 v[232:233], v[152:153], s[54:55]
  v_pk_mul_f32 v[236:237], v[156:157], s[54:55]
  v_pk_mul_f32 v[234:235], v[154:155], s[54:55]
  v_pk_mul_f32 v[238:239], v[158:159], s[54:55]
  v_exp_f32_e64 v232, v232 clamp
  v_exp_f32_e64 v236, v236 clamp
  v_exp_f32_e64 v233, v233 clamp
  v_exp_f32_e64 v237, v237 clamp
  v_exp_f32_e64 v234, v234 clamp
  v_exp_f32_e64 v238, v238 clamp
  v_exp_f32_e64 v235, v235 clamp
  v_exp_f32_e64 v239, v239 clamp
  v_max_f32 v152, 0, v152
  v_max_f32 v156, 0, v156
  v_max_f32 v153, 0, v153
  v_max_f32 v157, 0, v157
  v_max_f32 v154, 0, v154
  v_max_f32 v158, 0, v158
  v_max_f32 v155, 0, v155
  v_max_f32 v159, 0, v159
  v_pk_add_f32 v[152:153], v[152:153], s[56:57]
  v_pk_add_f32 v[156:157], v[156:157], s[56:57]
  v_pk_add_f32 v[154:155], v[154:155], s[56:57]
  v_pk_add_f32 v[158:159], v[158:159], s[56:57]
  v_pk_add_f32 v[152:153], v[152:153], v[232:233]
  v_pk_add_f32 v[156:157], v[156:157], v[236:237]
  v_pk_add_f32 v[154:155], v[154:155], v[234:235]
  v_pk_add_f32 v[158:159], v[158:159], v[238:239]
  v_cvt_pk_bf16_f32 v186, v152, v153
  v_cvt_pk_bf16_f32 v187, v154, v155
  v_cvt_pk_bf16_f32 v190, v156, v157
  v_cvt_pk_bf16_f32 v191, v158, v159
  v_pk_mul_f32 v[232:233], v[160:161], s[54:55]
  v_pk_mul_f32 v[236:237], v[164:165], s[54:55]
  v_pk_mul_f32 v[234:235], v[162:163], s[54:55]
  v_pk_mul_f32 v[238:239], v[166:167], s[54:55]
  v_exp_f32_e64 v232, v232 clamp
  v_exp_f32_e64 v236, v236 clamp
  v_exp_f32_e64 v233, v233 clamp
  v_exp_f32_e64 v237, v237 clamp
  v_exp_f32_e64 v234, v234 clamp
  v_exp_f32_e64 v238, v238 clamp
  v_exp_f32_e64 v235, v235 clamp
  v_exp_f32_e64 v239, v239 clamp
  v_max_f32 v160, 0, v160
  v_max_f32 v164, 0, v164
  v_max_f32 v161, 0, v161
  v_max_f32 v165, 0, v165
  v_max_f32 v162, 0, v162
  v_max_f32 v166, 0, v166
  v_max_f32 v163, 0, v163
  v_max_f32 v167, 0, v167
  v_pk_add_f32 v[160:161], v[160:161], s[56:57]
  v_pk_add_f32 v[164:165], v[164:165], s[56:57]
  v_pk_add_f32 v[162:163], v[162:163], s[56:57]
  v_pk_add_f32 v[166:167], v[166:167], s[56:57]
  v_pk_add_f32 v[160:161], v[160:161], v[232:233]
  v_pk_add_f32 v[164:165], v[164:165], v[236:237]
  v_pk_add_f32 v[162:163], v[162:163], v[234:235]
  v_pk_add_f32 v[166:167], v[166:167], v[238:239]
  v_cvt_pk_bf16_f32 v192, v160, v161
  v_cvt_pk_bf16_f32 v193, v162, v163
  v_cvt_pk_bf16_f32 v196, v164, v165
  v_cvt_pk_bf16_f32 v197, v166, v167
  v_pk_mul_f32 v[232:233], v[168:169], s[54:55]
  v_pk_mul_f32 v[236:237], v[172:173], s[54:55]
  v_pk_mul_f32 v[234:235], v[170:171], s[54:55]
  v_pk_mul_f32 v[238:239], v[174:175], s[54:55]
  v_exp_f32_e64 v232, v232 clamp
  v_exp_f32_e64 v236, v236 clamp
  v_exp_f32_e64 v233, v233 clamp
  v_exp_f32_e64 v237, v237 clamp
  v_exp_f32_e64 v234, v234 clamp
  v_exp_f32_e64 v238, v238 clamp
  v_exp_f32_e64 v235, v235 clamp
  v_exp_f32_e64 v239, v239 clamp
  v_max_f32 v168, 0, v168
  v_max_f32 v172, 0, v172
  v_max_f32 v169, 0, v169
  v_max_f32 v173, 0, v173
  v_max_f32 v170, 0, v170
  v_max_f32 v174, 0, v174
  v_max_f32 v171, 0, v171
  v_max_f32 v175, 0, v175
  v_pk_add_f32 v[168:169], v[168:169], s[56:57]
  v_pk_add_f32 v[172:173], v[172:173], s[56:57]
  v_pk_add_f32 v[170:171], v[170:171], s[56:57]
  v_pk_add_f32 v[174:175], v[174:175], s[56:57]
  v_pk_add_f32 v[168:169], v[168:169], v[232:233]
  v_pk_add_f32 v[172:173], v[172:173], v[236:237]
  v_pk_add_f32 v[170:171], v[170:171], v[234:235]
  v_pk_add_f32 v[174:175], v[174:175], v[238:239]
  v_cvt_pk_bf16_f32 v194, v168, v169
  v_cvt_pk_bf16_f32 v195, v170, v171
  v_cvt_pk_bf16_f32 v198, v172, v173
  v_cvt_pk_bf16_f32 v199, v174, v175
  v_pk_mul_f32 v[232:233], v[176:177], s[54:55]
  v_pk_mul_f32 v[236:237], v[180:181], s[54:55]
  v_pk_mul_f32 v[234:235], v[178:179], s[54:55]
  v_pk_mul_f32 v[238:239], v[182:183], s[54:55]
  v_exp_f32_e64 v232, v232 clamp
  v_exp_f32_e64 v236, v236 clamp
  v_exp_f32_e64 v233, v233 clamp
  v_exp_f32_e64 v237, v237 clamp
  v_exp_f32_e64 v234, v234 clamp
  v_exp_f32_e64 v238, v238 clamp
  v_exp_f32_e64 v235, v235 clamp
  v_exp_f32_e64 v239, v239 clamp
  v_max_f32 v176, 0, v176
  v_max_f32 v180, 0, v180
  v_max_f32 v177, 0, v177
  v_max_f32 v181, 0, v181
  v_max_f32 v178, 0, v178
  v_max_f32 v182, 0, v182
  v_max_f32 v179, 0, v179
  v_max_f32 v183, 0, v183
  v_pk_add_f32 v[176:177], v[176:177], s[56:57]
  v_pk_add_f32 v[180:181], v[180:181], s[56:57]
  v_pk_add_f32 v[178:179], v[178:179], s[56:57]
  v_pk_add_f32 v[182:183], v[182:183], s[56:57]
  v_pk_add_f32 v[176:177], v[176:177], v[232:233]
  v_pk_add_f32 v[180:181], v[180:181], v[236:237]
  v_pk_add_f32 v[178:179], v[178:179], v[234:235]
  v_pk_add_f32 v[182:183], v[182:183], v[238:239]
  v_cvt_pk_bf16_f32 v200, v176, v177
  v_cvt_pk_bf16_f32 v201, v178, v179
  v_cvt_pk_bf16_f32 v204, v180, v181
  v_cvt_pk_bf16_f32 v205, v182, v183
  v_mov_b32 v202, 0
  v_mov_b32 v203, 0
  v_mov_b32 v206, 0
  v_mov_b32 v207, 0
  s_add_u32 m0, s38, 98304
  s_movk_i32 s37, 128
  buffer_load_dwordx4 v241, s[16:19], s37 offen lds
  s_add_u32 m0, s38, 106496
  s_movk_i32 s37, 128
  buffer_load_dwordx4 v242, s[16:19], s37 offen lds
  s_add_u32 m0, s38, 114688
  s_movk_i32 s37, 128
  buffer_load_dwordx4 v243, s[16:19], s37 offen lds
  s_add_u32 m0, s38, 122880
  s_movk_i32 s37, 256
  buffer_load_dwordx4 v241, s[16:19], s37 offen lds
  s_add_u32 m0, s38, 131072
  s_movk_i32 s37, 256
  buffer_load_dwordx4 v242, s[16:19], s37 offen lds
  s_add_u32 m0, s38, 139264
  s_movk_i32 s37, 256
  buffer_load_dwordx4 v243, s[16:19], s37 offen lds
  s_waitcnt vmcnt(6)
  v_lshlrev_b32 v251, 4, v255
  s_mul_i32 s33, s32, 18432
  v_add_u32 v251, s33, v251
  s_cmp_lg_u32 s31, 0
  s_cbranch_scc1 L_tgn79
  v_cvt_pk_bf16_f32 v0, v0, v1
  v_cvt_pk_bf16_f32 v1, v2, v3
  v_cvt_pk_bf16_f32 v4, v4, v5
  v_cvt_pk_bf16_f32 v5, v6, v7
  v_cvt_pk_bf16_f32 v8, v8, v9
  v_cvt_pk_bf16_f32 v9, v10, v11
  v_cvt_pk_bf16_f32 v12, v12, v13
  v_cvt_pk_bf16_f32 v13, v14, v15
  v_cvt_pk_bf16_f32 v16, v16, v17
  v_cvt_pk_bf16_f32 v17, v18, v19
  v_cvt_pk_bf16_f32 v20, v20, v21
  v_cvt_pk_bf16_f32 v21, v22, v23
  s_mov_b32 s62, 4278255360
  s_mov_b32 s63, 4278255360
  v_cndmask_b32 v32, 0, v0, s[62:63]
  v_cndmask_b32 v36, 0, v16, s[62:63]
  s_mov_b32 s62, 4278255360
  s_mov_b32 s63, 4278255360
  v_cndmask_b32 v33, 0, v1, s[62:63]
  v_cndmask_b32 v37, 0, v17, s[62:63]
  s_mov_b32 s62, 65280
  s_mov_b32 s63, 0
  v_cndmask_b32 v34, 0, v4, s[62:63]
  v_cndmask_b32 v38, 0, v20, s[62:63]
  s_mov_b32 s62, 0
  s_mov_b32 s63, 0
  v_cndmask_b32 v35, 0, v5, s[62:63]
  v_cndmask_b32 v39, 0, v21, s[62:63]
  ds_write_b128 v251, v[32:35] offset:0
  ds_write_b128 v251, v[36:39] offset:9216
  s_mov_b32 s62, 67044351
  s_mov_b32 s63, 67044351
  v_cndmask_b32 v40, 0, v8, s[62:63]
  v_cndmask_b32 v44, 0, v16, s[62:63]
  s_mov_b32 s62, 67044351
  s_mov_b32 s63, 67044351
  v_cndmask_b32 v41, 0, v9, s[62:63]
  v_cndmask_b32 v45, 0, v17, s[62:63]
  s_mov_b32 s62, 4227859455
  s_mov_b32 s63, 4227922944
  v_cndmask_b32 v42, 0, v12, s[62:63]
  v_cndmask_b32 v46, 0, v20, s[62:63]
  s_mov_b32 s62, 4227922944
  s_mov_b32 s63, 4227922944
  v_cndmask_b32 v43, 0, v13, s[62:63]
  v_cndmask_b32 v47, 0, v21, s[62:63]
  ds_write_b128 v251, v[40:43] offset:1024
  ds_write_b128 v251, v[44:47] offset:10240
  s_branch L_tgv78
L_tgn79:
  s_cmp_lg_u32 s31, 1
  s_cbranch_scc1 L_tgn80
  v_cvt_pk_bf16_f32 v0, v0, v1
  v_cvt_pk_bf16_f32 v1, v2, v3
  v_cvt_pk_bf16_f32 v4, v4, v5
  v_cvt_pk_bf16_f32 v5, v6, v7
  v_cvt_pk_bf16_f32 v16, v16, v17
  v_cvt_pk_bf16_f32 v17, v18, v19
  v_cvt_pk_bf16_f32 v20, v20, v21
  v_cvt_pk_bf16_f32 v21, v22, v23
  s_mov_b32 s62, 64512
  s_mov_b32 s63, 0
  v_cndmask_b32 v32, 0, v0, s[62:63]
  v_cndmask_b32 v36, 0, v16, s[62:63]
  s_mov_b32 s62, 64512
  s_mov_b32 s63, 0
  v_cndmask_b32 v33, 0, v1, s[62:63]
  v_cndmask_b32 v37, 0, v17, s[62:63]
  v_mov_b32 v34, 0
  v_mov_b32 v35, 0
  v_mov_b32 v38, 0
  v_mov_b32 v39, 0
  ds_write_b128 v251, v[32:35] offset:2048
  ds_write_b128 v251, v[36:39] offset:11264
  v_mov_b32 v40, 0
  v_mov_b32 v41, 0
  v_mov_b32 v44, 0
  v_mov_b32 v45, 0
  s_mov_b32 s62, 268369920
  s_mov_b32 s63, 268374015
  v_cndmask_b32 v42, 0, v4, s[62:63]
  v_cndmask_b32 v46, 0, v20, s[62:63]
  s_mov_b32 s62, 268374015
  s_mov_b32 s63, 268374015
  v_cndmask_b32 v43, 0, v5, s[62:63]
  v_cndmask_b32 v47, 0, v21, s[62:63]
  ds_write_b128 v251, v[40:43] offset:3072
  ds_write_b128 v251, v[44:47] offset:12288
  s_branch L_tgv78
L_tgn80:
  s_cmp_lg_u32 s31, 2
  s_cbranch_scc1 L_tgn81
  v_cvt_pk_bf16_f32 v0, v0, v1
  v_cvt_pk_bf16_f32 v1, v2, v3
  v_cvt_pk_bf16_f32 v4, v4, v5
  v_cvt_pk_bf16_f32 v5, v6, v7
  v_cvt_pk_bf16_f32 v8, v8, v9
  v_cvt_pk_bf16_f32 v9, v10, v11
  v_cvt_pk_bf16_f32 v12, v12, v13
  v_cvt_pk_bf16_f32 v13, v14, v15
  v_cvt_pk_bf16_f32 v16, v16, v17
  v_cvt_pk_bf16_f32 v17, v18, v19
  v_cvt_pk_bf16_f32 v20, v20, v21
  v_cvt_pk_bf16_f32 v21, v22, v23
  s_mov_b32 s62, 4026535935
  s_mov_b32 s63, 4026593280
  v_cndmask_b32 v32, 0, v0, s[62:63]
  v_cndmask_b32 v36, 0, v16, s[62:63]
  s_mov_b32 s62, 4026535935
  s_mov_b32 s63, 4026593280
  v_cndmask_b32 v33, 0, v1, s[62:63]
  v_cndmask_b32 v37, 0, v17, s[62:63]
  s_mov_b32 s62, 4026593280
  s_mov_b32 s63, 0
  v_cndmask_b32 v34, 0, v4, s[62:63]
  v_cndmask_b32 v38, 0, v20, s[62:63]
  s_mov_b32 s62, 61440
  s_mov_b32 s63, 0
  v_cndmask_b32 v35, 0, v5, s[62:63]
  v_cndmask_b32 v39, 0, v21, s[62:63]
  ds_write_b128 v251, v[32:35] offset:4096
  ds_write_b128 v251, v[36:39] offset:13312
  s_mov_b32 s62, 1073676288
  s_mov_b32 s63, 1073692671
  v_cndmask_b32 v40, 0, v8, s[62:63]
  v_cndmask_b32 v44, 0, v16, s[62:63]
  s_mov_b32 s62, 1073676288
  s_mov_b32 s63, 1073692671
  v_cndmask_b32 v41, 0, v9, s[62:63]
  v_cndmask_b32 v45, 0, v17, s[62:63]
  s_mov_b32 s62, 1073692671
  s_mov_b32 s63, 3221274624
  v_cndmask_b32 v42, 0, v12, s[62:63]
  v_cndmask_b32 v46, 0, v20, s[62:63]
  s_mov_b32 s62, 3221241855
  s_mov_b32 s63, 3221274624
  v_cndmask_b32 v43, 0, v13, s[62:63]
  v_cndmask_b32 v47, 0, v21, s[62:63]
  ds_write_b128 v251, v[40:43] offset:5120
  ds_write_b128 v251, v[44:47] offset:14336
  s_branch L_tgv78
L_tgn81:
  v_cvt_pk_bf16_f32 v0, v0, v1
  v_cvt_pk_bf16_f32 v1, v2, v3
  v_cvt_pk_bf16_f32 v4, v4, v5
  v_cvt_pk_bf16_f32 v5, v6, v7
  v_cvt_pk_bf16_f32 v8, v8, v9
  v_cvt_pk_bf16_f32 v9, v10, v11
  v_cvt_pk_bf16_f32 v16, v16, v17
  v_cvt_pk_bf16_f32 v17, v18, v19
  v_cvt_pk_bf16_f32 v20, v20, v21
  v_cvt_pk_bf16_f32 v21, v22, v23
  s_mov_b32 s62, 3221274624
  s_mov_b32 s63, 0
  v_cndmask_b32 v32, 0, v0, s[62:63]
  v_cndmask_b32 v36, 0, v16, s[62:63]
  s_mov_b32 s62, 3221274624
  s_mov_b32 s63, 0
  v_cndmask_b32 v33, 0, v1, s[62:63]
  v_cndmask_b32 v37, 0, v17, s[62:63]
  v_mov_b32 v34, 0
  v_mov_b32 v35, 0
  v_mov_b32 v38, 0
  v_mov_b32 v39, 0
  ds_write_b128 v251, v[32:35] offset:6144
  ds_write_b128 v251, v[36:39] offset:15360
  v_mov_b32 v40, 0
  v_mov_b32 v41, 0
  v_mov_b32 v44, 0
  v_mov_b32 v45, 0
  s_mov_b32 s62, 0
  s_mov_b32 s63, 4294967295
  v_cndmask_b32 v42, 0, v4, s[62:63]
  v_cndmask_b32 v46, 0, v20, s[62:63]
  s_mov_b32 s62, 4294901760
  s_mov_b32 s63, 4294967295
  v_cndmask_b32 v43, 0, v5, s[62:63]
  v_cndmask_b32 v47, 0, v21, s[62:63]
  ds_write_b128 v251, v[40:43] offset:7168
  ds_write_b128 v251, v[44:47] offset:16384
  s_mov_b32 s62, 4294967295
  s_mov_b32 s63, 0
  v_cndmask_b32 v48, 0, v8, s[62:63]
  v_cndmask_b32 v52, 0, v16, s[62:63]
  s_mov_b32 s62, 4294967295
  s_mov_b32 s63, 0
  v_cndmask_b32 v49, 0, v9, s[62:63]
  v_cndmask_b32 v53, 0, v17, s[62:63]
  v_mov_b32 v50, 0
  v_mov_b32 v51, 0
  v_mov_b32 v54, 0
  v_mov_b32 v55, 0
  ds_write_b128 v251, v[48:51] offset:8192
  ds_write_b128 v251, v[52:55] offset:17408
L_tgv78:
  s_waitcnt lgkmcnt(0)
  s_barrier
  ds_read_b128 v[64:67], v251 offset:0
  ds_read_b128 v[100:103], v251 offset:9216
  ds_read_b128 v[68:71], v251 offset:1024
  ds_read_b128 v[104:107], v251 offset:10240
  ds_read_b128 v[72:75], v251 offset:2048
  ds_read_b128 v[108:111], v251 offset:11264
  ds_read_b128 v[76:79], v251 offset:3072
  ds_read_b128 v[112:115], v251 offset:12288
  ds_read_b128 v[80:83], v251 offset:4096
  ds_read_b128 v[116:119], v251 offset:13312
  ds_read_b128 v[84:87], v251 offset:5120
  ds_read_b128 v[120:123], v251 offset:14336
  ds_read_b128 v[88:91], v251 offset:6144
  ds_read_b128 v[124:127], v251 offset:15360
  ds_read_b128 v[92:95], v251 offset:7168
  ds_read_b128 v[128:131], v251 offset:16384
  ds_read_b128 v[96:99], v251 offset:8192
  ds_read_b128 v[132:135], v251 offset:17408
  s_waitcnt lgkmcnt(0)
  s_nop 1
  v_mfma_f32_16x16x32_bf16 v[144:147], v[64:67], v[184:187], 0
  v_mfma_f32_16x16x32_bf16 v[152:155], v[100:103], v[184:187], 0
  v_mfma_f32_16x16x32_bf16 v[148:151], v[64:67], v[188:191], 0
  v_mfma_f32_16x16x32_bf16 v[156:159], v[100:103], v[188:191], 0
  v_mfma_f32_16x16x32_bf16 v[160:163], v[68:71], v[184:187], 0
  v_mfma_f32_16x16x32_bf16 v[168:171], v[104:107], v[184:187], 0
  v_mfma_f32_16x16x32_bf16 v[164:167], v[68:71], v[188:191], 0
  v_mfma_f32_16x16x32_bf16 v[172:175], v[104:107], v[188:191], 0
  v_mfma_f32_16x16x32_bf16 v[160:163], v[72:75], v[192:195], v[160:163]
  v_mfma_f32_16x16x32_bf16 v[168:171], v[108:111], v[192:195], v[168:171]
  v_mfma_f32_16x16x32_bf16 v[164:167], v[72:75], v[196:199], v[164:167]
  v_mfma_f32_16x16x32_bf16 v[172:175], v[108:111], v[196:199], v[172:175]
  v_add_f32 v152, 0x358637bd, v152
  v_add_f32 v153, 0x358637bd, v153
  v_add_f32 v154, 0x358637bd, v154
  v_add_f32 v155, 0x358637bd, v155
  v_add_f32 v156, 0x358637bd, v156
  v_add_f32 v157, 0x358637bd, v157
  v_add_f32 v158, 0x358637bd, v158
  v_add_f32 v159, 0x358637bd, v159
  v_rcp_f32 v152, v152
  v_rcp_f32 v153, v153
  v_rcp_f32 v154, v154
  v_rcp_f32 v155, v155
  v_rcp_f32 v156, v156
  v_rcp_f32 v157, v157
  v_rcp_f32 v158, v158
  v_rcp_f32 v159, v159
  v_mul_f32 v144, v144, v152
  v_mul_f32 v145, v145, v153
  v_mul_f32 v146, v146, v154
  v_mul_f32 v147, v147, v155
  v_mul_f32 v148, v148, v156
  v_mul_f32 v149, v149, v157
  v_mul_f32 v150, v150, v158
  v_mul_f32 v151, v151, v159
  v_cvt_pk_bf16_f32 v208, v144, v145
  v_cvt_pk_bf16_f32 v209, v146, v147
  v_cvt_pk_bf16_f32 v220, v148, v149
  v_cvt_pk_bf16_f32 v221, v150, v151
  v_mfma_f32_16x16x32_bf16 v[144:147], v[76:79], v[184:187], 0
  v_mfma_f32_16x16x32_bf16 v[152:155], v[112:115], v[184:187], 0
  v_mfma_f32_16x16x32_bf16 v[148:151], v[76:79], v[188:191], 0
  v_mfma_f32_16x16x32_bf16 v[156:159], v[112:115], v[188:191], 0
  v_mfma_f32_16x16x32_bf16 v[144:147], v[80:83], v[192:195], v[144:147]
  v_mfma_f32_16x16x32_bf16 v[152:155], v[116:119], v[192:195], v[152:155]
  v_mfma_f32_16x16x32_bf16 v[148:151], v[80:83], v[196:199], v[148:151]
  v_mfma_f32_16x16x32_bf16 v[156:159], v[116:119], v[196:199], v[156:159]
  v_add_f32 v168, 0x358637bd, v168
  v_add_f32 v169, 0x358637bd, v169
  v_add_f32 v170, 0x358637bd, v170
  v_add_f32 v171, 0x358637bd, v171
  v_add_f32 v172, 0x358637bd, v172
  v_add_f32 v173, 0x358637bd, v173
  v_add_f32 v174, 0x358637bd, v174
  v_add_f32 v175, 0x358637bd, v175
  v_rcp_f32 v168, v168
  v_rcp_f32 v169, v169
  v_rcp_f32 v170, v170
  v_rcp_f32 v171, v171
  v_rcp_f32 v172, v172
  v_rcp_f32 v173, v173
  v_rcp_f32 v174, v174
  v_rcp_f32 v175, v175
  v_mul_f32 v160, v160, v168
  v_mul_f32 v161, v161, v169
  v_mul_f32 v162, v162, v170
  v_mul_f32 v163, v163, v171
  v_mul_f32 v164, v164, v172
  v_mul_f32 v165, v165, v173
  v_mul_f32 v166, v166, v174
  v_mul_f32 v167, v167, v175
  v_cvt_pk_bf16_f32 v210, v160, v161
  v_cvt_pk_bf16_f32 v211, v162, v163
  v_cvt_pk_bf16_f32 v222, v164, v165
  v_cvt_pk_bf16_f32 v223, v166, v167
  v_mfma_f32_16x16x32_bf16 v[160:163], v[84:87], v[192:195], 0
  v_mfma_f32_16x16x32_bf16 v[168:171], v[120:123], v[192:195], 0
  v_mfma_f32_16x16x32_bf16 v[164:167], v[84:87], v[196:199], 0
  v_mfma_f32_16x16x32_bf16 v[172:175], v[120:123], v[196:199], 0
  v_mfma_f32_16x16x32_bf16 v[160:163], v[88:91], v[200:203], v[160:163]
  v_mfma_f32_16x16x32_bf16 v[168:171], v[124:127], v[200:203], v[168:171]
  v_mfma_f32_16x16x32_bf16 v[164:167], v[88:91], v[204:207], v[164:167]
  v_mfma_f32_16x16x32_bf16 v[172:175], v[124:127], v[204:207], v[172:175]
  v_add_f32 v152, 0x358637bd, v152
  v_add_f32 v153, 0x358637bd, v153
  v_add_f32 v154, 0x358637bd, v154
  v_add_f32 v155, 0x358637bd, v155
  v_add_f32 v156, 0x358637bd, v156
  v_add_f32 v157, 0x358637bd, v157
  v_add_f32 v158, 0x358637bd, v158
  v_add_f32 v159, 0x358637bd, v159
  v_rcp_f32 v152, v152
  v_rcp_f32 v153, v153
  v_rcp_f32 v154, v154
  v_rcp_f32 v155, v155
  v_rcp_f32 v156, v156
  v_rcp_f32 v157, v157
  v_rcp_f32 v158, v158
  v_rcp_f32 v159, v159
  v_mul_f32 v144, v144, v152
  v_mul_f32 v145, v145, v153
  v_mul_f32 v146, v146, v154
  v_mul_f32 v147, v147, v155
  v_mul_f32 v148, v148, v156
  v_mul_f32 v149, v149, v157
  v_mul_f32 v150, v150, v158
  v_mul_f32 v151, v151, v159
  v_cvt_pk_bf16_f32 v212, v144, v145
  v_cvt_pk_bf16_f32 v213, v146, v147
  v_cvt_pk_bf16_f32 v224, v148, v149
  v_cvt_pk_bf16_f32 v225, v150, v151
  v_mfma_f32_16x16x32_bf16 v[144:147], v[92:95], v[192:195], 0
  v_mfma_f32_16x16x32_bf16 v[152:155], v[128:131], v[192:195], 0
  v_mfma_f32_16x16x32_bf16 v[148:151], v[92:95], v[196:199], 0
  v_mfma_f32_16x16x32_bf16 v[156:159], v[128:131], v[196:199], 0
  v_mfma_f32_16x16x32_bf16 v[144:147], v[96:99], v[200:203], v[144:147]
  v_mfma_f32_16x16x32_bf16 v[152:155], v[132:135], v[200:203], v[152:155]
  v_mfma_f32_16x16x32_bf16 v[148:151], v[96:99], v[204:207], v[148:151]
  v_mfma_f32_16x16x32_bf16 v[156:159], v[132:135], v[204:207], v[156:159]
  v_add_f32 v168, 0x358637bd, v168
  v_add_f32 v169, 0x358637bd, v169
  v_add_f32 v170, 0x358637bd, v170
  v_add_f32 v171, 0x358637bd, v171
  v_add_f32 v172, 0x358637bd, v172
  v_add_f32 v173, 0x358637bd, v173
  v_add_f32 v174, 0x358637bd, v174
  v_add_f32 v175, 0x358637bd, v175
  v_rcp_f32 v168, v168
  v_rcp_f32 v169, v169
  v_rcp_f32 v170, v170
  v_rcp_f32 v171, v171
  v_rcp_f32 v172, v172
  v_rcp_f32 v173, v173
  v_rcp_f32 v174, v174
  v_rcp_f32 v175, v175
  v_mul_f32 v160, v160, v168
  v_mul_f32 v161, v161, v169
  v_mul_f32 v162, v162, v170
  v_mul_f32 v163, v163, v171
  v_mul_f32 v164, v164, v172
  v_mul_f32 v165, v165, v173
  v_mul_f32 v166, v166, v174
  v_mul_f32 v167, v167, v175
  v_cvt_pk_bf16_f32 v214, v160, v161
  v_cvt_pk_bf16_f32 v215, v162, v163
  v_cvt_pk_bf16_f32 v226, v164, v165
  v_cvt_pk_bf16_f32 v227, v166, v167
  s_nop 7
  v_add_f32 v152, 0x358637bd, v152
  v_add_f32 v153, 0x358637bd, v153
  v_add_f32 v154, 0x358637bd, v154
  v_add_f32 v155, 0x358637bd, v155
  v_add_f32 v156, 0x358637bd, v156
  v_add_f32 v157, 0x358637bd, v157
  v_add_f32 v158, 0x358637bd, v158
  v_add_f32 v159, 0x358637bd, v159
  v_rcp_f32 v152, v152
  v_rcp_f32 v153, v153
  v_rcp_f32 v154, v154
  v_rcp_f32 v155, v155
  v_rcp_f32 v156, v156
  v_rcp_f32 v157, v157
  v_rcp_f32 v158, v158
  v_rcp_f32 v159, v159
  v_mul_f32 v144, v144, v152
  v_mul_f32 v145, v145, v153
  v_mul_f32 v146, v146, v154
  v_mul_f32 v147, v147, v155
  v_mul_f32 v148, v148, v156
  v_mul_f32 v149, v149, v157
  v_mul_f32 v150, v150, v158
  v_mul_f32 v151, v151, v159
  v_cvt_pk_bf16_f32 v216, v144, v145
  v_cvt_pk_bf16_f32 v217, v146, v147
  v_cvt_pk_bf16_f32 v228, v148, v149
  v_cvt_pk_bf16_f32 v229, v150, v151
  s_barrier
  v_lshlrev_b32 v249, 4, v255
  v_lshlrev_b32 v251, 3, v255
  s_mul_i32 s33, s28, 5120
  s_xor_b32 s34, s28, 4
  s_mul_i32 s34, s34, 5120
  v_add_u32 v250, s34, v249
  v_add_u32 v249, s33, v249
  v_add_u32 v252, s34, v251
  v_add_u32 v251, s33, v251
  ds_write_b128 v249, v[208:211] offset:0
  ds_write_b128 v249, v[212:215] offset:1024
  ds_write_b64 v251, v[216:217] offset:2048
  ds_write_b128 v249, v[220:223] offset:2560
  ds_write_b128 v249, v[224:227] offset:3584
  ds_write_b64 v251, v[228:229] offset:4608
  s_waitcnt lgkmcnt(0)
  s_barrier
  ds_read_b128 v[0:3], v250 offset:0
  ds_read_b128 v[4:7], v250 offset:1024
  ds_read_b64 v[218:219], v252 offset:2048
  ds_read_b128 v[8:11], v250 offset:2560
  ds_read_b128 v[12:15], v250 offset:3584
  ds_read_b64 v[230:231], v252 offset:4608
  s_waitcnt lgkmcnt(0) vmcnt(0)
  s_barrier
  v_lshrrev_b32 v249, 4, v255
  v_and_b32 v250, 15, v255
  v_lshlrev_b32 v244, 2, v249
  v_lshrrev_b32 v245, 2, v250
  v_add_u32 v244, v244, v245
  v_lshlrev_b32 v244, 7, v244
  v_and_b32 v245, 3, v250
  v_lshlrev_b32 v245, 3, v245
  v_add_u32 v244, v244, v245
  v_and_b32 v249, 1, v249
  v_lshlrev_b32 v249, 1, v249
  v_lshrrev_b32 v250, 3, v250
  v_add_u32 v249, v249, v250
  s_lshl_b32 s33, s32, 1
  v_xor_b32 v249, s33, v249
  v_lshlrev_b32 v249, 5, v249
  v_add_u32 v244, v244, v249
  v_xor_b32 v245, 32, v244
  s_mul_i32 s33, s32, 10240
  s_xor_b32 s34, s32, 1
  s_mul_i32 s34, s34, 10240
  s_add_u32 s33, s33, 73728
  s_add_u32 s34, s34, 73728
  v_add_u32 v246, s34, v244
  v_add_u32 v247, s34, v245
  v_add_u32 v244, s33, v244
  v_add_u32 v245, s33, v245
  v_lshlrev_b32 v254, 4, v255
  s_add_u32 s33, s30, 12
  s_mul_i32 s33, s33, 2359296
  s_mul_i32 s34, s29, 147456
  s_add_u32 s33, s33, s34
  s_lshl_b32 s34, s31, 12
  s_add_u32 s33, s33, s34
  s_lshl_b32 s34, s32, 11
  s_add_u32 s39, s33, s34
  ds_read_b64_tr_b16 v[96:97], v244 offset:0
  ds_read_b64_tr_b16 v[98:99], v244 offset:2048
  ds_read_b64_tr_b16 v[100:101], v245 offset:0
  ds_read_b64_tr_b16 v[102:103], v245 offset:2048
  ds_read_b64_tr_b16 v[104:105], v244 offset:4096
  ds_read_b64_tr_b16 v[106:107], v244 offset:6144
  ds_read_b64_tr_b16 v[108:109], v245 offset:4096
  ds_read_b64_tr_b16 v[110:111], v245 offset:6144
  s_waitcnt lgkmcnt(6)
  v_mfma_f32_16x16x32_bf16 v[144:147], v[96:99], v[208:211], 0
  ds_read_b64_tr_b16 v[112:113], v246 offset:0
  v_mfma_f32_16x16x32_bf16 v[148:151], v[96:99], v[220:223], 0
  ds_read_b64_tr_b16 v[114:115], v246 offset:2048
  s_waitcnt lgkmcnt(6)
  v_mfma_f32_16x16x32_bf16 v[152:155], v[100:103], v[208:211], 0
  ds_read_b64_tr_b16 v[116:117], v247 offset:0
  s_add_u32 m0, s38, 0
  s_movk_i32 s37, 384
  buffer_load_dwordx4 v241, s[16:19], s37 offen lds
  v_mfma_f32_16x16x32_bf16 v[156:159], v[100:103], v[220:223], 0
  ds_read_b64_tr_b16 v[118:119], v247 offset:2048
  s_waitcnt lgkmcnt(6)
  v_mfma_f32_16x16x32_bf16 v[144:147], v[104:107], v[212:215], v[144:147]
  ds_read_b64_tr_b16 v[96:97], v246 offset:4096
  s_add_u32 m0, s38, 8192
  s_movk_i32 s37, 384
  buffer_load_dwordx4 v242, s[16:19], s37 offen lds
  v_mfma_f32_16x16x32_bf16 v[148:151], v[104:107], v[224:227], v[148:151]
  ds_read_b64_tr_b16 v[98:99], v246 offset:6144
  s_waitcnt lgkmcnt(6)
  v_mfma_f32_16x16x32_bf16 v[152:155], v[108:111], v[212:215], v[152:155]
  ds_read_b64_tr_b16 v[100:101], v247 offset:4096
  s_add_u32 m0, s38, 16384
  s_movk_i32 s37, 384
  buffer_load_dwordx4 v243, s[16:19], s37 offen lds
  v_mfma_f32_16x16x32_bf16 v[156:159], v[108:111], v[224:227], v[156:159]
  ds_read_b64_tr_b16 v[102:103], v247 offset:6144
  s_waitcnt lgkmcnt(6)
  v_mfma_f32_16x16x32_bf16 v[144:147], v[112:115], v[0:3], v[144:147]
  ds_read_b64_tr_b16 v[104:105], v244 offset:8192
  s_add_u32 m0, s38, 24576
  s_movk_i32 s37, 512
  buffer_load_dwordx4 v241, s[16:19], s37 offen lds
  v_mfma_f32_16x16x32_bf16 v[148:151], v[112:115], v[8:11], v[148:151]
  ds_read_b64_tr_b16 v[106:107], v246 offset:8192
  s_waitcnt lgkmcnt(6)
  v_mfma_f32_16x16x32_bf16 v[152:155], v[116:119], v[0:3], v[152:155]
  ds_read_b64_tr_b16 v[108:109], v245 offset:8192
  s_add_u32 m0, s38, 32768
  s_movk_i32 s37, 512
  buffer_load_dwordx4 v242, s[16:19], s37 offen lds
  v_mfma_f32_16x16x32_bf16 v[156:159], v[116:119], v[8:11], v[156:159]
  ds_read_b64_tr_b16 v[110:111], v247 offset:8192
  s_waitcnt lgkmcnt(6)
  v_mfma_f32_16x16x32_bf16 v[144:147], v[96:99], v[4:7], v[144:147]
  ds_read_b64_tr_b16 v[112:113], v244 offset:24576
  s_add_u32 m0, s38, 40960
  s_movk_i32 s37, 512
  buffer_load_dwordx4 v243, s[16:19], s37 offen lds
  v_mfma_f32_16x16x32_bf16 v[148:151], v[96:99], v[12:15], v[148:151]
  ds_read_b64_tr_b16 v[114:115], v244 offset:26624
  s_waitcnt lgkmcnt(6)
  v_mfma_f32_16x16x32_bf16 v[152:155], v[100:103], v[4:7], v[152:155]
  ds_read_b64_tr_b16 v[116:117], v245 offset:24576
  s_add_u32 m0, s38, 49152
  s_movk_i32 s37, 640
  buffer_load_dwordx4 v241, s[16:19], s37 offen lds
  v_mfma_f32_16x16x32_bf16 v[156:159], v[100:103], v[12:15], v[156:159]
  ds_read_b64_tr_b16 v[118:119], v245 offset:26624
  s_waitcnt lgkmcnt(6)
  v_mfma_f32_16x16x32_bf16 v[144:147], v[104:107], v[216:219], v[144:147]
  ds_read_b64_tr_b16 v[96:97], v244 offset:28672
  s_add_u32 m0, s38, 57344
  s_movk_i32 s37, 640
  buffer_load_dwordx4 v242, s[16:19], s37 offen lds
  v_mfma_f32_16x16x32_bf16 v[148:151], v[104:107], v[228:231], v[148:151]
  ds_read_b64_tr_b16 v[98:99], v244 offset:30720
  s_waitcnt lgkmcnt(6)
  v_mfma_f32_16x16x32_bf16 v[152:155], v[108:111], v[216:219], v[152:155]
  ds_read_b64_tr_b16 v[100:101], v245 offset:28672
  s_add_u32 m0, s38, 65536
  s_movk_i32 s37, 640
  buffer_load_dwordx4 v243, s[16:19], s37 offen lds
  v_mfma_f32_16x16x32_bf16 v[156:159], v[108:111], v[228:231], v[156:159]
  ds_read_b64_tr_b16 v[102:103], v245 offset:30720
  s_waitcnt lgkmcnt(6)
  v_mfma_f32_16x16x32_bf16 v[160:163], v[112:115], v[208:211], 0
  ds_read_b64_tr_b16 v[104:105], v246 offset:24576
  v_mfma_f32_16x16x32_bf16 v[164:167], v[112:115], v[220:223], 0
  ds_read_b64_tr_b16 v[106:107], v246 offset:26624
  s_waitcnt lgkmcnt(6)
  v_mfma_f32_16x16x32_bf16 v[168:171], v[116:119], v[208:211], 0
  ds_read_b64_tr_b16 v[108:109], v247 offset:24576
  v_mfma_f32_16x16x32_bf16 v[172:175], v[116:119], v[220:223], 0
  ds_read_b64_tr_b16 v[110:111], v247 offset:26624
  s_waitcnt lgkmcnt(6)
  v_mfma_f32_16x16x32_bf16 v[160:163], v[96:99], v[212:215], v[160:163]
  ds_read_b64_tr_b16 v[112:113], v246 offset:28672
  v_mfma_f32_16x16x32_bf16 v[164:167], v[96:99], v[224:227], v[164:167]
  ds_read_b64_tr_b16 v[114:115], v246 offset:30720
  s_waitcnt lgkmcnt(6)
  v_mfma_f32_16x16x32_bf16 v[168:171], v[100:103], v[212:215], v[168:171]
  ds_read_b64_tr_b16 v[116:117], v247 offset:28672
  v_mfma_f32_16x16x32_bf16 v[172:175], v[100:103], v[224:227], v[172:175]
  ds_read_b64_tr_b16 v[118:119], v247 offset:30720
  s_waitcnt lgkmcnt(6)
  v_mfma_f32_16x16x32_bf16 v[160:163], v[104:107], v[0:3], v[160:163]
  ds_read_b64_tr_b16 v[96:97], v244 offset:32768
  v_cvt_pk_bf16_f32 v32, v144, v145
  v_mfma_f32_16x16x32_bf16 v[164:167], v[104:107], v[8:11], v[164:167]
  ds_read_b64_tr_b16 v[98:99], v246 offset:32768
  v_cvt_pk_bf16_f32 v33, v146, v147
  s_waitcnt lgkmcnt(6)
  v_mfma_f32_16x16x32_bf16 v[168:171], v[108:111], v[0:3], v[168:171]
  ds_read_b64_tr_b16 v[100:101], v245 offset:32768
  v_cvt_pk_bf16_f32 v34, v152, v153
  v_mfma_f32_16x16x32_bf16 v[172:175], v[108:111], v[8:11], v[172:175]
  ds_read_b64_tr_b16 v[102:103], v247 offset:32768
  v_cvt_pk_bf16_f32 v35, v154, v155
  s_waitcnt lgkmcnt(6)
  v_mfma_f32_16x16x32_bf16 v[160:163], v[112:115], v[4:7], v[160:163]
  ds_read_b64_tr_b16 v[104:105], v244 offset:49152
  v_cvt_pk_bf16_f32 v36, v148, v149
  v_mfma_f32_16x16x32_bf16 v[164:167], v[112:115], v[12:15], v[164:167]
  ds_read_b64_tr_b16 v[106:107], v244 offset:51200
  v_cvt_pk_bf16_f32 v37, v150, v151
  s_waitcnt lgkmcnt(6)
  v_mfma_f32_16x16x32_bf16 v[168:171], v[116:119], v[4:7], v[168:171]
  ds_read_b64_tr_b16 v[108:109], v245 offset:49152
  v_cvt_pk_bf16_f32 v38, v156, v157
  v_mfma_f32_16x16x32_bf16 v[172:175], v[116:119], v[12:15], v[172:175]
  ds_read_b64_tr_b16 v[110:111], v245 offset:51200
  v_cvt_pk_bf16_f32 v39, v158, v159
  s_waitcnt lgkmcnt(6)
  v_mfma_f32_16x16x32_bf16 v[160:163], v[96:99], v[216:219], v[160:163]
  ds_read_b64_tr_b16 v[112:113], v244 offset:53248
  v_mfma_f32_16x16x32_bf16 v[164:167], v[96:99], v[228:231], v[164:167]
  ds_read_b64_tr_b16 v[114:115], v244 offset:55296
  s_waitcnt lgkmcnt(6)
  v_mfma_f32_16x16x32_bf16 v[168:171], v[100:103], v[216:219], v[168:171]
  ds_read_b64_tr_b16 v[116:117], v245 offset:53248
  v_mfma_f32_16x16x32_bf16 v[172:175], v[100:103], v[228:231], v[172:175]
  ds_read_b64_tr_b16 v[118:119], v245 offset:55296
  s_add_u32 s35, s39, 0
  buffer_store_dwordx4 v[32:35], v254, s[20:23], s35 offen offset:0 sc1
  buffer_store_dwordx4 v[36:39], v254, s[20:23], s35 offen offset:1024 sc1
  s_waitcnt lgkmcnt(6)
  v_mfma_f32_16x16x32_bf16 v[144:147], v[104:107], v[208:211], 0
  ds_read_b64_tr_b16 v[96:97], v246 offset:49152
  v_mfma_f32_16x16x32_bf16 v[148:151], v[104:107], v[220:223], 0
  ds_read_b64_tr_b16 v[98:99], v246 offset:51200
  s_waitcnt lgkmcnt(6)
  v_mfma_f32_16x16x32_bf16 v[152:155], v[108:111], v[208:211], 0
  ds_read_b64_tr_b16 v[100:101], v247 offset:49152
  v_mfma_f32_16x16x32_bf16 v[156:159], v[108:111], v[220:223], 0
  ds_read_b64_tr_b16 v[102:103], v247 offset:51200
  s_waitcnt lgkmcnt(6)
  v_mfma_f32_16x16x32_bf16 v[144:147], v[112:115], v[212:215], v[144:147]
  ds_read_b64_tr_b16 v[104:105], v246 offset:53248
  v_mfma_f32_16x16x32_bf16 v[148:151], v[112:115], v[224:227], v[148:151]
  ds_read_b64_tr_b16 v[106:107], v246 offset:55296
  s_waitcnt lgkmcnt(6)
  v_mfma_f32_16x16x32_bf16 v[152:155], v[116:119], v[212:215], v[152:155]
  ds_read_b64_tr_b16 v[108:109], v247 offset:53248
  v_mfma_f32_16x16x32_bf16 v[156:159], v[116:119], v[224:227], v[156:159]
  ds_read_b64_tr_b16 v[110:111], v247 offset:55296
  s_waitcnt lgkmcnt(6)
  v_mfma_f32_16x16x32_bf16 v[144:147], v[96:99], v[0:3], v[144:147]
  ds_read_b64_tr_b16 v[112:113], v244 offset:57344
  v_cvt_pk_bf16_f32 v40, v160, v161
  v_mfma_f32_16x16x32_bf16 v[148:151], v[96:99], v[8:11], v[148:151]
  ds_read_b64_tr_b16 v[114:115], v246 offset:57344
  v_cvt_pk_bf16_f32 v41, v162, v163
  s_waitcnt lgkmcnt(6)
  v_mfma_f32_16x16x32_bf16 v[152:155], v[100:103], v[0:3], v[152:155]
  ds_read_b64_tr_b16 v[116:117], v245 offset:57344
  v_cvt_pk_bf16_f32 v42, v168, v169
  v_mfma_f32_16x16x32_bf16 v[156:159], v[100:103], v[8:11], v[156:159]
  ds_read_b64_tr_b16 v[118:119], v247 offset:57344
  v_cvt_pk_bf16_f32 v43, v170, v171
  s_waitcnt lgkmcnt(6)
  v_mfma_f32_16x16x32_bf16 v[144:147], v[104:107], v[4:7], v[144:147]
  v_cvt_pk_bf16_f32 v44, v164, v165
  v_mfma_f32_16x16x32_bf16 v[148:151], v[104:107], v[12:15], v[148:151]
  v_cvt_pk_bf16_f32 v45, v166, v167
  s_waitcnt lgkmcnt(4)
  v_mfma_f32_16x16x32_bf16 v[152:155], v[108:111], v[4:7], v[152:155]
  v_cvt_pk_bf16_f32 v46, v172, v173
  v_mfma_f32_16x16x32_bf16 v[156:159], v[108:111], v[12:15], v[156:159]
  v_cvt_pk_bf16_f32 v47, v174, v175
  s_waitcnt lgkmcnt(2)
  v_mfma_f32_16x16x32_bf16 v[144:147], v[112:115], v[216:219], v[144:147]
  v_mfma_f32_16x16x32_bf16 v[148:151], v[112:115], v[228:231], v[148:151]
  s_waitcnt lgkmcnt(0)
  v_mfma_f32_16x16x32_bf16 v[152:155], v[116:119], v[216:219], v[152:155]
  v_mfma_f32_16x16x32_bf16 v[156:159], v[116:119], v[228:231], v[156:159]
  s_add_u32 s35, s39, 16384
  buffer_store_dwordx4 v[40:43], v254, s[20:23], s35 offen offset:0 sc1
  buffer_store_dwordx4 v[44:47], v254, s[20:23], s35 offen offset:1024 sc1
  v_add_u32 v244, 4294893568, v244
  v_add_u32 v245, 4294893568, v245
  v_add_u32 v246, 4294893568, v246
  v_add_u32 v247, 4294893568, v247
  s_waitcnt vmcnt(4)
  s_barrier
  ds_read_b64_tr_b16 v[96:97], v244 offset:0
  ds_read_b64_tr_b16 v[98:99], v244 offset:2048
  ds_read_b64_tr_b16 v[100:101], v245 offset:0
  ds_read_b64_tr_b16 v[102:103], v245 offset:2048
  ds_read_b64_tr_b16 v[104:105], v244 offset:4096
  ds_read_b64_tr_b16 v[106:107], v244 offset:6144
  ds_read_b64_tr_b16 v[108:109], v245 offset:4096
  ds_read_b64_tr_b16 v[110:111], v245 offset:6144
  s_waitcnt lgkmcnt(6)
  v_mfma_f32_16x16x32_bf16 v[160:163], v[96:99], v[208:211], 0
  ds_read_b64_tr_b16 v[112:113], v246 offset:0
  v_mfma_f32_16x16x32_bf16 v[164:167], v[96:99], v[220:223], 0
  ds_read_b64_tr_b16 v[114:115], v246 offset:2048
  s_waitcnt lgkmcnt(6)
  v_mfma_f32_16x16x32_bf16 v[168:171], v[100:103], v[208:211], 0
  ds_read_b64_tr_b16 v[116:117], v247 offset:0
  s_add_u32 m0, s38, 73728
  s_movk_i32 s37, 768
  buffer_load_dwordx4 v241, s[16:19], s37 offen lds
  v_mfma_f32_16x16x32_bf16 v[172:175], v[100:103], v[220:223], 0
  ds_read_b64_tr_b16 v[118:119], v247 offset:2048
  s_waitcnt lgkmcnt(6)
  v_mfma_f32_16x16x32_bf16 v[160:163], v[104:107], v[212:215], v[160:163]
  ds_read_b64_tr_b16 v[96:97], v246 offset:4096
  s_add_u32 m0, s38, 81920
  s_movk_i32 s37, 768
  buffer_load_dwordx4 v242, s[16:19], s37 offen lds
  v_mfma_f32_16x16x32_bf16 v[164:167], v[104:107], v[224:227], v[164:167]
  ds_read_b64_tr_b16 v[98:99], v246 offset:6144
  s_waitcnt lgkmcnt(6)
  v_mfma_f32_16x16x32_bf16 v[168:171], v[108:111], v[212:215], v[168:171]
  ds_read_b64_tr_b16 v[100:101], v247 offset:4096
  s_add_u32 m0, s38, 90112
  s_movk_i32 s37, 768
  buffer_load_dwordx4 v243, s[16:19], s37 offen lds
  v_mfma_f32_16x16x32_bf16 v[172:175], v[108:111], v[224:227], v[172:175]
  ds_read_b64_tr_b16 v[102:103], v247 offset:6144
  s_waitcnt lgkmcnt(6)
  v_mfma_f32_16x16x32_bf16 v[160:163], v[112:115], v[0:3], v[160:163]
  ds_read_b64_tr_b16 v[104:105], v244 offset:8192
  s_add_u32 m0, s38, 98304
  s_movk_i32 s37, 896
  buffer_load_dwordx4 v241, s[16:19], s37 offen lds
  v_cvt_pk_bf16_f32 v32, v144, v145
  v_mfma_f32_16x16x32_bf16 v[164:167], v[112:115], v[8:11], v[164:167]
  ds_read_b64_tr_b16 v[106:107], v246 offset:8192
  v_cvt_pk_bf16_f32 v33, v146, v147
  s_waitcnt lgkmcnt(6)
  v_mfma_f32_16x16x32_bf16 v[168:171], v[116:119], v[0:3], v[168:171]
  ds_read_b64_tr_b16 v[108:109], v245 offset:8192
  s_add_u32 m0, s38, 106496
  s_movk_i32 s37, 896
  buffer_load_dwordx4 v242, s[16:19], s37 offen lds
  v_cvt_pk_bf16_f32 v34, v152, v153
  v_mfma_f32_16x16x32_bf16 v[172:175], v[116:119], v[8:11], v[172:175]
  ds_read_b64_tr_b16 v[110:111], v247 offset:8192
  v_cvt_pk_bf16_f32 v35, v154, v155
  s_waitcnt lgkmcnt(6)
  v_mfma_f32_16x16x32_bf16 v[160:163], v[96:99], v[4:7], v[160:163]
  ds_read_b64_tr_b16 v[112:113], v244 offset:24576
  s_add_u32 m0, s38, 114688
  s_movk_i32 s37, 896
  buffer_load_dwordx4 v243, s[16:19], s37 offen lds
  v_cvt_pk_bf16_f32 v36, v148, v149
  v_mfma_f32_16x16x32_bf16 v[164:167], v[96:99], v[12:15], v[164:167]
  ds_read_b64_tr_b16 v[114:115], v244 offset:26624
  v_cvt_pk_bf16_f32 v37, v150, v151
  s_waitcnt lgkmcnt(6)
  v_mfma_f32_16x16x32_bf16 v[168:171], v[100:103], v[4:7], v[168:171]
  ds_read_b64_tr_b16 v[116:117], v245 offset:24576
  s_add_u32 m0, s38, 122880
  s_movk_i32 s37, 1024
  buffer_load_dwordx4 v241, s[16:19], s37 offen lds
  v_cvt_pk_bf16_f32 v38, v156, v157
  v_mfma_f32_16x16x32_bf16 v[172:175], v[100:103], v[12:15], v[172:175]
  ds_read_b64_tr_b16 v[118:119], v245 offset:26624
  v_cvt_pk_bf16_f32 v39, v158, v159
  s_waitcnt lgkmcnt(6)
  v_mfma_f32_16x16x32_bf16 v[160:163], v[104:107], v[216:219], v[160:163]
  ds_read_b64_tr_b16 v[96:97], v244 offset:28672
  s_add_u32 m0, s38, 131072
  s_movk_i32 s37, 1024
  buffer_load_dwordx4 v242, s[16:19], s37 offen lds
  v_mfma_f32_16x16x32_bf16 v[164:167], v[104:107], v[228:231], v[164:167]
  ds_read_b64_tr_b16 v[98:99], v244 offset:30720
  s_waitcnt lgkmcnt(6)
  v_mfma_f32_16x16x32_bf16 v[168:171], v[108:111], v[216:219], v[168:171]
  ds_read_b64_tr_b16 v[100:101], v245 offset:28672
  s_add_u32 m0, s38, 139264
  s_movk_i32 s37, 1024
  buffer_load_dwordx4 v243, s[16:19], s37 offen lds
  v_mfma_f32_16x16x32_bf16 v[172:175], v[108:111], v[228:231], v[172:175]
  ds_read_b64_tr_b16 v[102:103], v245 offset:30720
  s_add_u32 s35, s39, 32768
  buffer_store_dwordx4 v[32:35], v254, s[20:23], s35 offen offset:0 sc1
  buffer_store_dwordx4 v[36:39], v254, s[20:23], s35 offen offset:1024 sc1
  s_waitcnt lgkmcnt(6)
  v_mfma_f32_16x16x32_bf16 v[144:147], v[112:115], v[208:211], 0
  ds_read_b64_tr_b16 v[104:105], v246 offset:24576
  v_mfma_f32_16x16x32_bf16 v[148:151], v[112:115], v[220:223], 0
  ds_read_b64_tr_b16 v[106:107], v246 offset:26624
  s_waitcnt lgkmcnt(6)
  v_mfma_f32_16x16x32_bf16 v[152:155], v[116:119], v[208:211], 0
  ds_read_b64_tr_b16 v[108:109], v247 offset:24576
  v_mfma_f32_16x16x32_bf16 v[156:159], v[116:119], v[220:223], 0
  ds_read_b64_tr_b16 v[110:111], v247 offset:26624
  s_waitcnt lgkmcnt(6)
  v_mfma_f32_16x16x32_bf16 v[144:147], v[96:99], v[212:215], v[144:147]
  ds_read_b64_tr_b16 v[112:113], v246 offset:28672
  v_mfma_f32_16x16x32_bf16 v[148:151], v[96:99], v[224:227], v[148:151]
  ds_read_b64_tr_b16 v[114:115], v246 offset:30720
  s_waitcnt lgkmcnt(6)
  v_mfma_f32_16x16x32_bf16 v[152:155], v[100:103], v[212:215], v[152:155]
  ds_read_b64_tr_b16 v[116:117], v247 offset:28672
  v_mfma_f32_16x16x32_bf16 v[156:159], v[100:103], v[224:227], v[156:159]
  ds_read_b64_tr_b16 v[118:119], v247 offset:30720
  s_waitcnt lgkmcnt(6)
  v_mfma_f32_16x16x32_bf16 v[144:147], v[104:107], v[0:3], v[144:147]
  ds_read_b64_tr_b16 v[96:97], v244 offset:32768
  v_cvt_pk_bf16_f32 v40, v160, v161
  v_mfma_f32_16x16x32_bf16 v[148:151], v[104:107], v[8:11], v[148:151]
  ds_read_b64_tr_b16 v[98:99], v246 offset:32768
  v_cvt_pk_bf16_f32 v41, v162, v163
  s_waitcnt lgkmcnt(6)
  v_mfma_f32_16x16x32_bf16 v[152:155], v[108:111], v[0:3], v[152:155]
  ds_read_b64_tr_b16 v[100:101], v245 offset:32768
  v_cvt_pk_bf16_f32 v42, v168, v169
  v_mfma_f32_16x16x32_bf16 v[156:159], v[108:111], v[8:11], v[156:159]
  ds_read_b64_tr_b16 v[102:103], v247 offset:32768
  v_cvt_pk_bf16_f32 v43, v170, v171
  s_waitcnt lgkmcnt(6)
  v_mfma_f32_16x16x32_bf16 v[144:147], v[112:115], v[4:7], v[144:147]
  ds_read_b64_tr_b16 v[104:105], v244 offset:49152
  v_cvt_pk_bf16_f32 v44, v164, v165
  v_mfma_f32_16x16x32_bf16 v[148:151], v[112:115], v[12:15], v[148:151]
  ds_read_b64_tr_b16 v[106:107], v244 offset:51200
  v_cvt_pk_bf16_f32 v45, v166, v167
  s_waitcnt lgkmcnt(6)
  v_mfma_f32_16x16x32_bf16 v[152:155], v[116:119], v[4:7], v[152:155]
  ds_read_b64_tr_b16 v[108:109], v245 offset:49152
  v_cvt_pk_bf16_f32 v46, v172, v173
  v_mfma_f32_16x16x32_bf16 v[156:159], v[116:119], v[12:15], v[156:159]
  ds_read_b64_tr_b16 v[110:111], v245 offset:51200
  v_cvt_pk_bf16_f32 v47, v174, v175
  s_waitcnt lgkmcnt(6)
  v_mfma_f32_16x16x32_bf16 v[144:147], v[96:99], v[216:219], v[144:147]
  ds_read_b64_tr_b16 v[112:113], v244 offset:53248
  v_mfma_f32_16x16x32_bf16 v[148:151], v[96:99], v[228:231], v[148:151]
  ds_read_b64_tr_b16 v[114:115], v244 offset:55296
  s_waitcnt lgkmcnt(6)
  v_mfma_f32_16x16x32_bf16 v[152:155], v[100:103], v[216:219], v[152:155]
  ds_read_b64_tr_b16 v[116:117], v245 offset:53248
  v_mfma_f32_16x16x32_bf16 v[156:159], v[100:103], v[228:231], v[156:159]
  ds_read_b64_tr_b16 v[118:119], v245 offset:55296
  s_add_u32 s35, s39, 49152
  buffer_store_dwordx4 v[40:43], v254, s[20:23], s35 offen offset:0 sc1
  buffer_store_dwordx4 v[44:47], v254, s[20:23], s35 offen offset:1024 sc1
  s_waitcnt lgkmcnt(6)
  v_mfma_f32_16x16x32_bf16 v[160:163], v[104:107], v[208:211], 0
  ds_read_b64_tr_b16 v[96:97], v246 offset:49152
  v_mfma_f32_16x16x32_bf16 v[164:167], v[104:107], v[220:223], 0
  ds_read_b64_tr_b16 v[98:99], v246 offset:51200
  s_waitcnt lgkmcnt(6)
  v_mfma_f32_16x16x32_bf16 v[168:171], v[108:111], v[208:211], 0
  ds_read_b64_tr_b16 v[100:101], v247 offset:49152
  v_mfma_f32_16x16x32_bf16 v[172:175], v[108:111], v[220:223], 0
  ds_read_b64_tr_b16 v[102:103], v247 offset:51200
  s_waitcnt lgkmcnt(6)
  v_mfma_f32_16x16x32_bf16 v[160:163], v[112:115], v[212:215], v[160:163]
  ds_read_b64_tr_b16 v[104:105], v246 offset:53248
  v_mfma_f32_16x16x32_bf16 v[164:167], v[112:115], v[224:227], v[164:167]
  ds_read_b64_tr_b16 v[106:107], v246 offset:55296
  s_waitcnt lgkmcnt(6)
  v_mfma_f32_16x16x32_bf16 v[168:171], v[116:119], v[212:215], v[168:171]
  ds_read_b64_tr_b16 v[108:109], v247 offset:53248
  v_mfma_f32_16x16x32_bf16 v[172:175], v[116:119], v[224:227], v[172:175]
  ds_read_b64_tr_b16 v[110:111], v247 offset:55296
  s_waitcnt lgkmcnt(6)
  v_mfma_f32_16x16x32_bf16 v[160:163], v[96:99], v[0:3], v[160:163]
  ds_read_b64_tr_b16 v[112:113], v244 offset:57344
  v_cvt_pk_bf16_f32 v32, v144, v145
  v_mfma_f32_16x16x32_bf16 v[164:167], v[96:99], v[8:11], v[164:167]
  ds_read_b64_tr_b16 v[114:115], v246 offset:57344
  v_cvt_pk_bf16_f32 v33, v146, v147
  s_waitcnt lgkmcnt(6)
  v_mfma_f32_16x16x32_bf16 v[168:171], v[100:103], v[0:3], v[168:171]
  ds_read_b64_tr_b16 v[116:117], v245 offset:57344
  v_cvt_pk_bf16_f32 v34, v152, v153
  v_mfma_f32_16x16x32_bf16 v[172:175], v[100:103], v[8:11], v[172:175]
  ds_read_b64_tr_b16 v[118:119], v247 offset:57344
  v_cvt_pk_bf16_f32 v35, v154, v155
  s_waitcnt lgkmcnt(6)
  v_mfma_f32_16x16x32_bf16 v[160:163], v[104:107], v[4:7], v[160:163]
  v_cvt_pk_bf16_f32 v36, v148, v149
  v_mfma_f32_16x16x32_bf16 v[164:167], v[104:107], v[12:15], v[164:167]
  v_cvt_pk_bf16_f32 v37, v150, v151
  s_waitcnt lgkmcnt(4)
  v_mfma_f32_16x16x32_bf16 v[168:171], v[108:111], v[4:7], v[168:171]
  v_cvt_pk_bf16_f32 v38, v156, v157
  v_mfma_f32_16x16x32_bf16 v[172:175], v[108:111], v[12:15], v[172:175]
  v_cvt_pk_bf16_f32 v39, v158, v159
  s_waitcnt lgkmcnt(2)
  v_mfma_f32_16x16x32_bf16 v[160:163], v[112:115], v[216:219], v[160:163]
  v_mfma_f32_16x16x32_bf16 v[164:167], v[112:115], v[228:231], v[164:167]
  s_waitcnt lgkmcnt(0)
  v_mfma_f32_16x16x32_bf16 v[168:171], v[116:119], v[216:219], v[168:171]
  v_mfma_f32_16x16x32_bf16 v[172:175], v[116:119], v[228:231], v[172:175]
  s_add_u32 s35, s39, 65536
  buffer_store_dwordx4 v[32:35], v254, s[20:23], s35 offen offset:0 sc1
  buffer_store_dwordx4 v[36:39], v254, s[20:23], s35 offen offset:1024 sc1
  v_add_u32 v244, 73728, v244
  v_add_u32 v245, 73728, v245
  v_add_u32 v246, 73728, v246
  v_add_u32 v247, 73728, v247
  s_waitcnt vmcnt(6)
  s_barrier
  ds_read_b64_tr_b16 v[96:97], v244 offset:0
  ds_read_b64_tr_b16 v[98:99], v244 offset:2048
  ds_read_b64_tr_b16 v[100:101], v245 offset:0
  ds_read_b64_tr_b16 v[102:103], v245 offset:2048
  ds_read_b64_tr_b16 v[104:105], v244 offset:4096
  ds_read_b64_tr_b16 v[106:107], v244 offset:6144
  ds_read_b64_tr_b16 v[108:109], v245 offset:4096
  ds_read_b64_tr_b16 v[110:111], v245 offset:6144
  s_waitcnt lgkmcnt(6)
  v_mfma_f32_16x16x32_bf16 v[144:147], v[96:99], v[208:211], 0
  ds_read_b64_tr_b16 v[112:113], v246 offset:0
  v_mfma_f32_16x16x32_bf16 v[148:151], v[96:99], v[220:223], 0
  ds_read_b64_tr_b16 v[114:115], v246 offset:2048
  s_waitcnt lgkmcnt(6)
  v_mfma_f32_16x16x32_bf16 v[152:155], v[100:103], v[208:211], 0
  ds_read_b64_tr_b16 v[116:117], v247 offset:0
  v_mfma_f32_16x16x32_bf16 v[156:159], v[100:103], v[220:223], 0
  ds_read_b64_tr_b16 v[118:119], v247 offset:2048
  s_waitcnt lgkmcnt(6)
  v_mfma_f32_16x16x32_bf16 v[144:147], v[104:107], v[212:215], v[144:147]
  ds_read_b64_tr_b16 v[96:97], v246 offset:4096
  v_mfma_f32_16x16x32_bf16 v[148:151], v[104:107], v[224:227], v[148:151]
  ds_read_b64_tr_b16 v[98:99], v246 offset:6144
  s_waitcnt lgkmcnt(6)
  v_mfma_f32_16x16x32_bf16 v[152:155], v[108:111], v[212:215], v[152:155]
  ds_read_b64_tr_b16 v[100:101], v247 offset:4096
  v_mfma_f32_16x16x32_bf16 v[156:159], v[108:111], v[224:227], v[156:159]
  ds_read_b64_tr_b16 v[102:103], v247 offset:6144
  s_waitcnt lgkmcnt(6)
  v_mfma_f32_16x16x32_bf16 v[144:147], v[112:115], v[0:3], v[144:147]
  ds_read_b64_tr_b16 v[104:105], v244 offset:8192
  v_cvt_pk_bf16_f32 v40, v160, v161
  v_mfma_f32_16x16x32_bf16 v[148:151], v[112:115], v[8:11], v[148:151]
  ds_read_b64_tr_b16 v[106:107], v246 offset:8192
  v_cvt_pk_bf16_f32 v41, v162, v163
  s_waitcnt lgkmcnt(6)
  v_mfma_f32_16x16x32_bf16 v[152:155], v[116:119], v[0:3], v[152:155]
  ds_read_b64_tr_b16 v[108:109], v245 offset:8192
  v_cvt_pk_bf16_f32 v42, v168, v169
  v_mfma_f32_16x16x32_bf16 v[156:159], v[116:119], v[8:11], v[156:159]
  ds_read_b64_tr_b16 v[110:111], v247 offset:8192
  v_cvt_pk_bf16_f32 v43, v170, v171
  s_waitcnt lgkmcnt(6)
  v_mfma_f32_16x16x32_bf16 v[144:147], v[96:99], v[4:7], v[144:147]
  ds_read_b64_tr_b16 v[112:113], v244 offset:24576
  v_cvt_pk_bf16_f32 v44, v164, v165
  v_mfma_f32_16x16x32_bf16 v[148:151], v[96:99], v[12:15], v[148:151]
  ds_read_b64_tr_b16 v[114:115], v244 offset:26624
  v_cvt_pk_bf16_f32 v45, v166, v167
  s_waitcnt lgkmcnt(6)
  v_mfma_f32_16x16x32_bf16 v[152:155], v[100:103], v[4:7], v[152:155]
  ds_read_b64_tr_b16 v[116:117], v245 offset:24576
  v_cvt_pk_bf16_f32 v46, v172, v173
  v_mfma_f32_16x16x32_bf16 v[156:159], v[100:103], v[12:15], v[156:159]
  ds_read_b64_tr_b16 v[118:119], v245 offset:26624
  v_cvt_pk_bf16_f32 v47, v174, v175
  s_waitcnt lgkmcnt(6)
  v_mfma_f32_16x16x32_bf16 v[144:147], v[104:107], v[216:219], v[144:147]
  ds_read_b64_tr_b16 v[96:97], v244 offset:28672
  v_mfma_f32_16x16x32_bf16 v[148:151], v[104:107], v[228:231], v[148:151]
  ds_read_b64_tr_b16 v[98:99], v244 offset:30720
  s_waitcnt lgkmcnt(6)
  v_mfma_f32_16x16x32_bf16 v[152:155], v[108:111], v[216:219], v[152:155]
  ds_read_b64_tr_b16 v[100:101], v245 offset:28672
  v_mfma_f32_16x16x32_bf16 v[156:159], v[108:111], v[228:231], v[156:159]
  ds_read_b64_tr_b16 v[102:103], v245 offset:30720
  s_add_u32 s35, s39, 81920
  buffer_store_dwordx4 v[40:43], v254, s[20:23], s35 offen offset:0 sc1
  buffer_store_dwordx4 v[44:47], v254, s[20:23], s35 offen offset:1024 sc1
  s_waitcnt lgkmcnt(6)
  v_mfma_f32_16x16x32_bf16 v[160:163], v[112:115], v[208:211], 0
  ds_read_b64_tr_b16 v[104:105], v246 offset:24576
  v_mfma_f32_16x16x32_bf16 v[164:167], v[112:115], v[220:223], 0
  ds_read_b64_tr_b16 v[106:107], v246 offset:26624
  s_waitcnt lgkmcnt(6)
  v_mfma_f32_16x16x32_bf16 v[168:171], v[116:119], v[208:211], 0
  ds_read_b64_tr_b16 v[108:109], v247 offset:24576
  v_mfma_f32_16x16x32_bf16 v[172:175], v[116:119], v[220:223], 0
  ds_read_b64_tr_b16 v[110:111], v247 offset:26624
  s_waitcnt lgkmcnt(6)
  v_mfma_f32_16x16x32_bf16 v[160:163], v[96:99], v[212:215], v[160:163]
  ds_read_b64_tr_b16 v[112:113], v246 offset:28672
  v_mfma_f32_16x16x32_bf16 v[164:167], v[96:99], v[224:227], v[164:167]
  ds_read_b64_tr_b16 v[114:115], v246 offset:30720
  s_waitcnt lgkmcnt(6)
  v_mfma_f32_16x16x32_bf16 v[168:171], v[100:103], v[212:215], v[168:171]
  ds_read_b64_tr_b16 v[116:117], v247 offset:28672
  v_mfma_f32_16x16x32_bf16 v[172:175], v[100:103], v[224:227], v[172:175]
  ds_read_b64_tr_b16 v[118:119], v247 offset:30720
  s_waitcnt lgkmcnt(6)
  v_mfma_f32_16x16x32_bf16 v[160:163], v[104:107], v[0:3], v[160:163]
  ds_read_b64_tr_b16 v[96:97], v244 offset:32768
  v_cvt_pk_bf16_f32 v32, v144, v145
  v_mfma_f32_16x16x32_bf16 v[164:167], v[104:107], v[8:11], v[164:167]
  ds_read_b64_tr_b16 v[98:99], v246 offset:32768
  v_cvt_pk_bf16_f32 v33, v146, v147
  s_waitcnt lgkmcnt(6)
  v_mfma_f32_16x16x32_bf16 v[168:171], v[108:111], v[0:3], v[168:171]
  ds_read_b64_tr_b16 v[100:101], v245 offset:32768
  v_cvt_pk_bf16_f32 v34, v152, v153
  v_mfma_f32_16x16x32_bf16 v[172:175], v[108:111], v[8:11], v[172:175]
  ds_read_b64_tr_b16 v[102:103], v247 offset:32768
  v_cvt_pk_bf16_f32 v35, v154, v155
  s_waitcnt lgkmcnt(6)
  v_mfma_f32_16x16x32_bf16 v[160:163], v[112:115], v[4:7], v[160:163]
  ds_read_b64_tr_b16 v[104:105], v244 offset:49152
  v_cvt_pk_bf16_f32 v36, v148, v149
  v_mfma_f32_16x16x32_bf16 v[164:167], v[112:115], v[12:15], v[164:167]
  ds_read_b64_tr_b16 v[106:107], v244 offset:51200
  v_cvt_pk_bf16_f32 v37, v150, v151
  s_waitcnt lgkmcnt(6)
  v_mfma_f32_16x16x32_bf16 v[168:171], v[116:119], v[4:7], v[168:171]
  ds_read_b64_tr_b16 v[108:109], v245 offset:49152
  v_cvt_pk_bf16_f32 v38, v156, v157
  v_mfma_f32_16x16x32_bf16 v[172:175], v[116:119], v[12:15], v[172:175]
  ds_read_b64_tr_b16 v[110:111], v245 offset:51200
  v_cvt_pk_bf16_f32 v39, v158, v159
  s_waitcnt lgkmcnt(6)
  v_mfma_f32_16x16x32_bf16 v[160:163], v[96:99], v[216:219], v[160:163]
  ds_read_b64_tr_b16 v[112:113], v244 offset:53248
  v_mfma_f32_16x16x32_bf16 v[164:167], v[96:99], v[228:231], v[164:167]
  ds_read_b64_tr_b16 v[114:115], v244 offset:55296
  s_waitcnt lgkmcnt(6)
  v_mfma_f32_16x16x32_bf16 v[168:171], v[100:103], v[216:219], v[168:171]
  ds_read_b64_tr_b16 v[116:117], v245 offset:53248
  v_mfma_f32_16x16x32_bf16 v[172:175], v[100:103], v[228:231], v[172:175]
  ds_read_b64_tr_b16 v[118:119], v245 offset:55296
  s_add_u32 s35, s39, 98304
  buffer_store_dwordx4 v[32:35], v254, s[20:23], s35 offen offset:0 sc1
  buffer_store_dwordx4 v[36:39], v254, s[20:23], s35 offen offset:1024 sc1
  s_waitcnt lgkmcnt(6)
  v_mfma_f32_16x16x32_bf16 v[144:147], v[104:107], v[208:211], 0
  ds_read_b64_tr_b16 v[96:97], v246 offset:49152
  v_mfma_f32_16x16x32_bf16 v[148:151], v[104:107], v[220:223], 0
  ds_read_b64_tr_b16 v[98:99], v246 offset:51200
  s_waitcnt lgkmcnt(6)
  v_mfma_f32_16x16x32_bf16 v[152:155], v[108:111], v[208:211], 0
  ds_read_b64_tr_b16 v[100:101], v247 offset:49152
  v_mfma_f32_16x16x32_bf16 v[156:159], v[108:111], v[220:223], 0
  ds_read_b64_tr_b16 v[102:103], v247 offset:51200
  s_waitcnt lgkmcnt(6)
  v_mfma_f32_16x16x32_bf16 v[144:147], v[112:115], v[212:215], v[144:147]
  ds_read_b64_tr_b16 v[104:105], v246 offset:53248
  v_mfma_f32_16x16x32_bf16 v[148:151], v[112:115], v[224:227], v[148:151]
  ds_read_b64_tr_b16 v[106:107], v246 offset:55296
  s_waitcnt lgkmcnt(6)
  v_mfma_f32_16x16x32_bf16 v[152:155], v[116:119], v[212:215], v[152:155]
  ds_read_b64_tr_b16 v[108:109], v247 offset:53248
  v_mfma_f32_16x16x32_bf16 v[156:159], v[116:119], v[224:227], v[156:159]
  ds_read_b64_tr_b16 v[110:111], v247 offset:55296
  s_waitcnt lgkmcnt(6)
  v_mfma_f32_16x16x32_bf16 v[144:147], v[96:99], v[0:3], v[144:147]
  ds_read_b64_tr_b16 v[112:113], v244 offset:57344
  v_cvt_pk_bf16_f32 v40, v160, v161
  v_mfma_f32_16x16x32_bf16 v[148:151], v[96:99], v[8:11], v[148:151]
  ds_read_b64_tr_b16 v[114:115], v246 offset:57344
  v_cvt_pk_bf16_f32 v41, v162, v163
  s_waitcnt lgkmcnt(6)
  v_mfma_f32_16x16x32_bf16 v[152:155], v[100:103], v[0:3], v[152:155]
  ds_read_b64_tr_b16 v[116:117], v245 offset:57344
  v_cvt_pk_bf16_f32 v42, v168, v169
  v_mfma_f32_16x16x32_bf16 v[156:159], v[100:103], v[8:11], v[156:159]
  ds_read_b64_tr_b16 v[118:119], v247 offset:57344
  v_cvt_pk_bf16_f32 v43, v170, v171
  s_waitcnt lgkmcnt(6)
  v_mfma_f32_16x16x32_bf16 v[144:147], v[104:107], v[4:7], v[144:147]
  v_cvt_pk_bf16_f32 v44, v164, v165
  v_mfma_f32_16x16x32_bf16 v[148:151], v[104:107], v[12:15], v[148:151]
  v_cvt_pk_bf16_f32 v45, v166, v167
  s_waitcnt lgkmcnt(4)
  v_mfma_f32_16x16x32_bf16 v[152:155], v[108:111], v[4:7], v[152:155]
  v_cvt_pk_bf16_f32 v46, v172, v173
  v_mfma_f32_16x16x32_bf16 v[156:159], v[108:111], v[12:15], v[156:159]
  v_cvt_pk_bf16_f32 v47, v174, v175
  s_waitcnt lgkmcnt(2)
  v_mfma_f32_16x16x32_bf16 v[144:147], v[112:115], v[216:219], v[144:147]
  v_mfma_f32_16x16x32_bf16 v[148:151], v[112:115], v[228:231], v[148:151]
  s_waitcnt lgkmcnt(0)
  v_mfma_f32_16x16x32_bf16 v[152:155], v[116:119], v[216:219], v[152:155]
  v_mfma_f32_16x16x32_bf16 v[156:159], v[116:119], v[228:231], v[156:159]
  s_add_u32 s35, s39, 114688
  buffer_store_dwordx4 v[40:43], v254, s[20:23], s35 offen offset:0 sc1
  buffer_store_dwordx4 v[44:47], v254, s[20:23], s35 offen offset:1024 sc1
  s_nop 7
  v_cvt_pk_bf16_f32 v32, v144, v145
  v_cvt_pk_bf16_f32 v33, v146, v147
  v_cvt_pk_bf16_f32 v34, v152, v153
  v_cvt_pk_bf16_f32 v35, v154, v155
  v_cvt_pk_bf16_f32 v36, v148, v149
  v_cvt_pk_bf16_f32 v37, v150, v151
  v_cvt_pk_bf16_f32 v38, v156, v157
  v_cvt_pk_bf16_f32 v39, v158, v159
  s_add_u32 s35, s39, 131072
  buffer_store_dwordx4 v[32:35], v254, s[20:23], s35 offen offset:0 sc1
  buffer_store_dwordx4 v[36:39], v254, s[20:23], s35 offen offset:1024 sc1
  s_lshl_b32 s58, s29, 8
  s_add_u32 s58, s58, 37904512
  s_mov_b32 s35, 0
  s_cmp_lg_u32 s28, 0
  s_cbranch_scc1 L_zq83
  v_mov_b32 v2, 0
  buffer_load_dword v2, v2, s[48:51], s35 offen sc1
L_zq83:
  s_waitcnt vmcnt(0)
  s_cmp_lg_u32 s28, 0
  s_cbranch_scc1 L_zq84
  s_mov_b32 s52, 0
L_pc85:
  v_readfirstlane_b32 s36, v2
  s_add_u32 s52, s52, 1
  s_nop 3
  s_cmp_ge_u32 s36, 16
  s_cbranch_scc1 L_pcd86
  s_cmp_ge_u32 s52, 0x40000
  s_cbranch_scc1 L_pcd86
  s_sleep 2
  v_mov_b32 v2, 0
  buffer_load_dword v2, v2, s[48:51], s35 offen sc1
  s_waitcnt vmcnt(0)
  s_branch L_pc85
L_pcd86:
L_zq84:
  s_barrier
  s_cmp_lg_u32 s28, 0
  s_cbranch_scc1 L_sig87
  v_mov_b32 v0, 1
  v_mov_b32 v1, 0
  s_mov_b64 exec, 1
  buffer_atomic_add v0, v1, s[20:23], s58 offen
  s_mov_b64 exec, -1
L_sig87:
L_k1_end:

  s_endpgm
.section .rodata,"a"
.p2align 6
.amdhsa_kernel gated_mix__linear_attn_block__mixer_channel_mlp__prompt_kernel
  .amdhsa_next_free_vgpr 256
  .amdhsa_next_free_sgpr 102
  .amdhsa_accum_offset 256
  .amdhsa_group_segment_fixed_size 0
  .amdhsa_kernarg_size 96
  .amdhsa_user_sgpr_count 2
  .amdhsa_user_sgpr_kernarg_segment_ptr 1
  .amdhsa_system_sgpr_workgroup_id_x 1
.end_amdhsa_kernel
```
